```python
import torch

def _softmax(x, axis=-1):
    return torch.softmax(x, dim=axis)
def _gelu(x):
    return torch.nn.functional.gelu(x, approximate="tanh")
def _silu(x):
    return torch.nn.functional.silu(x)
def _sigmoid(x):
    return torch.sigmoid(x)
def _layernorm(x, axis=-1, eps=1e-5):
    m = x.mean(dim=axis, keepdim=True)
    v = x.var(dim=axis, keepdim=True, unbiased=False)
    return (x - m) / torch.sqrt(v + eps)
def _scatter_add(tgt, idx, src, axis=0):
    return tgt.clone().index_add_(axis, idx, src)
def _segment_sum(src, seg, n):
    out = torch.zeros((n,) + src.shape[1:], dtype=src.dtype)
    return out.index_add_(0, seg, src)
def _pad(x, pw):
    flat = tuple(v for pair in reversed(pw) for v in pair)
    return torch.nn.functional.pad(x, flat)

kernel_name = 'sequential_preLN__ssm_conv_s4d__dense_activation_squared_relu__prompt'

def setup_inputs():

    _w = (lambda a: (lambda t: t.to(torch.bfloat16) if t.is_floating_point() else t)(torch.as_tensor(a)))
    def _A_setup():
        Bsz, L, D, N = 1, 2048, 640, 128
        return {
            "u": _w((lambda *s: torch.randn(*s, dtype=torch.bfloat16) * 0.05)(Bsz, L, D)),
            "log_A_real": _w((lambda *s: torch.randn(*s, dtype=torch.bfloat16) * 3.2)(D, N) * 0.5),
            "A_imag": _w((lambda *s: torch.randn(*s, dtype=torch.bfloat16) * 0.05)(D, N) * 3.14),
            "C_real": _w((lambda *s: torch.randn(*s, dtype=torch.bfloat16) * 0.2)(D, N) / N ** 0.5),
            "C_imag": _w((lambda *s: torch.randn(*s, dtype=torch.bfloat16) * 0.2)(D, N) / N ** 0.5),
            "log_dt": _w((lambda *s: torch.randn(*s, dtype=torch.bfloat16) * 0.05)(D) * 0.5 - 4.0),
            "D_skip": _w((lambda *s: torch.randn(*s, dtype=torch.bfloat16) * 0.05)(D)),
        }
    _A_in = _A_setup()

    def _B_setup():
        B, S, D, F = 1, 2048, 640, 1728
        return {
            "x": _w((lambda *s: torch.randn(*s, dtype=torch.bfloat16) * 0.05)(B, S, D)),
            "w1": _w((lambda *s: torch.randn(*s, dtype=torch.bfloat16) * 0.05)(D, F)),
            "b1": _w((lambda *s: torch.randn(*s, dtype=torch.bfloat16) * 0.4)(F)),
            "w2": _w((lambda *s: torch.randn(*s, dtype=torch.bfloat16) * 0.05)(F, D)),
            "b2": _w((lambda *s: torch.randn(*s, dtype=torch.bfloat16) * 1.6)(D)),
        }
    _B_in = _B_setup()

    return {
        "A_u": _A_in["u"],
        "A_log_A_real": _A_in["log_A_real"],
        "A_A_imag": _A_in["A_imag"],
        "A_C_real": _A_in["C_real"],
        "A_C_imag": _A_in["C_imag"],
        "A_log_dt": _A_in["log_dt"],
        "A_D_skip": _A_in["D_skip"],
        "B_x": _B_in["x"],
        "B_w1": _B_in["w1"],
        "B_b1": _B_in["b1"],
        "B_w2": _B_in["w2"],
        "B_b2": _B_in["b2"],
    }

def reference(A_u, A_log_A_real, A_A_imag, A_C_real, A_C_imag, A_log_dt, A_D_skip, B_x, B_w1, B_b1, B_w2, B_b2):
    def _A_ref(u, log_A_real, A_imag, C_real, C_imag, log_dt, D_skip):
        L = u.shape[1]
        dt = torch.exp(log_dt)
        A = -torch.exp(log_A_real) + 1j * A_imag
        C = (C_real + 1j * C_imag) * dt[:, None]
        pos = (lambda x, dt: x.to(dt))(torch.arange(L), log_dt.dtype)
        P = torch.exp((A * dt[:, None])[:, :, None] * pos[None, None, :])
        K = 2.0 * torch.einsum("dn,dnl->dl", C, P).real
        L2 = 2 * L
        u_t = (lambda x, *d: x.permute(*d))(u, 0, 2, 1)
        Kf = (lambda x, *a, **k: torch.fft.rfft(x.float(), *a, **k))(K, L2)
        Uf = (lambda x, *a, **k: torch.fft.rfft(x.float(), *a, **k))(u_t, L2)
        y = (lambda x, *a, **k: torch.fft.irfft(x, *a, **k).to(torch.bfloat16))(Uf * Kf[None, :, :], L2)[:, :, :L]
        y = (lambda x, *d: x.permute(*d))(y, 0, 2, 1)
        return y + u * D_skip[None, None, :]

    def _B_ref(x, w1, b1, w2, b2):
        h = torch.einsum("bsd,df->bsf", x, w1) + b1
        zero = torch.zeros_like(h)
        r = torch.where(h > zero, h, zero)
        h = r * r
        out = torch.einsum("bsf,fd->bsd", h, w2) + b2
        return out

    x = A_u
    h = x + _A_ref(_layernorm(x, axis=-1), A_log_A_real, A_A_imag, A_C_real, A_C_imag, A_log_dt, A_D_skip)
    h2 = h + _B_ref(_layernorm(h, axis=-1), B_w1, B_b1, B_w2, B_b2)
    return h2
```

```asm
; @launch grid=(256,1,1) block=(256,1,1) lds=163840
.amdgcn_target "amdgcn-amd-amdhsa--gfx950"
.text
.globl sequential_preLN__ssm_conv_s4d__dense_activation_squared_relu__prompt_kernel
.p2align 8
.type sequential_preLN__ssm_conv_s4d__dense_activation_squared_relu__prompt_kernel,@function
sequential_preLN__ssm_conv_s4d__dense_activation_squared_relu__prompt_kernel:

s_cmp_ge_u32 s2, 256
s_cbranch_scc1 L_end_f
s_load_dwordx16 s[16:31], s[0:1], 0
s_load_dwordx8 s[32:39], s[0:1], 64
s_load_dwordx4 s[40:43], s[0:1], 96
s_load_dwordx2 s[44:45], s[0:1], 112
v_lshrrev_b32 v1, 6, v0
v_and_b32 v2, 63, v0
v_readfirstlane_b32 s4, v1
s_waitcnt lgkmcnt(0)
s_mov_b32 s12, s44
s_mov_b32 s13, s45
s_mov_b32 s14, 67108864
s_mov_b32 s15, 0x20000
s_mov_b32 s8, s16
s_mov_b32 s9, s17
s_mov_b32 s10, 2621440
s_mov_b32 s11, 0x20000
v_lshrrev_b32 v3, 5, v0
v_and_b32 v4, 31, v0
v_mul_u32_u24 v5, 0x500, v3
v_lshl_add_u32 v5, v4, 3, v5
s_mov_b32 s82, s2
s_mov_b32 s81, 1
s_mul_i32 s3, s82, 10240
buffer_load_dwordx2 v[8:9], v5, s[8:11], s3 offen offset:0
buffer_load_dwordx2 v[10:11], v5, s[8:11], s3 offen offset:256
buffer_load_dwordx2 v[12:13], v5, s[8:11], s3 offen offset:512
buffer_load_dwordx2 v[14:15], v5, s[8:11], s3 offen offset:768
buffer_load_dwordx2 v[16:17], v5, s[8:11], s3 offen offset:1024
s_add_u32 s3, s3, 983040
v_mov_b32 v97, 33554432
buffer_load_dword v96, v97, s[12:15], 0 offen sc1
s_cmp_lt_u32 s2, 160
s_cbranch_scc0 Laux_1
s_lshl_b32 s5, s2, 2
s_add_u32 s5, s5, s4
s_lshl_b32 s6, s5, 8
v_lshlrev_b32 v98, 2, v2
v_add_u32 v98, s6, v98
global_load_dword v156, v98, s[18:19]
global_load_dword v157, v98, s[20:21]
global_load_dword v158, v98, s[22:23]
global_load_dword v159, v98, s[24:25]
s_lshl_b32 s6, s5, 1
v_mov_b32 v99, s6
global_load_ushort v160, v99, s[26:27]
global_load_ushort v161, v99, s[28:29]
s_getpc_b64 s[46:47]
Lcp_3_pc:
s_sub_u32 s46, s46, Lcp_3_pc-sequential_preLN__ssm_conv_s4d__dense_activation_squared_relu__prompt_kernel
s_subb_u32 s47, s47, 0
s_lshr_b32 s5, s2, 3
s_lshl_b32 s5, s5, 2
s_add_u32 s5, s5, s4
s_min_u32 s5, s5, (L_end_f-sequential_preLN__ssm_conv_s4d__dense_activation_squared_relu__prompt_kernel)/1024-1
s_lshl_b32 s5, s5, 10
v_lshlrev_b32 v97, 4, v2
v_add_u32 v97, s5, v97
global_load_dwordx4 v[232:235], v97, s[46:47]
s_mul_i32 s61, s4, 30272
v_lshlrev_b32 v90, 3, v2
v_sub_u32 v90, 2047, v90
s_add_u32 s6, s61, 16640
s_movk_i32 s7, 0x80
v_subrev_u32 v91, 0, v90
v_cvt_f32_i32 v93, v91
v_subrev_u32 v92, 1, v90
v_cvt_f32_i32 v94, v92
v_cvt_pk_bf16_f32 v93, v93, v94
v_lshrrev_b32 v94, 16, v93
v_and_b32 v93, 0xffff, v93
v_subrev_u32 v93, 0x4280, v93
v_med3_i32 v93, v93, v91, s7
v_lshl_add_u32 v100, v93, 1, s6
v_subrev_u32 v94, 0x4280, v94
v_med3_i32 v94, v94, v92, s7
v_lshl_add_u32 v101, v94, 1, s6
v_subrev_u32 v91, 2, v90
v_cvt_f32_i32 v93, v91
v_subrev_u32 v92, 3, v90
v_cvt_f32_i32 v94, v92
v_cvt_pk_bf16_f32 v93, v93, v94
v_lshrrev_b32 v94, 16, v93
v_and_b32 v93, 0xffff, v93
v_subrev_u32 v93, 0x4280, v93
v_med3_i32 v93, v93, v91, s7
v_lshl_add_u32 v102, v93, 1, s6
v_subrev_u32 v94, 0x4280, v94
v_med3_i32 v94, v94, v92, s7
v_lshl_add_u32 v103, v94, 1, s6
v_subrev_u32 v91, 4, v90
v_cvt_f32_i32 v93, v91
v_subrev_u32 v92, 5, v90
v_cvt_f32_i32 v94, v92
v_cvt_pk_bf16_f32 v93, v93, v94
v_lshrrev_b32 v94, 16, v93
v_and_b32 v93, 0xffff, v93
v_subrev_u32 v93, 0x4280, v93
v_med3_i32 v93, v93, v91, s7
v_lshl_add_u32 v104, v93, 1, s6
v_subrev_u32 v94, 0x4280, v94
v_med3_i32 v94, v94, v92, s7
v_lshl_add_u32 v105, v94, 1, s6
v_subrev_u32 v91, 6, v90
v_cvt_f32_i32 v93, v91
v_subrev_u32 v92, 7, v90
v_cvt_f32_i32 v94, v92
v_cvt_pk_bf16_f32 v93, v93, v94
v_lshrrev_b32 v94, 16, v93
v_and_b32 v93, 0xffff, v93
v_subrev_u32 v93, 0x4280, v93
v_med3_i32 v93, v93, v91, s7
v_lshl_add_u32 v106, v93, 1, s6
v_subrev_u32 v94, 0x4280, v94
v_med3_i32 v94, v94, v92, s7
v_lshl_add_u32 v107, v94, 1, s6
v_subrev_u32 v91, 8, v90
v_cvt_f32_i32 v93, v91
v_subrev_u32 v92, 9, v90
v_cvt_f32_i32 v94, v92
v_cvt_pk_bf16_f32 v93, v93, v94
v_lshrrev_b32 v94, 16, v93
v_and_b32 v93, 0xffff, v93
v_subrev_u32 v93, 0x4280, v93
v_med3_i32 v93, v93, v91, s7
v_lshl_add_u32 v108, v93, 1, s6
v_subrev_u32 v94, 0x4280, v94
v_med3_i32 v94, v94, v92, s7
v_lshl_add_u32 v109, v94, 1, s6
v_subrev_u32 v91, 10, v90
v_cvt_f32_i32 v93, v91
v_cvt_pk_bf16_f32 v93, v93, v93
v_and_b32 v93, 0xffff, v93
v_subrev_u32 v93, 0x4280, v93
v_med3_i32 v93, v93, v91, s7
v_lshl_add_u32 v110, v93, 1, s6
v_mul_u32_u24 v6, 2624, v3
v_lshl_add_u32 v6, v4, 4, v6
s_mov_b32 s80, 0
s_waitcnt vmcnt(8)
Llnl_4:
v_lshlrev_b32 v20, 16, v8
v_and_b32 v21, 0xffff0000, v8
v_lshlrev_b32 v22, 16, v9
v_and_b32 v23, 0xffff0000, v9
v_lshlrev_b32 v24, 16, v10
v_and_b32 v25, 0xffff0000, v10
v_lshlrev_b32 v26, 16, v11
v_and_b32 v27, 0xffff0000, v11
v_lshlrev_b32 v28, 16, v12
v_and_b32 v29, 0xffff0000, v12
v_lshlrev_b32 v30, 16, v13
v_and_b32 v31, 0xffff0000, v13
v_lshlrev_b32 v32, 16, v14
v_and_b32 v33, 0xffff0000, v14
v_lshlrev_b32 v34, 16, v15
v_and_b32 v35, 0xffff0000, v15
v_lshlrev_b32 v36, 16, v16
v_and_b32 v37, 0xffff0000, v16
v_lshlrev_b32 v38, 16, v17
v_and_b32 v39, 0xffff0000, v17
v_pk_add_f32 v[40:41], v[20:21], v[22:23]
v_pk_add_f32 v[42:43], v[24:25], v[26:27]
v_pk_add_f32 v[40:41], v[40:41], v[28:29]
v_pk_add_f32 v[42:43], v[42:43], v[30:31]
v_pk_add_f32 v[40:41], v[40:41], v[32:33]
v_pk_add_f32 v[42:43], v[42:43], v[34:35]
v_pk_add_f32 v[40:41], v[40:41], v[36:37]
v_pk_add_f32 v[42:43], v[42:43], v[38:39]
v_pk_add_f32 v[40:41], v[40:41], v[42:43]
v_add_f32 v40, v40, v41
s_nop 1
v_add_f32_dpp v40, v40, v40 row_ror:8 row_mask:0xf bank_mask:0xf
s_nop 1
v_add_f32_dpp v40, v40, v40 row_ror:4 row_mask:0xf bank_mask:0xf
s_nop 1
v_add_f32_dpp v40, v40, v40 row_ror:2 row_mask:0xf bank_mask:0xf
s_nop 1
v_add_f32_dpp v40, v40, v40 row_ror:1 row_mask:0xf bank_mask:0xf
v_mov_b32 v41, v40
s_nop 1
v_permlane16_swap_b32 v40, v41
v_add_f32 v40, v40, v41
v_mul_f32 v40, 0x3acccccd, v40
v_mov_b32 v41, v40
v_pk_add_f32 v[48:49], v[20:21], v[40:41] neg_lo:[0,1] neg_hi:[0,1]
v_pk_add_f32 v[50:51], v[22:23], v[40:41] neg_lo:[0,1] neg_hi:[0,1]
v_pk_add_f32 v[52:53], v[24:25], v[40:41] neg_lo:[0,1] neg_hi:[0,1]
v_pk_add_f32 v[54:55], v[26:27], v[40:41] neg_lo:[0,1] neg_hi:[0,1]
v_pk_add_f32 v[56:57], v[28:29], v[40:41] neg_lo:[0,1] neg_hi:[0,1]
v_pk_add_f32 v[58:59], v[30:31], v[40:41] neg_lo:[0,1] neg_hi:[0,1]
v_pk_add_f32 v[60:61], v[32:33], v[40:41] neg_lo:[0,1] neg_hi:[0,1]
v_pk_add_f32 v[62:63], v[34:35], v[40:41] neg_lo:[0,1] neg_hi:[0,1]
v_pk_add_f32 v[64:65], v[36:37], v[40:41] neg_lo:[0,1] neg_hi:[0,1]
v_pk_add_f32 v[66:67], v[38:39], v[40:41] neg_lo:[0,1] neg_hi:[0,1]
v_pk_mul_f32 v[42:43], v[48:49], v[48:49]
v_pk_mul_f32 v[44:45], v[50:51], v[50:51]
v_pk_fma_f32 v[42:43], v[52:53], v[52:53], v[42:43]
v_pk_fma_f32 v[44:45], v[54:55], v[54:55], v[44:45]
v_pk_fma_f32 v[42:43], v[56:57], v[56:57], v[42:43]
v_pk_fma_f32 v[44:45], v[58:59], v[58:59], v[44:45]
v_pk_fma_f32 v[42:43], v[60:61], v[60:61], v[42:43]
v_pk_fma_f32 v[44:45], v[62:63], v[62:63], v[44:45]
v_pk_fma_f32 v[42:43], v[64:65], v[64:65], v[42:43]
v_pk_fma_f32 v[44:45], v[66:67], v[66:67], v[44:45]
v_pk_add_f32 v[42:43], v[42:43], v[44:45]
v_add_f32 v42, v42, v43
s_nop 1
v_add_f32_dpp v42, v42, v42 row_ror:8 row_mask:0xf bank_mask:0xf
s_nop 1
v_add_f32_dpp v42, v42, v42 row_ror:4 row_mask:0xf bank_mask:0xf
s_nop 1
v_add_f32_dpp v42, v42, v42 row_ror:2 row_mask:0xf bank_mask:0xf
s_nop 1
v_add_f32_dpp v42, v42, v42 row_ror:1 row_mask:0xf bank_mask:0xf
v_mov_b32 v43, v42
s_nop 1
v_permlane16_swap_b32 v42, v43
v_add_f32 v42, v42, v43
v_mul_f32 v42, 0x3acccccd, v42
v_cvt_pk_bf16_f32 v42, v42, v40
v_and_b32 v40, 0xffff0000, v42
v_lshlrev_b32 v42, 16, v42
v_mov_b32 v41, v40
v_add_f32 v42, 0x3727c5ac, v42
v_cvt_pk_bf16_f32 v42, v42, v42
v_and_b32 v42, 0xffff0000, v42
v_sqrt_f32 v42, v42
s_nop 0
v_cvt_pk_bf16_f32 v42, v42, v42
v_and_b32 v42, 0xffff0000, v42
v_rcp_f32 v42, v42
s_nop 0
v_mov_b32 v43, v42
v_pk_add_f32 v[48:49], v[20:21], v[40:41] neg_lo:[0,1] neg_hi:[0,1]
v_pk_add_f32 v[50:51], v[22:23], v[40:41] neg_lo:[0,1] neg_hi:[0,1]
v_pk_add_f32 v[52:53], v[24:25], v[40:41] neg_lo:[0,1] neg_hi:[0,1]
v_pk_add_f32 v[54:55], v[26:27], v[40:41] neg_lo:[0,1] neg_hi:[0,1]
v_pk_add_f32 v[56:57], v[28:29], v[40:41] neg_lo:[0,1] neg_hi:[0,1]
v_pk_add_f32 v[58:59], v[30:31], v[40:41] neg_lo:[0,1] neg_hi:[0,1]
v_pk_add_f32 v[60:61], v[32:33], v[40:41] neg_lo:[0,1] neg_hi:[0,1]
v_pk_add_f32 v[62:63], v[34:35], v[40:41] neg_lo:[0,1] neg_hi:[0,1]
v_pk_add_f32 v[64:65], v[36:37], v[40:41] neg_lo:[0,1] neg_hi:[0,1]
v_pk_add_f32 v[66:67], v[38:39], v[40:41] neg_lo:[0,1] neg_hi:[0,1]
v_cvt_pk_bf16_f32 v68, v48, v49
v_cvt_pk_bf16_f32 v69, v50, v51
v_cvt_pk_bf16_f32 v70, v52, v53
v_cvt_pk_bf16_f32 v71, v54, v55
v_cvt_pk_bf16_f32 v72, v56, v57
v_cvt_pk_bf16_f32 v73, v58, v59
v_cvt_pk_bf16_f32 v74, v60, v61
v_cvt_pk_bf16_f32 v75, v62, v63
v_cvt_pk_bf16_f32 v76, v64, v65
v_cvt_pk_bf16_f32 v77, v66, v67
v_lshlrev_b32 v48, 16, v68
v_and_b32 v49, 0xffff0000, v68
v_lshlrev_b32 v50, 16, v69
v_and_b32 v51, 0xffff0000, v69
v_lshlrev_b32 v52, 16, v70
v_and_b32 v53, 0xffff0000, v70
v_lshlrev_b32 v54, 16, v71
v_and_b32 v55, 0xffff0000, v71
v_lshlrev_b32 v56, 16, v72
v_and_b32 v57, 0xffff0000, v72
v_lshlrev_b32 v58, 16, v73
v_and_b32 v59, 0xffff0000, v73
v_lshlrev_b32 v60, 16, v74
v_and_b32 v61, 0xffff0000, v74
v_lshlrev_b32 v62, 16, v75
v_and_b32 v63, 0xffff0000, v75
v_lshlrev_b32 v64, 16, v76
v_and_b32 v65, 0xffff0000, v76
v_lshlrev_b32 v66, 16, v77
v_and_b32 v67, 0xffff0000, v77
v_pk_mul_f32 v[48:49], v[48:49], v[42:43]
v_pk_mul_f32 v[50:51], v[50:51], v[42:43]
v_pk_mul_f32 v[52:53], v[52:53], v[42:43]
v_pk_mul_f32 v[54:55], v[54:55], v[42:43]
v_pk_mul_f32 v[56:57], v[56:57], v[42:43]
v_pk_mul_f32 v[58:59], v[58:59], v[42:43]
v_pk_mul_f32 v[60:61], v[60:61], v[42:43]
v_pk_mul_f32 v[62:63], v[62:63], v[42:43]
v_pk_mul_f32 v[64:65], v[64:65], v[42:43]
v_pk_mul_f32 v[66:67], v[66:67], v[42:43]
v_cvt_pk_bf16_f32 v48, v48, v20
v_cvt_pk_bf16_f32 v49, v49, v21
v_cvt_pk_bf16_f32 v50, v50, v22
v_cvt_pk_bf16_f32 v51, v51, v23
v_cvt_pk_bf16_f32 v52, v52, v24
v_cvt_pk_bf16_f32 v53, v53, v25
v_cvt_pk_bf16_f32 v54, v54, v26
v_cvt_pk_bf16_f32 v55, v55, v27
v_cvt_pk_bf16_f32 v56, v56, v28
v_cvt_pk_bf16_f32 v57, v57, v29
v_cvt_pk_bf16_f32 v58, v58, v30
v_cvt_pk_bf16_f32 v59, v59, v31
v_cvt_pk_bf16_f32 v60, v60, v32
v_cvt_pk_bf16_f32 v61, v61, v33
v_cvt_pk_bf16_f32 v62, v62, v34
v_cvt_pk_bf16_f32 v63, v63, v35
v_cvt_pk_bf16_f32 v64, v64, v36
v_cvt_pk_bf16_f32 v65, v65, v37
v_cvt_pk_bf16_f32 v66, v66, v38
v_cvt_pk_bf16_f32 v67, v67, v39
ds_write_b128 v6, v[48:51] offset:0
ds_write_b128 v6, v[52:55] offset:512
ds_write_b128 v6, v[56:59] offset:1024
ds_write_b128 v6, v[60:63] offset:1536
ds_write_b128 v6, v[64:67] offset:2048
v_bfe_u32 v7, v2, 2, 2
v_mul_u32_u24 v7, 2624, v7
v_lshrrev_b32 v6, 4, v2
v_lshl_add_u32 v7, v6, 5, v7
v_and_b32 v6, 3, v2
v_lshl_add_u32 v7, v6, 3, v7
s_lshl_b32 s3, s4, 7
v_add_u32 v7, s3, v7
v_lshlrev_b32 v6, 4, v2
s_lshl_b32 s3, s4, 10
v_add_u32 v6, s3, v6
s_mul_i32 s3, s82, 20480
s_mov_b32 s80, 0
s_waitcnt lgkmcnt(0)
s_barrier
Llns_5:
ds_read_b64_tr_b16 v[68:69], v7 offset:0
ds_read_b64_tr_b16 v[70:71], v7 offset:10496
ds_read_b64_tr_b16 v[72:73], v7 offset:512
ds_read_b64_tr_b16 v[74:75], v7 offset:11008
ds_read_b64_tr_b16 v[76:77], v7 offset:1024
ds_read_b64_tr_b16 v[78:79], v7 offset:11520
ds_read_b64_tr_b16 v[80:81], v7 offset:1536
ds_read_b64_tr_b16 v[82:83], v7 offset:12032
ds_read_b64_tr_b16 v[84:85], v7 offset:2048
ds_read_b64_tr_b16 v[86:87], v7 offset:12544
s_mov_b32 s5, s3
s_waitcnt lgkmcnt(8)
buffer_store_dwordx4 v[68:71], v6, s[12:15], s5 offen sc1
s_add_u32 s5, s5, 4096
s_waitcnt lgkmcnt(6)
buffer_store_dwordx4 v[72:75], v6, s[12:15], s5 offen sc1
s_add_u32 s5, s5, 4096
s_waitcnt lgkmcnt(4)
buffer_store_dwordx4 v[76:79], v6, s[12:15], s5 offen sc1
s_add_u32 s5, s5, 4096
s_waitcnt lgkmcnt(2)
buffer_store_dwordx4 v[80:83], v6, s[12:15], s5 offen sc1
s_add_u32 s5, s5, 4096
s_waitcnt lgkmcnt(0)
buffer_store_dwordx4 v[84:87], v6, s[12:15], s5 offen sc1
s_mul_i32 s61, s4, 30272
v_lshlrev_b32 v90, 3, v2
v_sub_u32 v90, 2047, v90
s_add_u32 s6, s61, 16640
s_movk_i32 s7, 0x80
v_subrev_u32 v91, 512, v90
v_cvt_f32_i32 v93, v91
v_subrev_u32 v92, 513, v90
v_cvt_f32_i32 v94, v92
v_cvt_pk_bf16_f32 v93, v93, v94
v_lshrrev_b32 v94, 16, v93
v_and_b32 v93, 0xffff, v93
v_subrev_u32 v93, 0x4280, v93
v_med3_i32 v93, v93, v91, s7
v_lshl_add_u32 v111, v93, 1, s6
v_subrev_u32 v94, 0x4280, v94
v_med3_i32 v94, v94, v92, s7
v_lshl_add_u32 v112, v94, 1, s6
v_subrev_u32 v91, 514, v90
v_cvt_f32_i32 v93, v91
v_subrev_u32 v92, 515, v90
v_cvt_f32_i32 v94, v92
v_cvt_pk_bf16_f32 v93, v93, v94
v_lshrrev_b32 v94, 16, v93
v_and_b32 v93, 0xffff, v93
v_subrev_u32 v93, 0x4280, v93
v_med3_i32 v93, v93, v91, s7
v_lshl_add_u32 v113, v93, 1, s6
v_subrev_u32 v94, 0x4280, v94
v_med3_i32 v94, v94, v92, s7
v_lshl_add_u32 v114, v94, 1, s6
v_subrev_u32 v91, 516, v90
v_cvt_f32_i32 v93, v91
v_subrev_u32 v92, 517, v90
v_cvt_f32_i32 v94, v92
v_cvt_pk_bf16_f32 v93, v93, v94
v_lshrrev_b32 v94, 16, v93
v_and_b32 v93, 0xffff, v93
v_subrev_u32 v93, 0x4280, v93
v_med3_i32 v93, v93, v91, s7
v_lshl_add_u32 v115, v93, 1, s6
v_subrev_u32 v94, 0x4280, v94
v_med3_i32 v94, v94, v92, s7
v_lshl_add_u32 v116, v94, 1, s6
v_subrev_u32 v91, 518, v90
v_cvt_f32_i32 v93, v91
v_subrev_u32 v92, 519, v90
v_cvt_f32_i32 v94, v92
v_cvt_pk_bf16_f32 v93, v93, v94
v_lshrrev_b32 v94, 16, v93
v_and_b32 v93, 0xffff, v93
v_subrev_u32 v93, 0x4280, v93
v_med3_i32 v93, v93, v91, s7
v_lshl_add_u32 v117, v93, 1, s6
v_subrev_u32 v94, 0x4280, v94
v_med3_i32 v94, v94, v92, s7
v_lshl_add_u32 v118, v94, 1, s6
v_subrev_u32 v91, 520, v90
v_cvt_f32_i32 v93, v91
v_subrev_u32 v92, 521, v90
v_cvt_f32_i32 v94, v92
v_cvt_pk_bf16_f32 v93, v93, v94
v_lshrrev_b32 v94, 16, v93
v_and_b32 v93, 0xffff, v93
v_subrev_u32 v93, 0x4280, v93
v_med3_i32 v93, v93, v91, s7
v_lshl_add_u32 v119, v93, 1, s6
v_subrev_u32 v94, 0x4280, v94
v_med3_i32 v94, v94, v92, s7
v_lshl_add_u32 v120, v94, 1, s6
v_subrev_u32 v91, 522, v90
v_cvt_f32_i32 v93, v91
v_cvt_pk_bf16_f32 v93, v93, v93
v_and_b32 v93, 0xffff, v93
v_subrev_u32 v93, 0x4280, v93
v_med3_i32 v93, v93, v91, s7
v_lshl_add_u32 v121, v93, 1, s6
v_subrev_u32 v91, 1024, v90
v_cvt_f32_i32 v93, v91
v_subrev_u32 v92, 1025, v90
v_cvt_f32_i32 v94, v92
v_cvt_pk_bf16_f32 v93, v93, v94
v_lshrrev_b32 v94, 16, v93
v_and_b32 v93, 0xffff, v93
v_subrev_u32 v93, 0x4280, v93
v_med3_i32 v93, v93, v91, s7
v_lshl_add_u32 v122, v93, 1, s6
v_subrev_u32 v94, 0x4280, v94
v_med3_i32 v94, v94, v92, s7
v_lshl_add_u32 v123, v94, 1, s6
v_subrev_u32 v91, 1026, v90
v_cvt_f32_i32 v93, v91
v_subrev_u32 v92, 1027, v90
v_cvt_f32_i32 v94, v92
v_cvt_pk_bf16_f32 v93, v93, v94
v_lshrrev_b32 v94, 16, v93
v_and_b32 v93, 0xffff, v93
v_subrev_u32 v93, 0x4280, v93
v_med3_i32 v93, v93, v91, s7
v_lshl_add_u32 v124, v93, 1, s6
v_subrev_u32 v94, 0x4280, v94
v_med3_i32 v94, v94, v92, s7
v_lshl_add_u32 v125, v94, 1, s6
v_subrev_u32 v91, 1028, v90
v_cvt_f32_i32 v93, v91
v_subrev_u32 v92, 1029, v90
v_cvt_f32_i32 v94, v92
v_cvt_pk_bf16_f32 v93, v93, v94
v_lshrrev_b32 v94, 16, v93
v_and_b32 v93, 0xffff, v93
v_subrev_u32 v93, 0x4280, v93
v_med3_i32 v93, v93, v91, s7
v_lshl_add_u32 v126, v93, 1, s6
v_subrev_u32 v94, 0x4280, v94
v_med3_i32 v94, v94, v92, s7
v_lshl_add_u32 v127, v94, 1, s6
v_subrev_u32 v91, 1030, v90
v_cvt_f32_i32 v93, v91
v_subrev_u32 v92, 1031, v90
v_cvt_f32_i32 v94, v92
v_cvt_pk_bf16_f32 v93, v93, v94
v_lshrrev_b32 v94, 16, v93
v_and_b32 v93, 0xffff, v93
v_subrev_u32 v93, 0x4280, v93
v_med3_i32 v93, v93, v91, s7
v_lshl_add_u32 v128, v93, 1, s6
v_subrev_u32 v94, 0x4280, v94
v_med3_i32 v94, v94, v92, s7
v_lshl_add_u32 v129, v94, 1, s6
v_subrev_u32 v91, 1032, v90
v_cvt_f32_i32 v93, v91
v_subrev_u32 v92, 1033, v90
v_cvt_f32_i32 v94, v92
v_cvt_pk_bf16_f32 v93, v93, v94
v_lshrrev_b32 v94, 16, v93
v_and_b32 v93, 0xffff, v93
v_subrev_u32 v93, 0x4280, v93
v_med3_i32 v93, v93, v91, s7
v_lshl_add_u32 v130, v93, 1, s6
v_subrev_u32 v94, 0x4280, v94
v_med3_i32 v94, v94, v92, s7
v_lshl_add_u32 v131, v94, 1, s6
v_subrev_u32 v91, 1034, v90
v_cvt_f32_i32 v93, v91
v_cvt_pk_bf16_f32 v93, v93, v93
v_and_b32 v93, 0xffff, v93
v_subrev_u32 v93, 0x4280, v93
v_med3_i32 v93, v93, v91, s7
v_lshl_add_u32 v132, v93, 1, s6
v_subrev_u32 v91, 1536, v90
v_cvt_f32_i32 v93, v91
v_subrev_u32 v92, 1537, v90
v_cvt_f32_i32 v94, v92
v_cvt_pk_bf16_f32 v93, v93, v94
v_lshrrev_b32 v94, 16, v93
v_and_b32 v93, 0xffff, v93
v_subrev_u32 v93, 0x4280, v93
v_med3_i32 v93, v93, v91, s7
v_lshl_add_u32 v133, v93, 1, s6
v_subrev_u32 v94, 0x4280, v94
v_med3_i32 v94, v94, v92, s7
v_lshl_add_u32 v134, v94, 1, s6
v_subrev_u32 v91, 1538, v90
v_cvt_f32_i32 v93, v91
v_subrev_u32 v92, 1539, v90
v_cvt_f32_i32 v94, v92
v_cvt_pk_bf16_f32 v93, v93, v94
v_lshrrev_b32 v94, 16, v93
v_and_b32 v93, 0xffff, v93
v_subrev_u32 v93, 0x4280, v93
v_med3_i32 v93, v93, v91, s7
v_lshl_add_u32 v135, v93, 1, s6
v_subrev_u32 v94, 0x4280, v94
v_med3_i32 v94, v94, v92, s7
v_lshl_add_u32 v136, v94, 1, s6
v_subrev_u32 v91, 1540, v90
v_cvt_f32_i32 v93, v91
v_subrev_u32 v92, 1541, v90
v_cvt_f32_i32 v94, v92
v_cvt_pk_bf16_f32 v93, v93, v94
v_lshrrev_b32 v94, 16, v93
v_and_b32 v93, 0xffff, v93
v_subrev_u32 v93, 0x4280, v93
v_med3_i32 v93, v93, v91, s7
v_lshl_add_u32 v137, v93, 1, s6
v_subrev_u32 v94, 0x4280, v94
v_med3_i32 v94, v94, v92, s7
v_lshl_add_u32 v138, v94, 1, s6
v_subrev_u32 v91, 1542, v90
v_cvt_f32_i32 v93, v91
v_subrev_u32 v92, 1543, v90
v_cvt_f32_i32 v94, v92
v_cvt_pk_bf16_f32 v93, v93, v94
v_lshrrev_b32 v94, 16, v93
v_and_b32 v93, 0xffff, v93
v_subrev_u32 v93, 0x4280, v93
v_med3_i32 v93, v93, v91, s7
v_lshl_add_u32 v139, v93, 1, s6
v_subrev_u32 v94, 0x4280, v94
v_med3_i32 v94, v94, v92, s7
v_lshl_add_u32 v140, v94, 1, s6
v_subrev_u32 v91, 1544, v90
v_cvt_f32_i32 v93, v91
v_subrev_u32 v92, 1545, v90
v_cvt_f32_i32 v94, v92
v_cvt_pk_bf16_f32 v93, v93, v94
v_lshrrev_b32 v94, 16, v93
v_and_b32 v93, 0xffff, v93
v_subrev_u32 v93, 0x4280, v93
v_med3_i32 v93, v93, v91, s7
v_lshl_add_u32 v141, v93, 1, s6
v_subrev_u32 v94, 0x4280, v94
v_med3_i32 v94, v94, v92, s7
v_lshl_add_u32 v142, v94, 1, s6
v_subrev_u32 v91, 1546, v90
v_cvt_f32_i32 v93, v91
v_cvt_pk_bf16_f32 v93, v93, v93
v_and_b32 v93, 0xffff, v93
v_subrev_u32 v93, 0x4280, v93
v_med3_i32 v93, v93, v91, s7
v_lshl_add_u32 v143, v93, 1, s6
v_and_b32 v90, 15, v2
v_lshrrev_b32 v91, 4, v2
v_and_b32 v92, 3, v90
v_sub_u32 v92, 3, v92
v_mul_u32_u24 v92, 4160, v92
v_lshrrev_b32 v93, 2, v90
v_lshlrev_b32 v93, 3, v93
v_sub_u32 v92, v92, v93
v_lshl_add_u32 v92, v91, 4, v92
s_add_u32 s6, s61, 24
v_add_u32 v152, s6, v92
v_lshlrev_b32 v92, 1, v90
v_add_u32 v92, v92, v91
v_lshlrev_b32 v92, 7, v92
v_lshrrev_b32 v93, 1, v91
v_add_u32 v93, v93, v90
s_lshl_b32 s7, s4, 1
v_subrev_u32 v94, 1, v93
v_and_b32 v94, 7, v94
v_xor_b32 v94, s7, v94
v_lshl_add_u32 v94, v94, 4, v92
v_add_u32 v144, 124928, v94
v_subrev_u32 v94, 3, v93
v_and_b32 v94, 7, v94
v_xor_b32 v94, s7, v94
v_lshl_add_u32 v94, v94, 4, v92
v_add_u32 v145, 124416, v94
v_subrev_u32 v94, 5, v93
v_and_b32 v94, 7, v94
v_xor_b32 v94, s7, v94
v_lshl_add_u32 v94, v94, 4, v92
v_add_u32 v146, 123904, v94
v_subrev_u32 v94, 7, v93
v_and_b32 v94, 7, v94
v_xor_b32 v94, s7, v94
v_lshl_add_u32 v94, v94, 4, v92
v_add_u32 v147, 123392, v94
v_subrev_u32 v94, 9, v93
v_and_b32 v94, 7, v94
v_xor_b32 v94, s7, v94
v_lshl_add_u32 v94, v94, 4, v92
v_add_u32 v148, 122880, v94
v_subrev_u32 v94, 11, v93
v_and_b32 v94, 7, v94
v_xor_b32 v94, s7, v94
v_lshl_add_u32 v94, v94, 4, v92
v_add_u32 v149, 122368, v94
v_subrev_u32 v94, 13, v93
v_and_b32 v94, 7, v94
v_xor_b32 v94, s7, v94
v_lshl_add_u32 v94, v94, 4, v92
v_add_u32 v150, 121856, v94
v_subrev_u32 v94, 15, v93
v_and_b32 v94, 7, v94
v_xor_b32 v94, s7, v94
v_lshl_add_u32 v94, v94, 4, v92
v_add_u32 v151, 121344, v94
v_lshlrev_b32 v92, 1, v90
v_lshrrev_b32 v93, 1, v91
v_add_u32 v92, v92, v93
v_lshlrev_b32 v92, 7, v92
v_and_b32 v93, 7, v90
v_xor_b32 v93, s7, v93
v_lshl_add_u32 v92, v93, 4, v92
v_and_b32 v93, 1, v91
v_lshl_add_u32 v92, v93, 3, v92
v_add_u32 v153, 125184, v92
v_lshlrev_b32 v92, 5, v90
v_lshl_add_u32 v92, v91, 3, v92
v_add_u32 v154, s61, v92
s_waitcnt vmcnt(12)
v_readfirstlane_b32 s83, v96
s_nop 0
s_add_u32 s83, s83, 1
s_waitcnt vmcnt(0) lgkmcnt(0)
s_barrier
s_cmp_eq_u32 s4, 0
s_cbranch_scc0 Lsig_6
v_lshlrev_b32 v5, 10, v2
s_lshl_b32 s5, s2, 2
s_add_u32 s5, s5, 33558528
v_mov_b32 v4, s83
s_mov_b64 exec, 0xff
buffer_store_dword v4, v5, s[12:15], s5 offen sc1
s_mov_b64 exec, -1
Lsig_6:
v_mov_b32 v12, 0
v_mov_b32 v13, 0
v_mov_b32 v14, 0
v_mov_b32 v15, 0
v_lshlrev_b32 v10, 4, v0
v_add_u32 v10, 121088, v10
ds_write_b128 v10, v[12:15]
s_mov_b32 s62, 0x3fb8aa3b
s_mov_b32 s63, 0x32a57060
s_mov_b32 s64, 0x3f317218
s_mov_b32 s65, 0x3e22f983
s_waitcnt vmcnt(0)
v_lshlrev_b32 v4, 16, v160
v_mul_f32 v5, s62, v4
v_fma_f32 v6, v4, s62, -v5
v_fma_f32 v6, v4, s63, v6
v_exp_f32 v10, v5
s_nop 0
v_mul_f32 v6, v10, v6
v_fma_f32 v10, v6, s64, v10
v_cvt_pk_bf16_f32 v10, v10, v10
v_and_b32 v10, 0xffff0000, v10
v_lshlrev_b32 v4, 16, v156
v_mul_f32 v5, s62, v4
v_fma_f32 v6, v4, s62, -v5
v_fma_f32 v6, v4, s63, v6
v_exp_f32 v7, v5
s_nop 0
v_mul_f32 v6, v7, v6
v_fma_f32 v7, v6, s64, v7
v_cvt_pk_bf16_f32 v7, v7, v7
v_and_b32 v7, 0xffff0000, v7
v_mul_f32 v7, v7, v10
v_mul_f32 v12, s62, v7
v_sub_f32 v12, 0, v12
v_lshlrev_b32 v4, 16, v157
v_mul_f32 v4, v4, v10
v_mul_f32 v14, s65, v4
v_lshlrev_b32 v4, 16, v158
v_mul_f32 v4, v4, v10
v_add_f32 v16, v4, v4
v_lshlrev_b32 v4, 16, v159
v_mul_f32 v4, v4, v10
v_add_f32 v17, v4, v4
v_and_b32 v4, 0xffff0000, v156
v_mul_f32 v5, s62, v4
v_fma_f32 v6, v4, s62, -v5
v_fma_f32 v6, v4, s63, v6
v_exp_f32 v7, v5
s_nop 0
v_mul_f32 v6, v7, v6
v_fma_f32 v7, v6, s64, v7
v_cvt_pk_bf16_f32 v7, v7, v7
v_and_b32 v7, 0xffff0000, v7
v_mul_f32 v7, v7, v10
v_mul_f32 v13, s62, v7
v_sub_f32 v13, 0, v13
v_and_b32 v4, 0xffff0000, v157
v_mul_f32 v4, v4, v10
v_mul_f32 v15, s65, v4
v_and_b32 v4, 0xffff0000, v158
v_mul_f32 v4, v4, v10
v_add_f32 v18, v4, v4
v_and_b32 v4, 0xffff0000, v159
v_mul_f32 v4, v4, v10
v_add_f32 v19, v4, v4
v_mul_f32 v4, 0x3f800000, v12
v_mul_f32 v5, 0x3f800000, v14
v_exp_f32 v4, v4
v_rndne_f32 v6, v5
v_sub_f32 v5, v5, v6
v_cos_f32 v6, v5
v_sin_f32 v7, v5
v_mul_f32 v20, v4, v6
v_mul_f32 v21, v4, v7
v_mul_f32 v4, 0x3f800000, v13
v_mul_f32 v5, 0x3f800000, v15
v_exp_f32 v4, v4
v_rndne_f32 v6, v5
v_sub_f32 v5, v5, v6
v_cos_f32 v6, v5
v_sin_f32 v7, v5
v_mul_f32 v22, v4, v6
v_mul_f32 v23, v4, v7
v_mul_f32 v4, 0x41000000, v12
v_mul_f32 v5, 0x41000000, v14
v_exp_f32 v4, v4
v_rndne_f32 v6, v5
v_sub_f32 v5, v5, v6
v_cos_f32 v6, v5
v_sin_f32 v7, v5
v_mul_f32 v24, v4, v6
v_mul_f32 v25, v4, v7
v_mul_f32 v4, 0x41000000, v13
v_mul_f32 v5, 0x41000000, v15
v_exp_f32 v4, v4
v_rndne_f32 v6, v5
v_sub_f32 v5, v5, v6
v_cos_f32 v6, v5
v_sin_f32 v7, v5
v_mul_f32 v26, v4, v6
v_mul_f32 v27, v4, v7
v_mul_f32 v4, 0x43000000, v12
v_mul_f32 v5, 0x43000000, v14
v_exp_f32 v4, v4
v_rndne_f32 v6, v5
v_sub_f32 v5, v5, v6
v_cos_f32 v6, v5
v_sin_f32 v7, v5
v_mul_f32 v28, v4, v6
v_mul_f32 v29, v4, v7
v_mul_f32 v4, 0x43000000, v13
v_mul_f32 v5, 0x43000000, v15
v_exp_f32 v4, v4
v_rndne_f32 v6, v5
v_sub_f32 v5, v5, v6
v_cos_f32 v6, v5
v_sin_f32 v7, v5
v_mul_f32 v30, v4, v6
v_mul_f32 v31, v4, v7
v_lshlrev_b32 v11, 3, v2
v_add_u32 v11, s61, v11
v_pk_mul_f32 v[32:33], v[20:21], v[20:21] op_sel:[0,0] op_sel_hi:[0,1]
v_pk_mul_f32 v[34:35], v[22:23], v[22:23] op_sel:[0,0] op_sel_hi:[0,1]
v_pk_fma_f32 v[32:33], v[20:21], v[20:21], v[32:33] op_sel:[1,1,0] op_sel_hi:[1,0,1] neg_lo:[1,0,0]
v_pk_fma_f32 v[34:35], v[22:23], v[22:23], v[34:35] op_sel:[1,1,0] op_sel_hi:[1,0,1] neg_lo:[1,0,0]
v_pk_mul_f32 v[36:37], v[32:33], v[20:21] op_sel:[0,0] op_sel_hi:[0,1]
v_pk_mul_f32 v[38:39], v[34:35], v[22:23] op_sel:[0,0] op_sel_hi:[0,1]
v_pk_fma_f32 v[36:37], v[32:33], v[20:21], v[36:37] op_sel:[1,1,0] op_sel_hi:[1,0,1] neg_lo:[1,0,0]
v_pk_fma_f32 v[38:39], v[34:35], v[22:23], v[38:39] op_sel:[1,1,0] op_sel_hi:[1,0,1] neg_lo:[1,0,0]
v_pk_mul_f32 v[40:41], v[32:33], v[32:33] op_sel:[0,0] op_sel_hi:[0,1]
v_pk_mul_f32 v[42:43], v[34:35], v[34:35] op_sel:[0,0] op_sel_hi:[0,1]
v_pk_fma_f32 v[40:41], v[32:33], v[32:33], v[40:41] op_sel:[1,1,0] op_sel_hi:[1,0,1] neg_lo:[1,0,0]
v_pk_fma_f32 v[42:43], v[34:35], v[34:35], v[42:43] op_sel:[1,1,0] op_sel_hi:[1,0,1] neg_lo:[1,0,0]
v_pk_mul_f32 v[44:45], v[40:41], v[20:21] op_sel:[0,0] op_sel_hi:[0,1]
v_pk_mul_f32 v[46:47], v[42:43], v[22:23] op_sel:[0,0] op_sel_hi:[0,1]
v_pk_fma_f32 v[44:45], v[40:41], v[20:21], v[44:45] op_sel:[1,1,0] op_sel_hi:[1,0,1] neg_lo:[1,0,0]
v_pk_fma_f32 v[46:47], v[42:43], v[22:23], v[46:47] op_sel:[1,1,0] op_sel_hi:[1,0,1] neg_lo:[1,0,0]
v_pk_mul_f32 v[48:49], v[40:41], v[32:33] op_sel:[0,0] op_sel_hi:[0,1]
v_pk_mul_f32 v[50:51], v[42:43], v[34:35] op_sel:[0,0] op_sel_hi:[0,1]
v_pk_fma_f32 v[48:49], v[40:41], v[32:33], v[48:49] op_sel:[1,1,0] op_sel_hi:[1,0,1] neg_lo:[1,0,0]
v_pk_fma_f32 v[50:51], v[42:43], v[34:35], v[50:51] op_sel:[1,1,0] op_sel_hi:[1,0,1] neg_lo:[1,0,0]
v_pk_mul_f32 v[52:53], v[40:41], v[36:37] op_sel:[0,0] op_sel_hi:[0,1]
v_pk_mul_f32 v[54:55], v[42:43], v[38:39] op_sel:[0,0] op_sel_hi:[0,1]
v_pk_fma_f32 v[52:53], v[40:41], v[36:37], v[52:53] op_sel:[1,1,0] op_sel_hi:[1,0,1] neg_lo:[1,0,0]
v_pk_fma_f32 v[54:55], v[42:43], v[38:39], v[54:55] op_sel:[1,1,0] op_sel_hi:[1,0,1] neg_lo:[1,0,0]
v_mov_b32 v60, 1.0
v_mov_b32 v61, 0
v_mov_b32 v62, 1.0
v_mov_b32 v63, 0
v_cvt_pk_bf16_f32 v88, v60, -v61
v_cvt_pk_bf16_f32 v89, v62, -v63
ds_write_b64 v11, v[88:89] offset:21648
v_cvt_pk_bf16_f32 v90, v24, -v25
v_cvt_pk_bf16_f32 v91, v26, -v27
ds_write_b64 v11, v[90:91] offset:22176
v_pk_mul_f32 v[64:65], v[24:25], v[24:25] op_sel:[0,0] op_sel_hi:[0,1]
v_pk_mul_f32 v[66:67], v[26:27], v[26:27] op_sel:[0,0] op_sel_hi:[0,1]
v_pk_fma_f32 v[64:65], v[24:25], v[24:25], v[64:65] op_sel:[1,1,0] op_sel_hi:[1,0,1] neg_lo:[1,0,0]
v_pk_fma_f32 v[66:67], v[26:27], v[26:27], v[66:67] op_sel:[1,1,0] op_sel_hi:[1,0,1] neg_lo:[1,0,0]
v_cvt_pk_bf16_f32 v92, v64, -v65
v_cvt_pk_bf16_f32 v93, v66, -v67
ds_write_b64 v11, v[92:93] offset:22704
v_pk_mul_f32 v[68:69], v[64:65], v[24:25] op_sel:[0,0] op_sel_hi:[0,1]
v_pk_mul_f32 v[70:71], v[66:67], v[26:27] op_sel:[0,0] op_sel_hi:[0,1]
v_pk_fma_f32 v[68:69], v[64:65], v[24:25], v[68:69] op_sel:[1,1,0] op_sel_hi:[1,0,1] neg_lo:[1,0,0]
v_pk_fma_f32 v[70:71], v[66:67], v[26:27], v[70:71] op_sel:[1,1,0] op_sel_hi:[1,0,1] neg_lo:[1,0,0]
v_cvt_pk_bf16_f32 v94, v68, -v69
v_cvt_pk_bf16_f32 v95, v70, -v71
ds_write_b64 v11, v[94:95] offset:23232
v_pk_mul_f32 v[64:65], v[68:69], v[24:25] op_sel:[0,0] op_sel_hi:[0,1]
v_pk_mul_f32 v[66:67], v[70:71], v[26:27] op_sel:[0,0] op_sel_hi:[0,1]
v_pk_fma_f32 v[64:65], v[68:69], v[24:25], v[64:65] op_sel:[1,1,0] op_sel_hi:[1,0,1] neg_lo:[1,0,0]
v_pk_fma_f32 v[66:67], v[70:71], v[26:27], v[66:67] op_sel:[1,1,0] op_sel_hi:[1,0,1] neg_lo:[1,0,0]
v_cvt_pk_bf16_f32 v88, v64, -v65
v_cvt_pk_bf16_f32 v89, v66, -v67
ds_write_b64 v11, v[88:89] offset:23760
v_pk_mul_f32 v[68:69], v[64:65], v[24:25] op_sel:[0,0] op_sel_hi:[0,1]
v_pk_mul_f32 v[70:71], v[66:67], v[26:27] op_sel:[0,0] op_sel_hi:[0,1]
v_pk_fma_f32 v[68:69], v[64:65], v[24:25], v[68:69] op_sel:[1,1,0] op_sel_hi:[1,0,1] neg_lo:[1,0,0]
v_pk_fma_f32 v[70:71], v[66:67], v[26:27], v[70:71] op_sel:[1,1,0] op_sel_hi:[1,0,1] neg_lo:[1,0,0]
v_cvt_pk_bf16_f32 v90, v68, -v69
v_cvt_pk_bf16_f32 v91, v70, -v71
ds_write_b64 v11, v[90:91] offset:24288
v_pk_mul_f32 v[64:65], v[68:69], v[24:25] op_sel:[0,0] op_sel_hi:[0,1]
v_pk_mul_f32 v[66:67], v[70:71], v[26:27] op_sel:[0,0] op_sel_hi:[0,1]
v_pk_fma_f32 v[64:65], v[68:69], v[24:25], v[64:65] op_sel:[1,1,0] op_sel_hi:[1,0,1] neg_lo:[1,0,0]
v_pk_fma_f32 v[66:67], v[70:71], v[26:27], v[66:67] op_sel:[1,1,0] op_sel_hi:[1,0,1] neg_lo:[1,0,0]
v_cvt_pk_bf16_f32 v92, v64, -v65
v_cvt_pk_bf16_f32 v93, v66, -v67
ds_write_b64 v11, v[92:93] offset:24816
v_pk_mul_f32 v[68:69], v[64:65], v[24:25] op_sel:[0,0] op_sel_hi:[0,1]
v_pk_mul_f32 v[70:71], v[66:67], v[26:27] op_sel:[0,0] op_sel_hi:[0,1]
v_pk_fma_f32 v[68:69], v[64:65], v[24:25], v[68:69] op_sel:[1,1,0] op_sel_hi:[1,0,1] neg_lo:[1,0,0]
v_pk_fma_f32 v[70:71], v[66:67], v[26:27], v[70:71] op_sel:[1,1,0] op_sel_hi:[1,0,1] neg_lo:[1,0,0]
v_cvt_pk_bf16_f32 v94, v68, -v69
v_cvt_pk_bf16_f32 v95, v70, -v71
ds_write_b64 v11, v[94:95] offset:25344
v_pk_mul_f32 v[64:65], v[68:69], v[24:25] op_sel:[0,0] op_sel_hi:[0,1]
v_pk_mul_f32 v[66:67], v[70:71], v[26:27] op_sel:[0,0] op_sel_hi:[0,1]
v_pk_fma_f32 v[64:65], v[68:69], v[24:25], v[64:65] op_sel:[1,1,0] op_sel_hi:[1,0,1] neg_lo:[1,0,0]
v_pk_fma_f32 v[66:67], v[70:71], v[26:27], v[66:67] op_sel:[1,1,0] op_sel_hi:[1,0,1] neg_lo:[1,0,0]
v_cvt_pk_bf16_f32 v88, v64, -v65
v_cvt_pk_bf16_f32 v89, v66, -v67
ds_write_b64 v11, v[88:89] offset:25872
v_pk_mul_f32 v[68:69], v[64:65], v[24:25] op_sel:[0,0] op_sel_hi:[0,1]
v_pk_mul_f32 v[70:71], v[66:67], v[26:27] op_sel:[0,0] op_sel_hi:[0,1]
v_pk_fma_f32 v[68:69], v[64:65], v[24:25], v[68:69] op_sel:[1,1,0] op_sel_hi:[1,0,1] neg_lo:[1,0,0]
v_pk_fma_f32 v[70:71], v[66:67], v[26:27], v[70:71] op_sel:[1,1,0] op_sel_hi:[1,0,1] neg_lo:[1,0,0]
v_cvt_pk_bf16_f32 v90, v68, -v69
v_cvt_pk_bf16_f32 v91, v70, -v71
ds_write_b64 v11, v[90:91] offset:26400
v_pk_mul_f32 v[64:65], v[68:69], v[24:25] op_sel:[0,0] op_sel_hi:[0,1]
v_pk_mul_f32 v[66:67], v[70:71], v[26:27] op_sel:[0,0] op_sel_hi:[0,1]
v_pk_fma_f32 v[64:65], v[68:69], v[24:25], v[64:65] op_sel:[1,1,0] op_sel_hi:[1,0,1] neg_lo:[1,0,0]
v_pk_fma_f32 v[66:67], v[70:71], v[26:27], v[66:67] op_sel:[1,1,0] op_sel_hi:[1,0,1] neg_lo:[1,0,0]
v_cvt_pk_bf16_f32 v92, v64, -v65
v_cvt_pk_bf16_f32 v93, v66, -v67
ds_write_b64 v11, v[92:93] offset:26928
v_pk_mul_f32 v[68:69], v[64:65], v[24:25] op_sel:[0,0] op_sel_hi:[0,1]
v_pk_mul_f32 v[70:71], v[66:67], v[26:27] op_sel:[0,0] op_sel_hi:[0,1]
v_pk_fma_f32 v[68:69], v[64:65], v[24:25], v[68:69] op_sel:[1,1,0] op_sel_hi:[1,0,1] neg_lo:[1,0,0]
v_pk_fma_f32 v[70:71], v[66:67], v[26:27], v[70:71] op_sel:[1,1,0] op_sel_hi:[1,0,1] neg_lo:[1,0,0]
v_cvt_pk_bf16_f32 v94, v68, -v69
v_cvt_pk_bf16_f32 v95, v70, -v71
ds_write_b64 v11, v[94:95] offset:27456
v_pk_mul_f32 v[64:65], v[68:69], v[24:25] op_sel:[0,0] op_sel_hi:[0,1]
v_pk_mul_f32 v[66:67], v[70:71], v[26:27] op_sel:[0,0] op_sel_hi:[0,1]
v_pk_fma_f32 v[64:65], v[68:69], v[24:25], v[64:65] op_sel:[1,1,0] op_sel_hi:[1,0,1] neg_lo:[1,0,0]
v_pk_fma_f32 v[66:67], v[70:71], v[26:27], v[66:67] op_sel:[1,1,0] op_sel_hi:[1,0,1] neg_lo:[1,0,0]
v_cvt_pk_bf16_f32 v88, v64, -v65
v_cvt_pk_bf16_f32 v89, v66, -v67
ds_write_b64 v11, v[88:89] offset:27984
v_pk_mul_f32 v[68:69], v[64:65], v[24:25] op_sel:[0,0] op_sel_hi:[0,1]
v_pk_mul_f32 v[70:71], v[66:67], v[26:27] op_sel:[0,0] op_sel_hi:[0,1]
v_pk_fma_f32 v[68:69], v[64:65], v[24:25], v[68:69] op_sel:[1,1,0] op_sel_hi:[1,0,1] neg_lo:[1,0,0]
v_pk_fma_f32 v[70:71], v[66:67], v[26:27], v[70:71] op_sel:[1,1,0] op_sel_hi:[1,0,1] neg_lo:[1,0,0]
v_cvt_pk_bf16_f32 v90, v68, -v69
v_cvt_pk_bf16_f32 v91, v70, -v71
ds_write_b64 v11, v[90:91] offset:28512
v_pk_mul_f32 v[64:65], v[68:69], v[24:25] op_sel:[0,0] op_sel_hi:[0,1]
v_pk_mul_f32 v[66:67], v[70:71], v[26:27] op_sel:[0,0] op_sel_hi:[0,1]
v_pk_fma_f32 v[64:65], v[68:69], v[24:25], v[64:65] op_sel:[1,1,0] op_sel_hi:[1,0,1] neg_lo:[1,0,0]
v_pk_fma_f32 v[66:67], v[70:71], v[26:27], v[66:67] op_sel:[1,1,0] op_sel_hi:[1,0,1] neg_lo:[1,0,0]
v_cvt_pk_bf16_f32 v92, v64, -v65
v_cvt_pk_bf16_f32 v93, v66, -v67
ds_write_b64 v11, v[92:93] offset:29040
v_pk_mul_f32 v[68:69], v[64:65], v[24:25] op_sel:[0,0] op_sel_hi:[0,1]
v_pk_mul_f32 v[70:71], v[66:67], v[26:27] op_sel:[0,0] op_sel_hi:[0,1]
v_pk_fma_f32 v[68:69], v[64:65], v[24:25], v[68:69] op_sel:[1,1,0] op_sel_hi:[1,0,1] neg_lo:[1,0,0]
v_pk_fma_f32 v[70:71], v[66:67], v[26:27], v[70:71] op_sel:[1,1,0] op_sel_hi:[1,0,1] neg_lo:[1,0,0]
v_cvt_pk_bf16_f32 v94, v68, -v69
v_cvt_pk_bf16_f32 v95, v70, -v71
ds_write_b64 v11, v[94:95] offset:29568
v_cvt_pk_bf16_f32 v88, v16, v17
v_cvt_pk_bf16_f32 v89, v18, v19
ds_write_b64 v11, v[88:89] offset:0
v_pk_mul_f32 v[80:81], v[16:17], v[20:21] op_sel:[0,0] op_sel_hi:[0,1]
v_pk_mul_f32 v[82:83], v[18:19], v[22:23] op_sel:[0,0] op_sel_hi:[0,1]
v_pk_fma_f32 v[80:81], v[16:17], v[20:21], v[80:81] op_sel:[1,1,0] op_sel_hi:[1,0,1] neg_lo:[1,0,0]
v_pk_fma_f32 v[82:83], v[18:19], v[22:23], v[82:83] op_sel:[1,1,0] op_sel_hi:[1,0,1] neg_lo:[1,0,0]
v_cvt_pk_bf16_f32 v90, v80, v81
v_cvt_pk_bf16_f32 v91, v82, v83
ds_write_b64 v11, v[90:91] offset:528
v_pk_mul_f32 v[84:85], v[16:17], v[32:33] op_sel:[0,0] op_sel_hi:[0,1]
v_pk_mul_f32 v[86:87], v[18:19], v[34:35] op_sel:[0,0] op_sel_hi:[0,1]
v_pk_fma_f32 v[84:85], v[16:17], v[32:33], v[84:85] op_sel:[1,1,0] op_sel_hi:[1,0,1] neg_lo:[1,0,0]
v_pk_fma_f32 v[86:87], v[18:19], v[34:35], v[86:87] op_sel:[1,1,0] op_sel_hi:[1,0,1] neg_lo:[1,0,0]
v_cvt_pk_bf16_f32 v92, v84, v85
v_cvt_pk_bf16_f32 v93, v86, v87
ds_write_b64 v11, v[92:93] offset:1056
v_pk_mul_f32 v[80:81], v[16:17], v[36:37] op_sel:[0,0] op_sel_hi:[0,1]
v_pk_mul_f32 v[82:83], v[18:19], v[38:39] op_sel:[0,0] op_sel_hi:[0,1]
v_pk_fma_f32 v[80:81], v[16:17], v[36:37], v[80:81] op_sel:[1,1,0] op_sel_hi:[1,0,1] neg_lo:[1,0,0]
v_pk_fma_f32 v[82:83], v[18:19], v[38:39], v[82:83] op_sel:[1,1,0] op_sel_hi:[1,0,1] neg_lo:[1,0,0]
v_cvt_pk_bf16_f32 v94, v80, v81
v_cvt_pk_bf16_f32 v95, v82, v83
ds_write_b64 v11, v[94:95] offset:1584
v_pk_mul_f32 v[84:85], v[16:17], v[40:41] op_sel:[0,0] op_sel_hi:[0,1]
v_pk_mul_f32 v[86:87], v[18:19], v[42:43] op_sel:[0,0] op_sel_hi:[0,1]
v_pk_fma_f32 v[84:85], v[16:17], v[40:41], v[84:85] op_sel:[1,1,0] op_sel_hi:[1,0,1] neg_lo:[1,0,0]
v_pk_fma_f32 v[86:87], v[18:19], v[42:43], v[86:87] op_sel:[1,1,0] op_sel_hi:[1,0,1] neg_lo:[1,0,0]
v_cvt_pk_bf16_f32 v88, v84, v85
v_cvt_pk_bf16_f32 v89, v86, v87
ds_write_b64 v11, v[88:89] offset:2112
v_pk_mul_f32 v[80:81], v[16:17], v[44:45] op_sel:[0,0] op_sel_hi:[0,1]
v_pk_mul_f32 v[82:83], v[18:19], v[46:47] op_sel:[0,0] op_sel_hi:[0,1]
v_pk_fma_f32 v[80:81], v[16:17], v[44:45], v[80:81] op_sel:[1,1,0] op_sel_hi:[1,0,1] neg_lo:[1,0,0]
v_pk_fma_f32 v[82:83], v[18:19], v[46:47], v[82:83] op_sel:[1,1,0] op_sel_hi:[1,0,1] neg_lo:[1,0,0]
v_cvt_pk_bf16_f32 v90, v80, v81
v_cvt_pk_bf16_f32 v91, v82, v83
ds_write_b64 v11, v[90:91] offset:2640
v_pk_mul_f32 v[84:85], v[16:17], v[48:49] op_sel:[0,0] op_sel_hi:[0,1]
v_pk_mul_f32 v[86:87], v[18:19], v[50:51] op_sel:[0,0] op_sel_hi:[0,1]
v_pk_fma_f32 v[84:85], v[16:17], v[48:49], v[84:85] op_sel:[1,1,0] op_sel_hi:[1,0,1] neg_lo:[1,0,0]
v_pk_fma_f32 v[86:87], v[18:19], v[50:51], v[86:87] op_sel:[1,1,0] op_sel_hi:[1,0,1] neg_lo:[1,0,0]
v_cvt_pk_bf16_f32 v92, v84, v85
v_cvt_pk_bf16_f32 v93, v86, v87
ds_write_b64 v11, v[92:93] offset:3168
v_pk_mul_f32 v[80:81], v[16:17], v[52:53] op_sel:[0,0] op_sel_hi:[0,1]
v_pk_mul_f32 v[82:83], v[18:19], v[54:55] op_sel:[0,0] op_sel_hi:[0,1]
v_pk_fma_f32 v[80:81], v[16:17], v[52:53], v[80:81] op_sel:[1,1,0] op_sel_hi:[1,0,1] neg_lo:[1,0,0]
v_pk_fma_f32 v[82:83], v[18:19], v[54:55], v[82:83] op_sel:[1,1,0] op_sel_hi:[1,0,1] neg_lo:[1,0,0]
v_cvt_pk_bf16_f32 v94, v80, v81
v_cvt_pk_bf16_f32 v95, v82, v83
ds_write_b64 v11, v[94:95] offset:3696
v_pk_mul_f32 v[76:77], v[16:17], v[28:29] op_sel:[0,0] op_sel_hi:[0,1]
v_pk_mul_f32 v[78:79], v[18:19], v[30:31] op_sel:[0,0] op_sel_hi:[0,1]
v_pk_fma_f32 v[76:77], v[16:17], v[28:29], v[76:77] op_sel:[1,1,0] op_sel_hi:[1,0,1] neg_lo:[1,0,0]
v_pk_fma_f32 v[78:79], v[18:19], v[30:31], v[78:79] op_sel:[1,1,0] op_sel_hi:[1,0,1] neg_lo:[1,0,0]
v_cvt_pk_bf16_f32 v88, v76, v77
v_cvt_pk_bf16_f32 v89, v78, v79
ds_write_b64 v11, v[88:89] offset:4224
v_pk_mul_f32 v[84:85], v[76:77], v[20:21] op_sel:[0,0] op_sel_hi:[0,1]
v_pk_mul_f32 v[86:87], v[78:79], v[22:23] op_sel:[0,0] op_sel_hi:[0,1]
v_pk_fma_f32 v[84:85], v[76:77], v[20:21], v[84:85] op_sel:[1,1,0] op_sel_hi:[1,0,1] neg_lo:[1,0,0]
v_pk_fma_f32 v[86:87], v[78:79], v[22:23], v[86:87] op_sel:[1,1,0] op_sel_hi:[1,0,1] neg_lo:[1,0,0]
v_cvt_pk_bf16_f32 v90, v84, v85
v_cvt_pk_bf16_f32 v91, v86, v87
ds_write_b64 v11, v[90:91] offset:4752
v_pk_mul_f32 v[80:81], v[76:77], v[32:33] op_sel:[0,0] op_sel_hi:[0,1]
v_pk_mul_f32 v[82:83], v[78:79], v[34:35] op_sel:[0,0] op_sel_hi:[0,1]
v_pk_fma_f32 v[80:81], v[76:77], v[32:33], v[80:81] op_sel:[1,1,0] op_sel_hi:[1,0,1] neg_lo:[1,0,0]
v_pk_fma_f32 v[82:83], v[78:79], v[34:35], v[82:83] op_sel:[1,1,0] op_sel_hi:[1,0,1] neg_lo:[1,0,0]
v_cvt_pk_bf16_f32 v92, v80, v81
v_cvt_pk_bf16_f32 v93, v82, v83
ds_write_b64 v11, v[92:93] offset:5280
v_pk_mul_f32 v[84:85], v[76:77], v[36:37] op_sel:[0,0] op_sel_hi:[0,1]
v_pk_mul_f32 v[86:87], v[78:79], v[38:39] op_sel:[0,0] op_sel_hi:[0,1]
v_pk_fma_f32 v[84:85], v[76:77], v[36:37], v[84:85] op_sel:[1,1,0] op_sel_hi:[1,0,1] neg_lo:[1,0,0]
v_pk_fma_f32 v[86:87], v[78:79], v[38:39], v[86:87] op_sel:[1,1,0] op_sel_hi:[1,0,1] neg_lo:[1,0,0]
v_cvt_pk_bf16_f32 v94, v84, v85
v_cvt_pk_bf16_f32 v95, v86, v87
ds_write_b64 v11, v[94:95] offset:5808
v_pk_mul_f32 v[80:81], v[76:77], v[40:41] op_sel:[0,0] op_sel_hi:[0,1]
v_pk_mul_f32 v[82:83], v[78:79], v[42:43] op_sel:[0,0] op_sel_hi:[0,1]
v_pk_fma_f32 v[80:81], v[76:77], v[40:41], v[80:81] op_sel:[1,1,0] op_sel_hi:[1,0,1] neg_lo:[1,0,0]
v_pk_fma_f32 v[82:83], v[78:79], v[42:43], v[82:83] op_sel:[1,1,0] op_sel_hi:[1,0,1] neg_lo:[1,0,0]
v_cvt_pk_bf16_f32 v88, v80, v81
v_cvt_pk_bf16_f32 v89, v82, v83
ds_write_b64 v11, v[88:89] offset:6336
v_pk_mul_f32 v[84:85], v[76:77], v[44:45] op_sel:[0,0] op_sel_hi:[0,1]
v_pk_mul_f32 v[86:87], v[78:79], v[46:47] op_sel:[0,0] op_sel_hi:[0,1]
v_pk_fma_f32 v[84:85], v[76:77], v[44:45], v[84:85] op_sel:[1,1,0] op_sel_hi:[1,0,1] neg_lo:[1,0,0]
v_pk_fma_f32 v[86:87], v[78:79], v[46:47], v[86:87] op_sel:[1,1,0] op_sel_hi:[1,0,1] neg_lo:[1,0,0]
v_cvt_pk_bf16_f32 v90, v84, v85
v_cvt_pk_bf16_f32 v91, v86, v87
ds_write_b64 v11, v[90:91] offset:6864
v_pk_mul_f32 v[80:81], v[76:77], v[48:49] op_sel:[0,0] op_sel_hi:[0,1]
v_pk_mul_f32 v[82:83], v[78:79], v[50:51] op_sel:[0,0] op_sel_hi:[0,1]
v_pk_fma_f32 v[80:81], v[76:77], v[48:49], v[80:81] op_sel:[1,1,0] op_sel_hi:[1,0,1] neg_lo:[1,0,0]
v_pk_fma_f32 v[82:83], v[78:79], v[50:51], v[82:83] op_sel:[1,1,0] op_sel_hi:[1,0,1] neg_lo:[1,0,0]
v_cvt_pk_bf16_f32 v92, v80, v81
v_cvt_pk_bf16_f32 v93, v82, v83
ds_write_b64 v11, v[92:93] offset:7392
v_pk_mul_f32 v[84:85], v[76:77], v[52:53] op_sel:[0,0] op_sel_hi:[0,1]
v_pk_mul_f32 v[86:87], v[78:79], v[54:55] op_sel:[0,0] op_sel_hi:[0,1]
v_pk_fma_f32 v[84:85], v[76:77], v[52:53], v[84:85] op_sel:[1,1,0] op_sel_hi:[1,0,1] neg_lo:[1,0,0]
v_pk_fma_f32 v[86:87], v[78:79], v[54:55], v[86:87] op_sel:[1,1,0] op_sel_hi:[1,0,1] neg_lo:[1,0,0]
v_cvt_pk_bf16_f32 v94, v84, v85
v_cvt_pk_bf16_f32 v95, v86, v87
ds_write_b64 v11, v[94:95] offset:7920
v_pk_mul_f32 v[72:73], v[76:77], v[28:29] op_sel:[0,0] op_sel_hi:[0,1]
v_pk_mul_f32 v[74:75], v[78:79], v[30:31] op_sel:[0,0] op_sel_hi:[0,1]
v_pk_fma_f32 v[72:73], v[76:77], v[28:29], v[72:73] op_sel:[1,1,0] op_sel_hi:[1,0,1] neg_lo:[1,0,0]
v_pk_fma_f32 v[74:75], v[78:79], v[30:31], v[74:75] op_sel:[1,1,0] op_sel_hi:[1,0,1] neg_lo:[1,0,0]
v_cvt_pk_bf16_f32 v88, v72, v73
v_cvt_pk_bf16_f32 v89, v74, v75
ds_write_b64 v11, v[88:89] offset:8448
v_pk_mul_f32 v[80:81], v[72:73], v[32:33] op_sel:[0,0] op_sel_hi:[0,1]
v_pk_mul_f32 v[82:83], v[74:75], v[34:35] op_sel:[0,0] op_sel_hi:[0,1]
v_pk_fma_f32 v[80:81], v[72:73], v[32:33], v[80:81] op_sel:[1,1,0] op_sel_hi:[1,0,1] neg_lo:[1,0,0]
v_pk_fma_f32 v[82:83], v[74:75], v[34:35], v[82:83] op_sel:[1,1,0] op_sel_hi:[1,0,1] neg_lo:[1,0,0]
v_cvt_pk_bf16_f32 v90, v80, v81
v_cvt_pk_bf16_f32 v91, v82, v83
ds_write_b64 v11, v[90:91] offset:8976
v_pk_mul_f32 v[84:85], v[72:73], v[40:41] op_sel:[0,0] op_sel_hi:[0,1]
v_pk_mul_f32 v[86:87], v[74:75], v[42:43] op_sel:[0,0] op_sel_hi:[0,1]
v_pk_fma_f32 v[84:85], v[72:73], v[40:41], v[84:85] op_sel:[1,1,0] op_sel_hi:[1,0,1] neg_lo:[1,0,0]
v_pk_fma_f32 v[86:87], v[74:75], v[42:43], v[86:87] op_sel:[1,1,0] op_sel_hi:[1,0,1] neg_lo:[1,0,0]
v_cvt_pk_bf16_f32 v92, v84, v85
v_cvt_pk_bf16_f32 v93, v86, v87
ds_write_b64 v11, v[92:93] offset:9504
v_pk_mul_f32 v[80:81], v[72:73], v[48:49] op_sel:[0,0] op_sel_hi:[0,1]
v_pk_mul_f32 v[82:83], v[74:75], v[50:51] op_sel:[0,0] op_sel_hi:[0,1]
v_pk_fma_f32 v[80:81], v[72:73], v[48:49], v[80:81] op_sel:[1,1,0] op_sel_hi:[1,0,1] neg_lo:[1,0,0]
v_pk_fma_f32 v[82:83], v[74:75], v[50:51], v[82:83] op_sel:[1,1,0] op_sel_hi:[1,0,1] neg_lo:[1,0,0]
v_cvt_pk_bf16_f32 v94, v80, v81
v_cvt_pk_bf16_f32 v95, v82, v83
ds_write_b64 v11, v[94:95] offset:10032
v_pk_mul_f32 v[76:77], v[72:73], v[28:29] op_sel:[0,0] op_sel_hi:[0,1]
v_pk_mul_f32 v[78:79], v[74:75], v[30:31] op_sel:[0,0] op_sel_hi:[0,1]
v_pk_fma_f32 v[76:77], v[72:73], v[28:29], v[76:77] op_sel:[1,1,0] op_sel_hi:[1,0,1] neg_lo:[1,0,0]
v_pk_fma_f32 v[78:79], v[74:75], v[30:31], v[78:79] op_sel:[1,1,0] op_sel_hi:[1,0,1] neg_lo:[1,0,0]
v_cvt_pk_bf16_f32 v88, v76, v77
v_cvt_pk_bf16_f32 v89, v78, v79
ds_write_b64 v11, v[88:89] offset:10560
v_pk_mul_f32 v[84:85], v[76:77], v[32:33] op_sel:[0,0] op_sel_hi:[0,1]
v_pk_mul_f32 v[86:87], v[78:79], v[34:35] op_sel:[0,0] op_sel_hi:[0,1]
v_pk_fma_f32 v[84:85], v[76:77], v[32:33], v[84:85] op_sel:[1,1,0] op_sel_hi:[1,0,1] neg_lo:[1,0,0]
v_pk_fma_f32 v[86:87], v[78:79], v[34:35], v[86:87] op_sel:[1,1,0] op_sel_hi:[1,0,1] neg_lo:[1,0,0]
v_cvt_pk_bf16_f32 v90, v84, v85
v_cvt_pk_bf16_f32 v91, v86, v87
ds_write_b64 v11, v[90:91] offset:11088
v_pk_mul_f32 v[80:81], v[76:77], v[40:41] op_sel:[0,0] op_sel_hi:[0,1]
v_pk_mul_f32 v[82:83], v[78:79], v[42:43] op_sel:[0,0] op_sel_hi:[0,1]
v_pk_fma_f32 v[80:81], v[76:77], v[40:41], v[80:81] op_sel:[1,1,0] op_sel_hi:[1,0,1] neg_lo:[1,0,0]
v_pk_fma_f32 v[82:83], v[78:79], v[42:43], v[82:83] op_sel:[1,1,0] op_sel_hi:[1,0,1] neg_lo:[1,0,0]
v_cvt_pk_bf16_f32 v92, v80, v81
v_cvt_pk_bf16_f32 v93, v82, v83
ds_write_b64 v11, v[92:93] offset:11616
v_pk_mul_f32 v[84:85], v[76:77], v[48:49] op_sel:[0,0] op_sel_hi:[0,1]
v_pk_mul_f32 v[86:87], v[78:79], v[50:51] op_sel:[0,0] op_sel_hi:[0,1]
v_pk_fma_f32 v[84:85], v[76:77], v[48:49], v[84:85] op_sel:[1,1,0] op_sel_hi:[1,0,1] neg_lo:[1,0,0]
v_pk_fma_f32 v[86:87], v[78:79], v[50:51], v[86:87] op_sel:[1,1,0] op_sel_hi:[1,0,1] neg_lo:[1,0,0]
v_cvt_pk_bf16_f32 v94, v84, v85
v_cvt_pk_bf16_f32 v95, v86, v87
ds_write_b64 v11, v[94:95] offset:12144
v_pk_mul_f32 v[72:73], v[76:77], v[28:29] op_sel:[0,0] op_sel_hi:[0,1]
v_pk_mul_f32 v[74:75], v[78:79], v[30:31] op_sel:[0,0] op_sel_hi:[0,1]
v_pk_fma_f32 v[72:73], v[76:77], v[28:29], v[72:73] op_sel:[1,1,0] op_sel_hi:[1,0,1] neg_lo:[1,0,0]
v_pk_fma_f32 v[74:75], v[78:79], v[30:31], v[74:75] op_sel:[1,1,0] op_sel_hi:[1,0,1] neg_lo:[1,0,0]
v_cvt_pk_bf16_f32 v88, v72, v73
v_cvt_pk_bf16_f32 v89, v74, v75
ds_write_b64 v11, v[88:89] offset:12672
v_pk_mul_f32 v[80:81], v[72:73], v[40:41] op_sel:[0,0] op_sel_hi:[0,1]
v_pk_mul_f32 v[82:83], v[74:75], v[42:43] op_sel:[0,0] op_sel_hi:[0,1]
v_pk_fma_f32 v[80:81], v[72:73], v[40:41], v[80:81] op_sel:[1,1,0] op_sel_hi:[1,0,1] neg_lo:[1,0,0]
v_pk_fma_f32 v[82:83], v[74:75], v[42:43], v[82:83] op_sel:[1,1,0] op_sel_hi:[1,0,1] neg_lo:[1,0,0]
v_cvt_pk_bf16_f32 v90, v80, v81
v_cvt_pk_bf16_f32 v91, v82, v83
ds_write_b64 v11, v[90:91] offset:13200
v_pk_mul_f32 v[76:77], v[72:73], v[28:29] op_sel:[0,0] op_sel_hi:[0,1]
v_pk_mul_f32 v[78:79], v[74:75], v[30:31] op_sel:[0,0] op_sel_hi:[0,1]
v_pk_fma_f32 v[76:77], v[72:73], v[28:29], v[76:77] op_sel:[1,1,0] op_sel_hi:[1,0,1] neg_lo:[1,0,0]
v_pk_fma_f32 v[78:79], v[74:75], v[30:31], v[78:79] op_sel:[1,1,0] op_sel_hi:[1,0,1] neg_lo:[1,0,0]
v_cvt_pk_bf16_f32 v92, v76, v77
v_cvt_pk_bf16_f32 v93, v78, v79
ds_write_b64 v11, v[92:93] offset:13728
v_pk_mul_f32 v[84:85], v[76:77], v[40:41] op_sel:[0,0] op_sel_hi:[0,1]
v_pk_mul_f32 v[86:87], v[78:79], v[42:43] op_sel:[0,0] op_sel_hi:[0,1]
v_pk_fma_f32 v[84:85], v[76:77], v[40:41], v[84:85] op_sel:[1,1,0] op_sel_hi:[1,0,1] neg_lo:[1,0,0]
v_pk_fma_f32 v[86:87], v[78:79], v[42:43], v[86:87] op_sel:[1,1,0] op_sel_hi:[1,0,1] neg_lo:[1,0,0]
v_cvt_pk_bf16_f32 v94, v84, v85
v_cvt_pk_bf16_f32 v95, v86, v87
ds_write_b64 v11, v[94:95] offset:14256
v_pk_mul_f32 v[72:73], v[76:77], v[28:29] op_sel:[0,0] op_sel_hi:[0,1]
v_pk_mul_f32 v[74:75], v[78:79], v[30:31] op_sel:[0,0] op_sel_hi:[0,1]
v_pk_fma_f32 v[72:73], v[76:77], v[28:29], v[72:73] op_sel:[1,1,0] op_sel_hi:[1,0,1] neg_lo:[1,0,0]
v_pk_fma_f32 v[74:75], v[78:79], v[30:31], v[74:75] op_sel:[1,1,0] op_sel_hi:[1,0,1] neg_lo:[1,0,0]
v_cvt_pk_bf16_f32 v88, v72, v73
v_cvt_pk_bf16_f32 v89, v74, v75
ds_write_b64 v11, v[88:89] offset:14784
v_pk_mul_f32 v[80:81], v[72:73], v[40:41] op_sel:[0,0] op_sel_hi:[0,1]
v_pk_mul_f32 v[82:83], v[74:75], v[42:43] op_sel:[0,0] op_sel_hi:[0,1]
v_pk_fma_f32 v[80:81], v[72:73], v[40:41], v[80:81] op_sel:[1,1,0] op_sel_hi:[1,0,1] neg_lo:[1,0,0]
v_pk_fma_f32 v[82:83], v[74:75], v[42:43], v[82:83] op_sel:[1,1,0] op_sel_hi:[1,0,1] neg_lo:[1,0,0]
v_cvt_pk_bf16_f32 v90, v80, v81
v_cvt_pk_bf16_f32 v91, v82, v83
ds_write_b64 v11, v[90:91] offset:15312
v_pk_mul_f32 v[76:77], v[72:73], v[28:29] op_sel:[0,0] op_sel_hi:[0,1]
v_pk_mul_f32 v[78:79], v[74:75], v[30:31] op_sel:[0,0] op_sel_hi:[0,1]
v_pk_fma_f32 v[76:77], v[72:73], v[28:29], v[76:77] op_sel:[1,1,0] op_sel_hi:[1,0,1] neg_lo:[1,0,0]
v_pk_fma_f32 v[78:79], v[74:75], v[30:31], v[78:79] op_sel:[1,1,0] op_sel_hi:[1,0,1] neg_lo:[1,0,0]
v_cvt_pk_bf16_f32 v92, v76, v77
v_cvt_pk_bf16_f32 v93, v78, v79
ds_write_b64 v11, v[92:93] offset:15840
v_pk_mul_f32 v[84:85], v[76:77], v[40:41] op_sel:[0,0] op_sel_hi:[0,1]
v_pk_mul_f32 v[86:87], v[78:79], v[42:43] op_sel:[0,0] op_sel_hi:[0,1]
v_pk_fma_f32 v[84:85], v[76:77], v[40:41], v[84:85] op_sel:[1,1,0] op_sel_hi:[1,0,1] neg_lo:[1,0,0]
v_pk_fma_f32 v[86:87], v[78:79], v[42:43], v[86:87] op_sel:[1,1,0] op_sel_hi:[1,0,1] neg_lo:[1,0,0]
v_cvt_pk_bf16_f32 v94, v84, v85
v_cvt_pk_bf16_f32 v95, v86, v87
ds_write_b64 v11, v[94:95] offset:16368
v_pk_mul_f32 v[72:73], v[76:77], v[28:29] op_sel:[0,0] op_sel_hi:[0,1]
v_pk_mul_f32 v[74:75], v[78:79], v[30:31] op_sel:[0,0] op_sel_hi:[0,1]
v_pk_fma_f32 v[72:73], v[76:77], v[28:29], v[72:73] op_sel:[1,1,0] op_sel_hi:[1,0,1] neg_lo:[1,0,0]
v_pk_fma_f32 v[74:75], v[78:79], v[30:31], v[74:75] op_sel:[1,1,0] op_sel_hi:[1,0,1] neg_lo:[1,0,0]
v_cvt_pk_bf16_f32 v88, v72, v73
v_cvt_pk_bf16_f32 v89, v74, v75
ds_write_b64 v11, v[88:89] offset:16896
v_pk_mul_f32 v[76:77], v[72:73], v[28:29] op_sel:[0,0] op_sel_hi:[0,1]
v_pk_mul_f32 v[78:79], v[74:75], v[30:31] op_sel:[0,0] op_sel_hi:[0,1]
v_pk_fma_f32 v[76:77], v[72:73], v[28:29], v[76:77] op_sel:[1,1,0] op_sel_hi:[1,0,1] neg_lo:[1,0,0]
v_pk_fma_f32 v[78:79], v[74:75], v[30:31], v[78:79] op_sel:[1,1,0] op_sel_hi:[1,0,1] neg_lo:[1,0,0]
v_cvt_pk_bf16_f32 v90, v76, v77
v_cvt_pk_bf16_f32 v91, v78, v79
ds_write_b64 v11, v[90:91] offset:17424
v_pk_mul_f32 v[72:73], v[76:77], v[28:29] op_sel:[0,0] op_sel_hi:[0,1]
v_pk_mul_f32 v[74:75], v[78:79], v[30:31] op_sel:[0,0] op_sel_hi:[0,1]
v_pk_fma_f32 v[72:73], v[76:77], v[28:29], v[72:73] op_sel:[1,1,0] op_sel_hi:[1,0,1] neg_lo:[1,0,0]
v_pk_fma_f32 v[74:75], v[78:79], v[30:31], v[74:75] op_sel:[1,1,0] op_sel_hi:[1,0,1] neg_lo:[1,0,0]
v_cvt_pk_bf16_f32 v92, v72, v73
v_cvt_pk_bf16_f32 v93, v74, v75
ds_write_b64 v11, v[92:93] offset:17952
v_pk_mul_f32 v[76:77], v[72:73], v[28:29] op_sel:[0,0] op_sel_hi:[0,1]
v_pk_mul_f32 v[78:79], v[74:75], v[30:31] op_sel:[0,0] op_sel_hi:[0,1]
v_pk_fma_f32 v[76:77], v[72:73], v[28:29], v[76:77] op_sel:[1,1,0] op_sel_hi:[1,0,1] neg_lo:[1,0,0]
v_pk_fma_f32 v[78:79], v[74:75], v[30:31], v[78:79] op_sel:[1,1,0] op_sel_hi:[1,0,1] neg_lo:[1,0,0]
v_cvt_pk_bf16_f32 v94, v76, v77
v_cvt_pk_bf16_f32 v95, v78, v79
ds_write_b64 v11, v[94:95] offset:18480
v_pk_mul_f32 v[72:73], v[76:77], v[28:29] op_sel:[0,0] op_sel_hi:[0,1]
v_pk_mul_f32 v[74:75], v[78:79], v[30:31] op_sel:[0,0] op_sel_hi:[0,1]
v_pk_fma_f32 v[72:73], v[76:77], v[28:29], v[72:73] op_sel:[1,1,0] op_sel_hi:[1,0,1] neg_lo:[1,0,0]
v_pk_fma_f32 v[74:75], v[78:79], v[30:31], v[74:75] op_sel:[1,1,0] op_sel_hi:[1,0,1] neg_lo:[1,0,0]
v_cvt_pk_bf16_f32 v88, v72, v73
v_cvt_pk_bf16_f32 v89, v74, v75
ds_write_b64 v11, v[88:89] offset:19008
v_pk_mul_f32 v[76:77], v[72:73], v[28:29] op_sel:[0,0] op_sel_hi:[0,1]
v_pk_mul_f32 v[78:79], v[74:75], v[30:31] op_sel:[0,0] op_sel_hi:[0,1]
v_pk_fma_f32 v[76:77], v[72:73], v[28:29], v[76:77] op_sel:[1,1,0] op_sel_hi:[1,0,1] neg_lo:[1,0,0]
v_pk_fma_f32 v[78:79], v[74:75], v[30:31], v[78:79] op_sel:[1,1,0] op_sel_hi:[1,0,1] neg_lo:[1,0,0]
v_cvt_pk_bf16_f32 v90, v76, v77
v_cvt_pk_bf16_f32 v91, v78, v79
ds_write_b64 v11, v[90:91] offset:19536
v_pk_mul_f32 v[72:73], v[76:77], v[28:29] op_sel:[0,0] op_sel_hi:[0,1]
v_pk_mul_f32 v[74:75], v[78:79], v[30:31] op_sel:[0,0] op_sel_hi:[0,1]
v_pk_fma_f32 v[72:73], v[76:77], v[28:29], v[72:73] op_sel:[1,1,0] op_sel_hi:[1,0,1] neg_lo:[1,0,0]
v_pk_fma_f32 v[74:75], v[78:79], v[30:31], v[74:75] op_sel:[1,1,0] op_sel_hi:[1,0,1] neg_lo:[1,0,0]
v_cvt_pk_bf16_f32 v92, v72, v73
v_cvt_pk_bf16_f32 v93, v74, v75
ds_write_b64 v11, v[92:93] offset:20064
v_pk_mul_f32 v[76:77], v[72:73], v[28:29] op_sel:[0,0] op_sel_hi:[0,1]
v_pk_mul_f32 v[78:79], v[74:75], v[30:31] op_sel:[0,0] op_sel_hi:[0,1]
v_pk_fma_f32 v[76:77], v[72:73], v[28:29], v[76:77] op_sel:[1,1,0] op_sel_hi:[1,0,1] neg_lo:[1,0,0]
v_pk_fma_f32 v[78:79], v[74:75], v[30:31], v[78:79] op_sel:[1,1,0] op_sel_hi:[1,0,1] neg_lo:[1,0,0]
v_cvt_pk_bf16_f32 v94, v76, v77
v_cvt_pk_bf16_f32 v95, v78, v79
ds_write_b64 v11, v[94:95] offset:20592
v_pk_mul_f32 v[72:73], v[76:77], v[28:29] op_sel:[0,0] op_sel_hi:[0,1]
v_pk_mul_f32 v[74:75], v[78:79], v[30:31] op_sel:[0,0] op_sel_hi:[0,1]
v_pk_fma_f32 v[72:73], v[76:77], v[28:29], v[72:73] op_sel:[1,1,0] op_sel_hi:[1,0,1] neg_lo:[1,0,0]
v_pk_fma_f32 v[74:75], v[78:79], v[30:31], v[74:75] op_sel:[1,1,0] op_sel_hi:[1,0,1] neg_lo:[1,0,0]
v_cvt_pk_bf16_f32 v88, v72, v73
v_cvt_pk_bf16_f32 v89, v74, v75
ds_write_b64 v11, v[88:89] offset:21120
v_lshlrev_b32 v99, 4, v2
s_and_b32 s5, s2, 7
s_lshl_b32 s5, s5, 10
s_add_u32 s5, s5, 33558528
buffer_load_dwordx4 v[228:231], v99, s[12:15], s5 offen sc1
v_and_b32 v5, 15, v2
v_lshrrev_b32 v6, 4, v2
v_mul_u32_u24 v11, 528, v5
v_lshl_add_u32 v11, v6, 4, v11
v_add_u32 v11, s61, v11
ds_read_b128 v[164:167], v11 offset:21648
ds_read_b128 v[168:171], v11 offset:0
ds_read_b128 v[172:175], v11 offset:8448
ds_read_b128 v[176:179], v11 offset:16896
ds_read_b128 v[180:183], v11 offset:21712
ds_read_b128 v[184:187], v11 offset:64
ds_read_b128 v[188:191], v11 offset:8512
ds_read_b128 v[192:195], v11 offset:16960
ds_read_b128 v[196:199], v11 offset:21776
ds_read_b128 v[200:203], v11 offset:128
ds_read_b128 v[204:207], v11 offset:8576
ds_read_b128 v[208:211], v11 offset:17024
ds_read_b128 v[212:215], v11 offset:21840
ds_read_b128 v[216:219], v11 offset:192
ds_read_b128 v[220:223], v11 offset:8640
ds_read_b128 v[224:227], v11 offset:17088
ds_read_b128 v[32:35], v11 offset:21904
ds_read_b128 v[36:39], v11 offset:256
ds_read_b128 v[40:43], v11 offset:8704
ds_read_b128 v[44:47], v11 offset:17152
ds_read_b128 v[48:51], v11 offset:21968
ds_read_b128 v[52:55], v11 offset:320
ds_read_b128 v[56:59], v11 offset:8768
ds_read_b128 v[60:63], v11 offset:17216
ds_read_b128 v[64:67], v11 offset:22032
ds_read_b128 v[68:71], v11 offset:384
ds_read_b128 v[72:75], v11 offset:8832
ds_read_b128 v[76:79], v11 offset:17280
ds_read_b128 v[80:83], v11 offset:22096
ds_read_b128 v[84:87], v11 offset:448
ds_read_b128 v[88:91], v11 offset:8896
ds_read_b128 v[92:95], v11 offset:17344
s_add_u32 s6, s61, 16640
v_lshrrev_b32 v7, 1, v6
v_lshlrev_b32 v7, 7, v7
v_and_b32 v8, 1, v6
v_lshl_add_u32 v7, v8, 2, v7
v_lshl_add_u32 v7, v5, 3, v7
v_lshl_add_u32 v7, v7, 1, s6
v_lshlrev_b32 v8, 6, v6
v_lshlrev_b32 v9, 2, v5
v_lshlrev_b32 v10, 1, v5
v_cmp_gt_u32 vcc, 2, v6
s_nop 1
v_cndmask_b32 v9, v10, v9, vcc
v_add_u32 v8, v8, v9
v_add_u32 v8, 256, v8
v_lshl_add_u32 v8, v8, 1, s6
v_mov_b32 v9, 64
v_mov_b32 v10, 4
v_cndmask_b32 v9, v9, v10, vcc
v_add_u32 v9, v8, v9
v_lshlrev_b32 v10, 6, v6
v_add_u32 v10, v10, v5
v_lshl_add_u32 v10, v10, 1, s6
s_waitcnt lgkmcnt(15)
v_mfma_f32_16x16x32_bf16 v[12:15], v[168:171], v[164:167], 0
v_mfma_f32_16x16x32_bf16 v[16:19], v[172:175], v[164:167], 0
v_mfma_f32_16x16x32_bf16 v[20:23], v[176:179], v[164:167], 0
s_waitcnt lgkmcnt(15)
v_mfma_f32_16x16x32_bf16 v[12:15], v[184:187], v[180:183], v[12:15]
v_mfma_f32_16x16x32_bf16 v[16:19], v[188:191], v[180:183], v[16:19]
v_mfma_f32_16x16x32_bf16 v[20:23], v[192:195], v[180:183], v[20:23]
s_waitcnt lgkmcnt(15)
v_mfma_f32_16x16x32_bf16 v[12:15], v[200:203], v[196:199], v[12:15]
v_mfma_f32_16x16x32_bf16 v[16:19], v[204:207], v[196:199], v[16:19]
v_mfma_f32_16x16x32_bf16 v[20:23], v[208:211], v[196:199], v[20:23]
s_waitcnt lgkmcnt(15)
v_mfma_f32_16x16x32_bf16 v[12:15], v[216:219], v[212:215], v[12:15]
v_mfma_f32_16x16x32_bf16 v[16:19], v[220:223], v[212:215], v[16:19]
v_mfma_f32_16x16x32_bf16 v[20:23], v[224:227], v[212:215], v[20:23]
s_waitcnt lgkmcnt(12)
v_mfma_f32_16x16x32_bf16 v[12:15], v[36:39], v[32:35], v[12:15]
v_mfma_f32_16x16x32_bf16 v[16:19], v[40:43], v[32:35], v[16:19]
v_mfma_f32_16x16x32_bf16 v[20:23], v[44:47], v[32:35], v[20:23]
s_waitcnt lgkmcnt(8)
v_mfma_f32_16x16x32_bf16 v[12:15], v[52:55], v[48:51], v[12:15]
v_mfma_f32_16x16x32_bf16 v[16:19], v[56:59], v[48:51], v[16:19]
v_mfma_f32_16x16x32_bf16 v[20:23], v[60:63], v[48:51], v[20:23]
s_waitcnt lgkmcnt(4)
v_mfma_f32_16x16x32_bf16 v[12:15], v[68:71], v[64:67], v[12:15]
v_mfma_f32_16x16x32_bf16 v[16:19], v[72:75], v[64:67], v[16:19]
v_mfma_f32_16x16x32_bf16 v[20:23], v[76:79], v[64:67], v[20:23]
s_waitcnt lgkmcnt(0)
v_mfma_f32_16x16x32_bf16 v[12:15], v[84:87], v[80:83], v[12:15]
v_mfma_f32_16x16x32_bf16 v[16:19], v[88:91], v[80:83], v[16:19]
v_mfma_f32_16x16x32_bf16 v[20:23], v[92:95], v[80:83], v[20:23]
s_nop 5
v_cvt_pk_bf16_f32 v24, v12, v13
v_cvt_pk_bf16_f32 v25, v14, v15
ds_write_b64 v7, v[24:25]
v_cvt_pk_bf16_f32 v26, v16, v17
v_cvt_pk_bf16_f32 v27, v18, v19
ds_write_b32 v8, v26
ds_write_b32 v9, v27
v_cvt_pk_bf16_f32 v28, v20, v21
v_cvt_pk_bf16_f32 v29, v22, v23
ds_write_b16 v10, v28 offset:1024
ds_write_b16_d16_hi v10, v28 offset:1056
ds_write_b16 v10, v29 offset:1088
ds_write_b16_d16_hi v10, v29 offset:1120
s_mov_b32 s7, 0
s_waitcnt vmcnt(0)
s_branch Lb1c_8
Lb1p_7:
s_sleep 1
v_lshlrev_b32 v99, 4, v2
s_and_b32 s5, s2, 7
s_lshl_b32 s5, s5, 10
s_add_u32 s5, s5, 33558528
buffer_load_dwordx4 v[228:231], v99, s[12:15], s5 offen sc1
s_waitcnt vmcnt(0)
Lb1c_8:
v_xor_b32 v228, s83, v228
v_xor_b32 v229, s83, v229
v_xor_b32 v230, s83, v230
v_xor_b32 v231, s83, v231
v_or_b32 v228, v228, v229
v_or3_b32 v228, v228, v230, v231
v_cmp_ne_u32 vcc, 0, v228
s_cbranch_vccz Lb1d_9
s_add_u32 s7, s7, 1
s_cmp_lt_u32 s7, 0x40000
s_cbranch_scc1 Lb1p_7
Lb1d_9:
v_lshrrev_b32 v232, 3, v2
v_mul_u32_u24 v233, 20480, v232
v_and_b32 v234, 7, v2
v_lshl_add_u32 v233, v234, 4, v233
s_mul_i32 s5, s4, 1310720
s_lshl_b32 s7, s2, 7
s_add_u32 s5, s5, s7
buffer_load_dwordx4 v[164:167], v233, s[12:15], s5 offen sc1
s_add_u32 s5, s5, 163840
buffer_load_dwordx4 v[168:171], v233, s[12:15], s5 offen sc1
s_add_u32 s5, s5, 163840
buffer_load_dwordx4 v[172:175], v233, s[12:15], s5 offen sc1
s_add_u32 s5, s5, 163840
buffer_load_dwordx4 v[176:179], v233, s[12:15], s5 offen sc1
s_add_u32 s5, s5, 163840
buffer_load_dwordx4 v[180:183], v233, s[12:15], s5 offen sc1
s_add_u32 s5, s5, 163840
buffer_load_dwordx4 v[184:187], v233, s[12:15], s5 offen sc1
s_add_u32 s5, s5, 163840
buffer_load_dwordx4 v[188:191], v233, s[12:15], s5 offen sc1
s_add_u32 s5, s5, 163840
buffer_load_dwordx4 v[192:195], v233, s[12:15], s5 offen sc1
v_lshlrev_b32 v7, 4, v2
v_add_u32 v7, s61, v7
v_and_b32 v10, 15, v2
v_lshlrev_b32 v10, 2, v10
v_add_u32 v10, s61, v10
v_mov_b32 v11, 0
ds_read_u16 v12, v100
ds_read_u16 v18, v101
ds_read_u16 v13, v102
ds_read_u16 v19, v103
ds_read_u16 v14, v104
ds_read_u16 v20, v105
ds_read_u16 v15, v106
ds_read_u16 v21, v107
ds_read_u16 v16, v108
ds_read_u16 v22, v109
ds_read_u16 v17, v110
ds_read_u16 v24, v111
ds_read_u16 v30, v112
ds_read_u16 v25, v113
ds_read_u16 v31, v114
ds_read_u16 v26, v115
ds_read_u16 v32, v116
ds_read_u16 v27, v117
ds_read_u16 v33, v118
ds_read_u16 v28, v119
ds_read_u16 v34, v120
ds_read_u16 v29, v121
ds_read_u16 v36, v122
ds_read_u16 v42, v123
ds_read_u16 v37, v124
ds_read_u16 v43, v125
ds_read_u16 v38, v126
ds_read_u16 v44, v127
ds_read_u16 v39, v128
ds_read_u16 v45, v129
ds_read_u16 v40, v130
ds_read_u16 v46, v131
ds_read_u16 v41, v132
ds_read_u16 v48, v133
ds_read_u16 v54, v134
ds_read_u16 v49, v135
ds_read_u16 v55, v136
ds_read_u16 v50, v137
ds_read_u16 v56, v138
ds_read_u16 v51, v139
ds_read_u16 v57, v140
ds_read_u16 v52, v141
ds_read_u16 v58, v142
ds_read_u16 v53, v143
ds_write_b32 v10, v11 offset:4096
ds_write_b32 v10, v11 offset:8256
ds_write_b32 v10, v11 offset:12416
ds_write_b32 v10, v11 offset:16576
s_waitcnt lgkmcnt(0)
v_lshl_or_b32 v64, v18, 16, v12
v_lshl_or_b32 v65, v19, 16, v13
v_lshl_or_b32 v66, v20, 16, v14
v_lshl_or_b32 v67, v21, 16, v15
v_lshl_or_b32 v68, v22, 16, v16
v_mov_b32 v69, v17
v_alignbit_b32 v72, v65, v64, 16
v_alignbit_b32 v73, v66, v65, 16
v_alignbit_b32 v74, v67, v66, 16
v_alignbit_b32 v75, v68, v67, 16
v_alignbit_b32 v76, v69, v68, 16
ds_write_b128 v7, v[64:67] offset:0
ds_write_b128 v7, v[72:75] offset:4160
v_pk_mov_b32 v[80:81], v[64:65], v[66:67] op_sel:[1,0]
v_pk_mov_b32 v[82:83], v[66:67], v[68:69] op_sel:[1,0]
v_pk_mov_b32 v[84:85], v[72:73], v[74:75] op_sel:[1,0]
v_pk_mov_b32 v[86:87], v[74:75], v[76:77] op_sel:[1,0]
ds_write_b128 v7, v[80:83] offset:8320
ds_write_b128 v7, v[84:87] offset:12480
v_lshl_or_b32 v64, v30, 16, v24
v_lshl_or_b32 v65, v31, 16, v25
v_lshl_or_b32 v66, v32, 16, v26
v_lshl_or_b32 v67, v33, 16, v27
v_lshl_or_b32 v68, v34, 16, v28
v_mov_b32 v69, v29
v_alignbit_b32 v72, v65, v64, 16
v_alignbit_b32 v73, v66, v65, 16
v_alignbit_b32 v74, v67, v66, 16
v_alignbit_b32 v75, v68, v67, 16
v_alignbit_b32 v76, v69, v68, 16
ds_write_b128 v7, v[64:67] offset:1024
ds_write_b128 v7, v[72:75] offset:5184
v_pk_mov_b32 v[80:81], v[64:65], v[66:67] op_sel:[1,0]
v_pk_mov_b32 v[82:83], v[66:67], v[68:69] op_sel:[1,0]
v_pk_mov_b32 v[84:85], v[72:73], v[74:75] op_sel:[1,0]
v_pk_mov_b32 v[86:87], v[74:75], v[76:77] op_sel:[1,0]
ds_write_b128 v7, v[80:83] offset:9344
ds_write_b128 v7, v[84:87] offset:13504
v_lshl_or_b32 v64, v42, 16, v36
v_lshl_or_b32 v65, v43, 16, v37
v_lshl_or_b32 v66, v44, 16, v38
v_lshl_or_b32 v67, v45, 16, v39
v_lshl_or_b32 v68, v46, 16, v40
v_mov_b32 v69, v41
v_alignbit_b32 v72, v65, v64, 16
v_alignbit_b32 v73, v66, v65, 16
v_alignbit_b32 v74, v67, v66, 16
v_alignbit_b32 v75, v68, v67, 16
v_alignbit_b32 v76, v69, v68, 16
ds_write_b128 v7, v[64:67] offset:2048
ds_write_b128 v7, v[72:75] offset:6208
v_pk_mov_b32 v[80:81], v[64:65], v[66:67] op_sel:[1,0]
v_pk_mov_b32 v[82:83], v[66:67], v[68:69] op_sel:[1,0]
v_pk_mov_b32 v[84:85], v[72:73], v[74:75] op_sel:[1,0]
v_pk_mov_b32 v[86:87], v[74:75], v[76:77] op_sel:[1,0]
ds_write_b128 v7, v[80:83] offset:10368
ds_write_b128 v7, v[84:87] offset:14528
v_lshl_or_b32 v64, v54, 16, v48
v_lshl_or_b32 v65, v55, 16, v49
v_lshl_or_b32 v66, v56, 16, v50
v_lshl_or_b32 v67, v57, 16, v51
v_lshl_or_b32 v68, v58, 16, v52
v_mov_b32 v69, v53
v_writelane_b32 v68, 0, 63
v_writelane_b32 v69, 0, 63
v_alignbit_b32 v72, v65, v64, 16
v_alignbit_b32 v73, v66, v65, 16
v_alignbit_b32 v74, v67, v66, 16
v_alignbit_b32 v75, v68, v67, 16
v_alignbit_b32 v76, v69, v68, 16
ds_write_b128 v7, v[64:67] offset:3072
ds_write_b128 v7, v[72:75] offset:7232
v_pk_mov_b32 v[80:81], v[64:65], v[66:67] op_sel:[1,0]
v_pk_mov_b32 v[82:83], v[66:67], v[68:69] op_sel:[1,0]
v_pk_mov_b32 v[84:85], v[72:73], v[74:75] op_sel:[1,0]
v_pk_mov_b32 v[86:87], v[74:75], v[76:77] op_sel:[1,0]
ds_write_b128 v7, v[80:83] offset:11392
ds_write_b128 v7, v[84:87] offset:15552
s_and_b32 s5, s2, 7
s_lshr_b32 s6, s2, 3
s_lshr_b32 s66, s5, 1
s_lshl_b32 s66, s66, 2
s_and_b32 s7, s6, 3
s_add_u32 s66, s66, s7
s_and_b32 s67, s5, 1
s_lshl_b32 s67, s67, 3
s_lshr_b32 s7, s6, 2
s_add_u32 s67, s67, s7
s_lshl_b32 s72, s5, 2
s_and_b32 s7, s6, 3
s_add_u32 s72, s72, s7
s_lshr_b32 s73, s6, 2
s_mul_i32 s74, s4, 14
s_mul_i32 s79, s73, 56
s_add_u32 s79, s79, s74
s_mul_i32 s79, s79, 5120
s_add_u32 s79, s79, 11534336
s_mul_i32 s76, s67, 143360
s_add_u32 s76, s76, 8388608
s_mul_i32 s75, s4, 30272
v_lshlrev_b32 v3, 4, v2
s_lshl_b32 s82, s4, 10
s_add_u32 s77, s76, s82
s_lshl_b32 s78, s66, 2
s_add_u32 s78, s78, s4
s_mul_i32 s78, s78, 20480
s_add_u32 s81, s78, 5242880
s_add_u32 s80, s81, 1310720
v_lshrrev_b32 v4, 3, v2
v_and_b32 v6, 7, v2
v_lshrrev_b32 v7, 4, v2
v_xor_b32 v8, v6, v7
v_xor_b32 v9, 4, v8
v_lshlrev_b32 v4, 7, v4
s_lshl_b32 s6, s4, 13
s_add_u32 s6, s6, 125184
v_add_u32 v4, s6, v4
v_lshl_add_u32 v8, v8, 4, v4
v_lshl_add_u32 v9, v9, 4, v4
s_waitcnt vmcnt(7)
ds_write_b128 v8, v[164:167] offset:0
s_waitcnt vmcnt(6)
ds_write_b128 v9, v[168:171] offset:1024
s_waitcnt vmcnt(5)
ds_write_b128 v8, v[172:175] offset:2048
s_waitcnt vmcnt(4)
ds_write_b128 v9, v[176:179] offset:3072
s_waitcnt vmcnt(3)
ds_write_b128 v8, v[180:183] offset:4096
s_waitcnt vmcnt(2)
ds_write_b128 v9, v[184:187] offset:5120
s_waitcnt vmcnt(1)
ds_write_b128 v8, v[188:191] offset:6144
s_waitcnt vmcnt(0)
ds_write_b128 v9, v[192:195] offset:7168
s_waitcnt lgkmcnt(0)
s_barrier
s_cmp_eq_u32 s4, 0
s_cbranch_scc0 Lsig_10
v_lshlrev_b32 v5, 10, v2
s_lshl_b32 s5, s2, 2
s_add_u32 s5, s5, 33595392
v_mov_b32 v4, s83
s_mov_b64 exec, 0xff
buffer_store_dword v4, v5, s[12:15], s5 offen sc1
s_mov_b64 exec, -1
Lsig_10:
v_lshlrev_b32 v7, 4, v2
s_and_b32 s5, s2, 7
s_lshl_b32 s5, s5, 10
s_add_u32 s5, s5, 33574912
buffer_load_dwordx4 v[8:11], v7, s[12:15], s5 offen sc1
ds_read_b64 v[44:45], v152 offset:4032
ds_read_b64 v[46:47], v152 offset:4040
ds_read_b128 v[76:79], v144 offset:0
ds_read_b64 v[48:49], v152 offset:3520
ds_read_b64 v[50:51], v152 offset:3528
ds_read_b128 v[80:83], v144 offset:4096
ds_read_b64 v[52:53], v152 offset:3008
ds_read_b64 v[54:55], v152 offset:3016
ds_read_b128 v[84:87], v144 offset:8192
ds_read_b64 v[56:57], v152 offset:2496
ds_read_b64 v[58:59], v152 offset:2504
ds_read_b128 v[88:91], v144 offset:12288
v_xor_b32 v4, 16, v153
v_lshlrev_b32 v6, 16, v161
s_waitcnt lgkmcnt(0)
v_mfma_f32_16x16x32_bf16 v[12:15], v[44:47], v[76:79], 0
ds_read_b64 v[164:165], v152 offset:3968
ds_read_b64 v[166:167], v152 offset:3976
v_mfma_f32_16x16x32_bf16 v[16:19], v[44:47], v[80:83], 0
ds_read_b128 v[196:199], v145 offset:0
ds_read_b64 v[168:169], v152 offset:3456
v_mfma_f32_16x16x32_bf16 v[20:23], v[44:47], v[84:87], 0
ds_read_b64 v[170:171], v152 offset:3464
ds_read_b128 v[200:203], v145 offset:4096
v_mfma_f32_16x16x32_bf16 v[24:27], v[44:47], v[88:91], 0
ds_read_b64 v[172:173], v152 offset:2944
ds_read_b64 v[174:175], v152 offset:2952
v_mfma_f32_16x16x32_bf16 v[16:19], v[48:51], v[76:79], v[16:19]
ds_read_b128 v[204:207], v145 offset:8192
ds_read_b64 v[176:177], v152 offset:2432
v_mfma_f32_16x16x32_bf16 v[20:23], v[48:51], v[80:83], v[20:23]
ds_read_b64 v[178:179], v152 offset:2440
ds_read_b128 v[208:211], v145 offset:12288
v_mfma_f32_16x16x32_bf16 v[24:27], v[48:51], v[84:87], v[24:27]
ds_read_b64 v[110:111], v153 offset:0
ds_read_b64 v[126:127], v4 offset:0
v_mfma_f32_16x16x32_bf16 v[20:23], v[52:55], v[76:79], v[20:23]
ds_read_b64 v[114:115], v153 offset:4096
ds_read_b64 v[130:131], v4 offset:4096
v_mfma_f32_16x16x32_bf16 v[24:27], v[52:55], v[80:83], v[24:27]
ds_read_b64 v[118:119], v153 offset:8192
ds_read_b64 v[134:135], v4 offset:8192
v_mfma_f32_16x16x32_bf16 v[24:27], v[56:59], v[76:79], v[24:27]
ds_read_b64 v[122:123], v153 offset:12288
ds_read_b64 v[138:139], v4 offset:12288
s_waitcnt lgkmcnt(0)
v_mfma_f32_16x16x32_bf16 v[12:15], v[164:167], v[196:199], v[12:15]
ds_read_b64 v[44:45], v152 offset:3904
ds_read_b64 v[46:47], v152 offset:3912
v_lshlrev_b32 v108, 16, v110
v_and_b32 v109, 0xffff0000, v110
v_mfma_f32_16x16x32_bf16 v[16:19], v[164:167], v[200:203], v[16:19]
ds_read_b128 v[76:79], v146 offset:0
ds_read_b64 v[48:49], v152 offset:3392
v_lshlrev_b32 v110, 16, v111
v_and_b32 v111, 0xffff0000, v111
v_mfma_f32_16x16x32_bf16 v[20:23], v[164:167], v[204:207], v[20:23]
ds_read_b64 v[50:51], v152 offset:3400
v_lshlrev_b32 v124, 16, v126
v_and_b32 v125, 0xffff0000, v126
v_mfma_f32_16x16x32_bf16 v[24:27], v[164:167], v[208:211], v[24:27]
ds_read_b128 v[80:83], v146 offset:4096
v_lshlrev_b32 v126, 16, v127
v_and_b32 v127, 0xffff0000, v127
v_mfma_f32_16x16x32_bf16 v[16:19], v[168:171], v[196:199], v[16:19]
ds_read_b64 v[52:53], v152 offset:2880
v_fma_f32 v108, v108, v6, v124
v_fma_f32 v109, v109, v6, v125
v_mfma_f32_16x16x32_bf16 v[20:23], v[168:171], v[200:203], v[20:23]
ds_read_b64 v[54:55], v152 offset:2888
v_fma_f32 v110, v110, v6, v126
v_fma_f32 v111, v111, v6, v127
v_mfma_f32_16x16x32_bf16 v[24:27], v[168:171], v[204:207], v[24:27]
ds_read_b128 v[84:87], v146 offset:8192
v_lshlrev_b32 v112, 16, v114
v_and_b32 v113, 0xffff0000, v114
v_mfma_f32_16x16x32_bf16 v[20:23], v[172:175], v[196:199], v[20:23]
ds_read_b64 v[56:57], v152 offset:2368
v_lshlrev_b32 v114, 16, v115
v_and_b32 v115, 0xffff0000, v115
v_mfma_f32_16x16x32_bf16 v[24:27], v[172:175], v[200:203], v[24:27]
ds_read_b64 v[58:59], v152 offset:2376
v_lshlrev_b32 v128, 16, v130
v_and_b32 v129, 0xffff0000, v130
v_mfma_f32_16x16x32_bf16 v[24:27], v[176:179], v[196:199], v[24:27]
ds_read_b128 v[88:91], v146 offset:12288
v_lshlrev_b32 v130, 16, v131
v_and_b32 v131, 0xffff0000, v131
s_waitcnt lgkmcnt(0)
v_mfma_f32_16x16x32_bf16 v[12:15], v[44:47], v[76:79], v[12:15]
ds_read_b64 v[164:165], v152 offset:3840
ds_read_b64 v[166:167], v152 offset:3848
v_fma_f32 v112, v112, v6, v128
v_fma_f32 v113, v113, v6, v129
v_mfma_f32_16x16x32_bf16 v[16:19], v[44:47], v[80:83], v[16:19]
ds_read_b128 v[196:199], v147 offset:0
ds_read_b64 v[168:169], v152 offset:3328
v_fma_f32 v114, v114, v6, v130
v_fma_f32 v115, v115, v6, v131
v_mfma_f32_16x16x32_bf16 v[20:23], v[44:47], v[84:87], v[20:23]
ds_read_b64 v[170:171], v152 offset:3336
v_lshlrev_b32 v116, 16, v118
v_and_b32 v117, 0xffff0000, v118
v_mfma_f32_16x16x32_bf16 v[24:27], v[44:47], v[88:91], v[24:27]
ds_read_b128 v[200:203], v147 offset:4096
v_lshlrev_b32 v118, 16, v119
v_and_b32 v119, 0xffff0000, v119
v_mfma_f32_16x16x32_bf16 v[16:19], v[48:51], v[76:79], v[16:19]
ds_read_b64 v[172:173], v152 offset:2816
v_lshlrev_b32 v132, 16, v134
v_and_b32 v133, 0xffff0000, v134
v_mfma_f32_16x16x32_bf16 v[20:23], v[48:51], v[80:83], v[20:23]
ds_read_b64 v[174:175], v152 offset:2824
v_lshlrev_b32 v134, 16, v135
v_and_b32 v135, 0xffff0000, v135
v_mfma_f32_16x16x32_bf16 v[24:27], v[48:51], v[84:87], v[24:27]
ds_read_b128 v[204:207], v147 offset:8192
v_fma_f32 v116, v116, v6, v132
v_fma_f32 v117, v117, v6, v133
v_mfma_f32_16x16x32_bf16 v[20:23], v[52:55], v[76:79], v[20:23]
ds_read_b64 v[176:177], v152 offset:2304
v_fma_f32 v118, v118, v6, v134
v_fma_f32 v119, v119, v6, v135
v_mfma_f32_16x16x32_bf16 v[24:27], v[52:55], v[80:83], v[24:27]
ds_read_b64 v[178:179], v152 offset:2312
v_lshlrev_b32 v120, 16, v122
v_and_b32 v121, 0xffff0000, v122
v_mfma_f32_16x16x32_bf16 v[24:27], v[56:59], v[76:79], v[24:27]
ds_read_b128 v[208:211], v147 offset:12288
v_lshlrev_b32 v122, 16, v123
v_and_b32 v123, 0xffff0000, v123
s_waitcnt lgkmcnt(0)
v_mfma_f32_16x16x32_bf16 v[12:15], v[164:167], v[196:199], v[12:15]
ds_read_b64 v[44:45], v152 offset:3776
ds_read_b64 v[46:47], v152 offset:3784
v_lshlrev_b32 v136, 16, v138
v_and_b32 v137, 0xffff0000, v138
v_mfma_f32_16x16x32_bf16 v[16:19], v[164:167], v[200:203], v[16:19]
ds_read_b128 v[76:79], v148 offset:0
ds_read_b64 v[48:49], v152 offset:3264
v_lshlrev_b32 v138, 16, v139
v_and_b32 v139, 0xffff0000, v139
v_mfma_f32_16x16x32_bf16 v[20:23], v[164:167], v[204:207], v[20:23]
ds_read_b64 v[50:51], v152 offset:3272
v_fma_f32 v120, v120, v6, v136
v_fma_f32 v121, v121, v6, v137
v_mfma_f32_16x16x32_bf16 v[24:27], v[164:167], v[208:211], v[24:27]
ds_read_b128 v[80:83], v148 offset:4096
v_fma_f32 v122, v122, v6, v138
v_fma_f32 v123, v123, v6, v139
v_mfma_f32_16x16x32_bf16 v[16:19], v[168:171], v[196:199], v[16:19]
ds_read_b64 v[52:53], v152 offset:2752
v_mfma_f32_16x16x32_bf16 v[20:23], v[168:171], v[200:203], v[20:23]
ds_read_b64 v[54:55], v152 offset:2760
v_mfma_f32_16x16x32_bf16 v[24:27], v[168:171], v[204:207], v[24:27]
ds_read_b128 v[84:87], v148 offset:8192
v_mfma_f32_16x16x32_bf16 v[20:23], v[172:175], v[196:199], v[20:23]
ds_read_b64 v[56:57], v152 offset:2240
v_mfma_f32_16x16x32_bf16 v[24:27], v[172:175], v[200:203], v[24:27]
ds_read_b64 v[58:59], v152 offset:2248
v_mfma_f32_16x16x32_bf16 v[24:27], v[176:179], v[196:199], v[24:27]
ds_read_b128 v[88:91], v148 offset:12288
s_waitcnt lgkmcnt(0)
v_mfma_f32_16x16x32_bf16 v[12:15], v[44:47], v[76:79], v[12:15]
ds_read_b64 v[164:165], v152 offset:3712
ds_read_b64 v[166:167], v152 offset:3720
v_mfma_f32_16x16x32_bf16 v[16:19], v[44:47], v[80:83], v[16:19]
ds_read_b128 v[196:199], v149 offset:0
ds_read_b64 v[168:169], v152 offset:3200
v_mfma_f32_16x16x32_bf16 v[20:23], v[44:47], v[84:87], v[20:23]
ds_read_b64 v[170:171], v152 offset:3208
v_mfma_f32_16x16x32_bf16 v[24:27], v[44:47], v[88:91], v[24:27]
ds_read_b128 v[200:203], v149 offset:4096
v_mfma_f32_16x16x32_bf16 v[16:19], v[48:51], v[76:79], v[16:19]
ds_read_b64 v[172:173], v152 offset:2688
v_mfma_f32_16x16x32_bf16 v[20:23], v[48:51], v[80:83], v[20:23]
ds_read_b64 v[174:175], v152 offset:2696
v_mfma_f32_16x16x32_bf16 v[24:27], v[48:51], v[84:87], v[24:27]
ds_read_b128 v[204:207], v149 offset:8192
v_mfma_f32_16x16x32_bf16 v[20:23], v[52:55], v[76:79], v[20:23]
ds_read_b64 v[176:177], v152 offset:2176
v_mfma_f32_16x16x32_bf16 v[24:27], v[52:55], v[80:83], v[24:27]
ds_read_b64 v[178:179], v152 offset:2184
v_mfma_f32_16x16x32_bf16 v[24:27], v[56:59], v[76:79], v[24:27]
ds_read_b128 v[208:211], v149 offset:12288
s_waitcnt lgkmcnt(0)
v_mfma_f32_16x16x32_bf16 v[12:15], v[164:167], v[196:199], v[12:15]
ds_read_b64 v[44:45], v152 offset:3648
ds_read_b64 v[46:47], v152 offset:3656
v_mfma_f32_16x16x32_bf16 v[16:19], v[164:167], v[200:203], v[16:19]
ds_read_b128 v[76:79], v150 offset:0
ds_read_b64 v[48:49], v152 offset:3136
v_mfma_f32_16x16x32_bf16 v[20:23], v[164:167], v[204:207], v[20:23]
ds_read_b64 v[50:51], v152 offset:3144
v_mfma_f32_16x16x32_bf16 v[24:27], v[164:167], v[208:211], v[24:27]
ds_read_b128 v[80:83], v150 offset:4096
v_mfma_f32_16x16x32_bf16 v[16:19], v[168:171], v[196:199], v[16:19]
ds_read_b64 v[52:53], v152 offset:2624
v_mfma_f32_16x16x32_bf16 v[20:23], v[168:171], v[200:203], v[20:23]
ds_read_b64 v[54:55], v152 offset:2632
v_mfma_f32_16x16x32_bf16 v[24:27], v[168:171], v[204:207], v[24:27]
ds_read_b128 v[84:87], v150 offset:8192
v_mfma_f32_16x16x32_bf16 v[20:23], v[172:175], v[196:199], v[20:23]
ds_read_b64 v[56:57], v152 offset:2112
v_mfma_f32_16x16x32_bf16 v[24:27], v[172:175], v[200:203], v[24:27]
ds_read_b64 v[58:59], v152 offset:2120
v_mfma_f32_16x16x32_bf16 v[24:27], v[176:179], v[196:199], v[24:27]
ds_read_b128 v[88:91], v150 offset:12288
s_waitcnt lgkmcnt(0)
v_mfma_f32_16x16x32_bf16 v[12:15], v[44:47], v[76:79], v[12:15]
ds_read_b64 v[164:165], v152 offset:3584
ds_read_b64 v[166:167], v152 offset:3592
v_mfma_f32_16x16x32_bf16 v[16:19], v[44:47], v[80:83], v[16:19]
ds_read_b128 v[196:199], v151 offset:0
ds_read_b64 v[168:169], v152 offset:3072
v_mfma_f32_16x16x32_bf16 v[20:23], v[44:47], v[84:87], v[20:23]
ds_read_b64 v[170:171], v152 offset:3080
v_mfma_f32_16x16x32_bf16 v[24:27], v[44:47], v[88:91], v[24:27]
ds_read_b128 v[200:203], v151 offset:4096
v_mfma_f32_16x16x32_bf16 v[16:19], v[48:51], v[76:79], v[16:19]
ds_read_b64 v[172:173], v152 offset:2560
v_mfma_f32_16x16x32_bf16 v[20:23], v[48:51], v[80:83], v[20:23]
ds_read_b64 v[174:175], v152 offset:2568
v_mfma_f32_16x16x32_bf16 v[24:27], v[48:51], v[84:87], v[24:27]
ds_read_b128 v[204:207], v151 offset:8192
v_mfma_f32_16x16x32_bf16 v[20:23], v[52:55], v[76:79], v[20:23]
ds_read_b64 v[176:177], v152 offset:2048
v_mfma_f32_16x16x32_bf16 v[24:27], v[52:55], v[80:83], v[24:27]
ds_read_b64 v[178:179], v152 offset:2056
v_mfma_f32_16x16x32_bf16 v[24:27], v[56:59], v[76:79], v[24:27]
ds_read_b128 v[208:211], v151 offset:12288
s_waitcnt lgkmcnt(0)
v_mfma_f32_16x16x32_bf16 v[12:15], v[164:167], v[196:199], v[12:15]
v_mfma_f32_16x16x32_bf16 v[16:19], v[164:167], v[200:203], v[16:19]
v_mfma_f32_16x16x32_bf16 v[20:23], v[164:167], v[204:207], v[20:23]
v_mfma_f32_16x16x32_bf16 v[24:27], v[164:167], v[208:211], v[24:27]
v_mfma_f32_16x16x32_bf16 v[16:19], v[168:171], v[196:199], v[16:19]
v_mfma_f32_16x16x32_bf16 v[20:23], v[168:171], v[200:203], v[20:23]
v_mfma_f32_16x16x32_bf16 v[24:27], v[168:171], v[204:207], v[24:27]
v_mfma_f32_16x16x32_bf16 v[20:23], v[172:175], v[196:199], v[20:23]
v_mfma_f32_16x16x32_bf16 v[24:27], v[172:175], v[200:203], v[24:27]
v_mfma_f32_16x16x32_bf16 v[24:27], v[176:179], v[196:199], v[24:27]
s_mov_b32 s70, 0x00003f80
s_mov_b32 s71, 0x3f800000
v_pk_add_f32 v[12:13], v[12:13], v[108:109]
v_pk_add_f32 v[14:15], v[14:15], v[110:111]
v_pk_add_f32 v[16:17], v[16:17], v[112:113]
v_pk_add_f32 v[18:19], v[18:19], v[114:115]
v_pk_add_f32 v[20:21], v[20:21], v[116:117]
v_pk_add_f32 v[22:23], v[22:23], v[118:119]
v_pk_add_f32 v[24:25], v[24:25], v[120:121]
v_pk_add_f32 v[26:27], v[26:27], v[122:123]
v_cvt_pk_bf16_f32 v84, v12, v13
v_cvt_pk_bf16_f32 v85, v14, v15
v_cvt_pk_bf16_f32 v86, v16, v17
v_cvt_pk_bf16_f32 v87, v18, v19
v_cvt_pk_bf16_f32 v88, v20, v21
v_cvt_pk_bf16_f32 v89, v22, v23
v_cvt_pk_bf16_f32 v90, v24, v25
v_cvt_pk_bf16_f32 v91, v26, v27
ds_write_b64 v154, v[84:85] offset:16640
ds_write_b64 v154, v[86:87] offset:17152
ds_write_b64 v154, v[88:89] offset:17664
ds_write_b64 v154, v[90:91] offset:18176
v_bfe_u32 v4, v2, 2, 2
v_mul_u32_u24 v4, 30272, v4
v_lshrrev_b32 v5, 4, v2
v_lshl_add_u32 v4, v5, 5, v4
v_and_b32 v7, 3, v2
v_lshl_add_u32 v4, v7, 3, v4
s_lshl_b32 s5, s4, 9
s_add_u32 s5, s5, 16640
v_add_u32 v4, s5, v4
v_mul_u32_u24 v5, 20480, v5
v_and_b32 v7, 15, v2
v_lshl_add_u32 v5, v7, 4, v5
s_mul_i32 s62, s4, 327680
s_lshr_b32 s6, s2, 3
s_lshl_b32 s6, s6, 10
s_add_u32 s62, s62, s6
s_bfe_u32 s6, s2, 0x20001
s_lshl_b32 s6, s6, 8
s_add_u32 s62, s62, s6
s_and_b32 s6, s2, 1
s_lshl_b32 s6, s6, 3
s_add_u32 s62, s62, s6
s_add_u32 s62, s62, 5242880
s_waitcnt lgkmcnt(0)
s_barrier
ds_read_b64_tr_b16 v[76:77], v4 offset:0
ds_read_b64_tr_b16 v[78:79], v4 offset:128
ds_read_b64_tr_b16 v[80:81], v4 offset:256
ds_read_b64_tr_b16 v[82:83], v4 offset:384
s_waitcnt lgkmcnt(3)
buffer_store_dwordx2 v[76:77], v5, s[12:15], s62 offen sc1
s_add_u32 s62, s62, 81920
s_waitcnt lgkmcnt(2)
buffer_store_dwordx2 v[78:79], v5, s[12:15], s62 offen sc1
s_add_u32 s62, s62, 81920
s_waitcnt lgkmcnt(1)
buffer_store_dwordx2 v[80:81], v5, s[12:15], s62 offen sc1
s_add_u32 s62, s62, 81920
s_waitcnt lgkmcnt(0)
buffer_store_dwordx2 v[82:83], v5, s[12:15], s62 offen sc1
ds_read_b64 v[44:45], v152 offset:4032
ds_read_b64 v[46:47], v152 offset:4040
ds_read_b128 v[76:79], v144 offset:0
ds_read_b64 v[48:49], v152 offset:3520
ds_read_b64 v[50:51], v152 offset:3528
ds_read_b128 v[80:83], v144 offset:4096
ds_read_b64 v[52:53], v152 offset:3008
ds_read_b64 v[54:55], v152 offset:3016
ds_read_b128 v[84:87], v144 offset:8192
ds_read_b64 v[56:57], v152 offset:2496
ds_read_b64 v[58:59], v152 offset:2504
ds_read_b128 v[88:91], v144 offset:12288
ds_read_b64 v[60:61], v152 offset:1984
ds_read_b64 v[62:63], v152 offset:1992
ds_read_b128 v[92:95], v144 offset:16384
ds_read_b64 v[64:65], v152 offset:1472
ds_read_b64 v[66:67], v152 offset:1480
ds_read_b128 v[96:99], v144 offset:20480
ds_read_b64 v[68:69], v152 offset:960
ds_read_b64 v[70:71], v152 offset:968
ds_read_b128 v[100:103], v144 offset:24576
ds_read_b64 v[72:73], v152 offset:448
ds_read_b64 v[74:75], v152 offset:456
ds_read_b128 v[104:107], v144 offset:28672
v_xor_b32 v4, 16, v153
s_waitcnt lgkmcnt(0)
v_mfma_f32_16x16x32_bf16 v[12:15], v[44:47], v[92:95], 0
ds_read_b64 v[110:111], v153 offset:16384
ds_read_b64 v[126:127], v4 offset:16384
v_mfma_f32_16x16x32_bf16 v[16:19], v[44:47], v[96:99], 0
ds_read_b64 v[114:115], v153 offset:20480
ds_read_b64 v[130:131], v4 offset:20480
v_mfma_f32_16x16x32_bf16 v[20:23], v[44:47], v[100:103], 0
ds_read_b64 v[118:119], v153 offset:24576
ds_read_b64 v[134:135], v4 offset:24576
v_mfma_f32_16x16x32_bf16 v[24:27], v[44:47], v[104:107], 0
ds_read_b64 v[122:123], v153 offset:28672
ds_read_b64 v[138:139], v4 offset:28672
v_mfma_f32_16x16x32_bf16 v[12:15], v[48:51], v[88:91], v[12:15]
ds_read_b64 v[164:165], v152 offset:3968
ds_read_b64 v[166:167], v152 offset:3976
v_mfma_f32_16x16x32_bf16 v[16:19], v[48:51], v[92:95], v[16:19]
ds_read_b128 v[196:199], v145 offset:0
ds_read_b64 v[168:169], v152 offset:3456
v_mfma_f32_16x16x32_bf16 v[20:23], v[48:51], v[96:99], v[20:23]
ds_read_b64 v[170:171], v152 offset:3464
v_mfma_f32_16x16x32_bf16 v[24:27], v[48:51], v[100:103], v[24:27]
ds_read_b128 v[200:203], v145 offset:4096
v_mfma_f32_16x16x32_bf16 v[12:15], v[52:55], v[84:87], v[12:15]
ds_read_b64 v[172:173], v152 offset:2944
v_mfma_f32_16x16x32_bf16 v[16:19], v[52:55], v[88:91], v[16:19]
ds_read_b64 v[174:175], v152 offset:2952
v_mfma_f32_16x16x32_bf16 v[20:23], v[52:55], v[92:95], v[20:23]
ds_read_b128 v[204:207], v145 offset:8192
v_mfma_f32_16x16x32_bf16 v[24:27], v[52:55], v[96:99], v[24:27]
ds_read_b64 v[176:177], v152 offset:2432
v_mfma_f32_16x16x32_bf16 v[12:15], v[56:59], v[80:83], v[12:15]
ds_read_b64 v[178:179], v152 offset:2440
v_mfma_f32_16x16x32_bf16 v[16:19], v[56:59], v[84:87], v[16:19]
ds_read_b128 v[208:211], v145 offset:12288
v_mfma_f32_16x16x32_bf16 v[20:23], v[56:59], v[88:91], v[20:23]
ds_read_b64 v[180:181], v152 offset:1920
v_mfma_f32_16x16x32_bf16 v[24:27], v[56:59], v[92:95], v[24:27]
ds_read_b64 v[182:183], v152 offset:1928
v_mfma_f32_16x16x32_bf16 v[12:15], v[60:63], v[76:79], v[12:15]
ds_read_b128 v[212:215], v145 offset:16384
v_mfma_f32_16x16x32_bf16 v[16:19], v[60:63], v[80:83], v[16:19]
ds_read_b64 v[184:185], v152 offset:1408
v_mfma_f32_16x16x32_bf16 v[20:23], v[60:63], v[84:87], v[20:23]
ds_read_b64 v[186:187], v152 offset:1416
v_mfma_f32_16x16x32_bf16 v[24:27], v[60:63], v[88:91], v[24:27]
ds_read_b128 v[216:219], v145 offset:20480
v_mfma_f32_16x16x32_bf16 v[16:19], v[64:67], v[76:79], v[16:19]
ds_read_b64 v[188:189], v152 offset:896
v_mfma_f32_16x16x32_bf16 v[20:23], v[64:67], v[80:83], v[20:23]
ds_read_b64 v[190:191], v152 offset:904
v_mfma_f32_16x16x32_bf16 v[24:27], v[64:67], v[84:87], v[24:27]
ds_read_b128 v[220:223], v145 offset:24576
v_mfma_f32_16x16x32_bf16 v[20:23], v[68:71], v[76:79], v[20:23]
ds_read_b64 v[192:193], v152 offset:384
v_mfma_f32_16x16x32_bf16 v[24:27], v[68:71], v[80:83], v[24:27]
ds_read_b64 v[194:195], v152 offset:392
v_mfma_f32_16x16x32_bf16 v[24:27], v[72:75], v[76:79], v[24:27]
ds_read_b128 v[224:227], v145 offset:28672
s_waitcnt lgkmcnt(0)
v_mfma_f32_16x16x32_bf16 v[12:15], v[164:167], v[212:215], v[12:15]
ds_read_b64 v[44:45], v152 offset:3904
v_lshlrev_b32 v108, 16, v110
v_mfma_f32_16x16x32_bf16 v[16:19], v[164:167], v[216:219], v[16:19]
ds_read_b64 v[46:47], v152 offset:3912
v_and_b32 v109, 0xffff0000, v110
v_mfma_f32_16x16x32_bf16 v[20:23], v[164:167], v[220:223], v[20:23]
ds_read_b128 v[76:79], v146 offset:0
v_lshlrev_b32 v110, 16, v111
v_mfma_f32_16x16x32_bf16 v[24:27], v[164:167], v[224:227], v[24:27]
ds_read_b64 v[48:49], v152 offset:3392
v_and_b32 v111, 0xffff0000, v111
v_mfma_f32_16x16x32_bf16 v[12:15], v[168:171], v[208:211], v[12:15]
ds_read_b64 v[50:51], v152 offset:3400
v_lshlrev_b32 v124, 16, v126
v_mfma_f32_16x16x32_bf16 v[16:19], v[168:171], v[212:215], v[16:19]
ds_read_b128 v[80:83], v146 offset:4096
v_and_b32 v125, 0xffff0000, v126
v_mfma_f32_16x16x32_bf16 v[20:23], v[168:171], v[216:219], v[20:23]
ds_read_b64 v[52:53], v152 offset:2880
v_lshlrev_b32 v126, 16, v127
v_mfma_f32_16x16x32_bf16 v[24:27], v[168:171], v[220:223], v[24:27]
ds_read_b64 v[54:55], v152 offset:2888
v_and_b32 v127, 0xffff0000, v127
v_mfma_f32_16x16x32_bf16 v[12:15], v[172:175], v[204:207], v[12:15]
ds_read_b128 v[84:87], v146 offset:8192
v_fma_f32 v108, v108, v6, v124
v_mfma_f32_16x16x32_bf16 v[16:19], v[172:175], v[208:211], v[16:19]
ds_read_b64 v[56:57], v152 offset:2368
v_fma_f32 v109, v109, v6, v125
v_mfma_f32_16x16x32_bf16 v[20:23], v[172:175], v[212:215], v[20:23]
ds_read_b64 v[58:59], v152 offset:2376
v_fma_f32 v110, v110, v6, v126
v_mfma_f32_16x16x32_bf16 v[24:27], v[172:175], v[216:219], v[24:27]
ds_read_b128 v[88:91], v146 offset:12288
v_fma_f32 v111, v111, v6, v127
v_mfma_f32_16x16x32_bf16 v[12:15], v[176:179], v[200:203], v[12:15]
ds_read_b64 v[60:61], v152 offset:1856
v_lshlrev_b32 v112, 16, v114
v_mfma_f32_16x16x32_bf16 v[16:19], v[176:179], v[204:207], v[16:19]
ds_read_b64 v[62:63], v152 offset:1864
v_and_b32 v113, 0xffff0000, v114
v_mfma_f32_16x16x32_bf16 v[20:23], v[176:179], v[208:211], v[20:23]
ds_read_b128 v[92:95], v146 offset:16384
v_lshlrev_b32 v114, 16, v115
v_mfma_f32_16x16x32_bf16 v[24:27], v[176:179], v[212:215], v[24:27]
ds_read_b64 v[64:65], v152 offset:1344
v_and_b32 v115, 0xffff0000, v115
v_mfma_f32_16x16x32_bf16 v[12:15], v[180:183], v[196:199], v[12:15]
ds_read_b64 v[66:67], v152 offset:1352
v_lshlrev_b32 v128, 16, v130
v_mfma_f32_16x16x32_bf16 v[16:19], v[180:183], v[200:203], v[16:19]
ds_read_b128 v[96:99], v146 offset:20480
v_and_b32 v129, 0xffff0000, v130
v_mfma_f32_16x16x32_bf16 v[20:23], v[180:183], v[204:207], v[20:23]
ds_read_b64 v[68:69], v152 offset:832
v_lshlrev_b32 v130, 16, v131
v_mfma_f32_16x16x32_bf16 v[24:27], v[180:183], v[208:211], v[24:27]
ds_read_b64 v[70:71], v152 offset:840
v_and_b32 v131, 0xffff0000, v131
v_mfma_f32_16x16x32_bf16 v[16:19], v[184:187], v[196:199], v[16:19]
ds_read_b128 v[100:103], v146 offset:24576
v_fma_f32 v112, v112, v6, v128
v_mfma_f32_16x16x32_bf16 v[20:23], v[184:187], v[200:203], v[20:23]
ds_read_b64 v[72:73], v152 offset:320
v_fma_f32 v113, v113, v6, v129
v_mfma_f32_16x16x32_bf16 v[24:27], v[184:187], v[204:207], v[24:27]
ds_read_b64 v[74:75], v152 offset:328
v_fma_f32 v114, v114, v6, v130
v_mfma_f32_16x16x32_bf16 v[20:23], v[188:191], v[196:199], v[20:23]
ds_read_b128 v[104:107], v146 offset:28672
v_fma_f32 v115, v115, v6, v131
v_mfma_f32_16x16x32_bf16 v[24:27], v[188:191], v[200:203], v[24:27]
v_lshlrev_b32 v116, 16, v118
v_mfma_f32_16x16x32_bf16 v[24:27], v[192:195], v[196:199], v[24:27]
v_and_b32 v117, 0xffff0000, v118
s_waitcnt vmcnt(0)
s_barrier
s_cmp_eq_u32 s4, 0
s_cbranch_scc0 Lsig_11
v_lshlrev_b32 v5, 10, v2
s_lshl_b32 s5, s2, 2
s_add_u32 s5, s5, 33566720
v_mov_b32 v4, s83
s_mov_b64 exec, 0xff
buffer_store_dword v4, v5, s[12:15], s5 offen sc1
s_mov_b64 exec, -1
Lsig_11:
s_waitcnt lgkmcnt(0)
v_mfma_f32_16x16x32_bf16 v[12:15], v[44:47], v[92:95], v[12:15]
ds_read_b64 v[164:165], v152 offset:3840
v_lshlrev_b32 v118, 16, v119
v_mfma_f32_16x16x32_bf16 v[16:19], v[44:47], v[96:99], v[16:19]
ds_read_b64 v[166:167], v152 offset:3848
v_and_b32 v119, 0xffff0000, v119
v_mfma_f32_16x16x32_bf16 v[20:23], v[44:47], v[100:103], v[20:23]
ds_read_b128 v[196:199], v147 offset:0
v_lshlrev_b32 v132, 16, v134
v_mfma_f32_16x16x32_bf16 v[24:27], v[44:47], v[104:107], v[24:27]
ds_read_b64 v[168:169], v152 offset:3328
v_and_b32 v133, 0xffff0000, v134
v_mfma_f32_16x16x32_bf16 v[12:15], v[48:51], v[88:91], v[12:15]
ds_read_b64 v[170:171], v152 offset:3336
v_lshlrev_b32 v134, 16, v135
v_mfma_f32_16x16x32_bf16 v[16:19], v[48:51], v[92:95], v[16:19]
ds_read_b128 v[200:203], v147 offset:4096
v_and_b32 v135, 0xffff0000, v135
v_mfma_f32_16x16x32_bf16 v[20:23], v[48:51], v[96:99], v[20:23]
ds_read_b64 v[172:173], v152 offset:2816
v_fma_f32 v116, v116, v6, v132
v_mfma_f32_16x16x32_bf16 v[24:27], v[48:51], v[100:103], v[24:27]
ds_read_b64 v[174:175], v152 offset:2824
v_fma_f32 v117, v117, v6, v133
v_mfma_f32_16x16x32_bf16 v[12:15], v[52:55], v[84:87], v[12:15]
ds_read_b128 v[204:207], v147 offset:8192
v_fma_f32 v118, v118, v6, v134
v_mfma_f32_16x16x32_bf16 v[16:19], v[52:55], v[88:91], v[16:19]
ds_read_b64 v[176:177], v152 offset:2304
v_fma_f32 v119, v119, v6, v135
v_mfma_f32_16x16x32_bf16 v[20:23], v[52:55], v[92:95], v[20:23]
ds_read_b64 v[178:179], v152 offset:2312
v_lshlrev_b32 v120, 16, v122
v_mfma_f32_16x16x32_bf16 v[24:27], v[52:55], v[96:99], v[24:27]
ds_read_b128 v[208:211], v147 offset:12288
v_and_b32 v121, 0xffff0000, v122
v_mfma_f32_16x16x32_bf16 v[12:15], v[56:59], v[80:83], v[12:15]
ds_read_b64 v[180:181], v152 offset:1792
v_lshlrev_b32 v122, 16, v123
v_mfma_f32_16x16x32_bf16 v[16:19], v[56:59], v[84:87], v[16:19]
ds_read_b64 v[182:183], v152 offset:1800
v_and_b32 v123, 0xffff0000, v123
v_mfma_f32_16x16x32_bf16 v[20:23], v[56:59], v[88:91], v[20:23]
ds_read_b128 v[212:215], v147 offset:16384
v_lshlrev_b32 v136, 16, v138
v_mfma_f32_16x16x32_bf16 v[24:27], v[56:59], v[92:95], v[24:27]
ds_read_b64 v[184:185], v152 offset:1280
v_and_b32 v137, 0xffff0000, v138
v_mfma_f32_16x16x32_bf16 v[12:15], v[60:63], v[76:79], v[12:15]
ds_read_b64 v[186:187], v152 offset:1288
v_lshlrev_b32 v138, 16, v139
v_mfma_f32_16x16x32_bf16 v[16:19], v[60:63], v[80:83], v[16:19]
ds_read_b128 v[216:219], v147 offset:20480
v_and_b32 v139, 0xffff0000, v139
v_mfma_f32_16x16x32_bf16 v[20:23], v[60:63], v[84:87], v[20:23]
ds_read_b64 v[188:189], v152 offset:768
v_fma_f32 v120, v120, v6, v136
v_mfma_f32_16x16x32_bf16 v[24:27], v[60:63], v[88:91], v[24:27]
ds_read_b64 v[190:191], v152 offset:776
v_fma_f32 v121, v121, v6, v137
v_mfma_f32_16x16x32_bf16 v[16:19], v[64:67], v[76:79], v[16:19]
ds_read_b128 v[220:223], v147 offset:24576
v_fma_f32 v122, v122, v6, v138
v_mfma_f32_16x16x32_bf16 v[20:23], v[64:67], v[80:83], v[20:23]
ds_read_b64 v[192:193], v152 offset:256
v_fma_f32 v123, v123, v6, v139
v_mfma_f32_16x16x32_bf16 v[24:27], v[64:67], v[84:87], v[24:27]
ds_read_b64 v[194:195], v152 offset:264
v_mfma_f32_16x16x32_bf16 v[20:23], v[68:71], v[76:79], v[20:23]
ds_read_b128 v[224:227], v147 offset:28672
v_mfma_f32_16x16x32_bf16 v[24:27], v[68:71], v[80:83], v[24:27]
v_mfma_f32_16x16x32_bf16 v[24:27], v[72:75], v[76:79], v[24:27]
s_mov_b32 s62, 0x0
s_mov_b32 s63, 0x1fffff00
s_mov_b32 s6, 0
s_waitcnt vmcnt(1)
s_branch Lpfc_13
Lpf_12:
s_sleep 2
v_lshlrev_b32 v7, 4, v2
s_and_b32 s5, s2, 7
s_lshl_b32 s5, s5, 10
s_add_u32 s5, s5, 33574912
buffer_load_dwordx4 v[8:11], v7, s[12:15], s5 offen sc1
s_waitcnt vmcnt(0)
Lpfc_13:
v_xor_b32 v8, s83, v8
v_xor_b32 v9, s83, v9
v_xor_b32 v10, s83, v10
v_xor_b32 v11, s83, v11
v_or_b32 v8, v8, v9
v_or3_b32 v8, v8, v10, v11
v_cmp_ne_u32 vcc, 0, v8
s_nop 0
s_and_b64 vcc, vcc, s[62:63]
s_cbranch_vccz Lpfd_14
s_add_u32 s6, s6, 1
s_cmp_lt_u32 s6, 0x40000
s_cbranch_scc1 Lpf_12
Lpfd_14:
v_lshlrev_b32 v35, 3, v2
s_mul_i32 s64, s67, 448
s_add_u32 s64, s64, 14680064
buffer_load_dwordx2 v[28:29], v35, s[12:15], s64 offen sc1
s_add_u32 s64, s64, 7168
buffer_load_dwordx2 v[30:31], v35, s[12:15], s64 offen sc1
s_add_u32 s64, s64, 7168
buffer_load_dwordx2 v[32:33], v35, s[12:15], s64 offen sc1
s_mov_b32 s48, s34
s_mov_b32 s49, s35
s_mov_b32 s50, 3456
s_mov_b32 s51, 0x20000
s_mul_i32 s64, s67, 216
v_lshlrev_b32 v36, 2, v2
buffer_load_dword v34, v36, s[48:51], s64 offen
s_waitcnt lgkmcnt(0)
v_mfma_f32_16x16x32_bf16 v[12:15], v[164:167], v[212:215], v[12:15]
ds_read_b64 v[44:45], v152 offset:3776
v_mfma_f32_16x16x32_bf16 v[16:19], v[164:167], v[216:219], v[16:19]
ds_read_b64 v[46:47], v152 offset:3784
v_mfma_f32_16x16x32_bf16 v[20:23], v[164:167], v[220:223], v[20:23]
ds_read_b128 v[76:79], v148 offset:0
v_mfma_f32_16x16x32_bf16 v[24:27], v[164:167], v[224:227], v[24:27]
ds_read_b64 v[48:49], v152 offset:3264
s_add_u32 m0, s75, 18688
s_add_u32 s5, s77, 0
buffer_load_dwordx4 v3, s[12:15], s5 offen sc1 lds
v_mfma_f32_16x16x32_bf16 v[12:15], v[168:171], v[208:211], v[12:15]
ds_read_b64 v[50:51], v152 offset:3272
v_mfma_f32_16x16x32_bf16 v[16:19], v[168:171], v[212:215], v[16:19]
ds_read_b128 v[80:83], v148 offset:4096
v_mfma_f32_16x16x32_bf16 v[20:23], v[168:171], v[216:219], v[20:23]
ds_read_b64 v[52:53], v152 offset:2752
v_mfma_f32_16x16x32_bf16 v[24:27], v[168:171], v[220:223], v[24:27]
ds_read_b64 v[54:55], v152 offset:2760
s_add_u32 s5, s79, 0
buffer_load_dwordx4 a[0:3], v3, s[12:15], s5 offen offset:0 sc1
v_mfma_f32_16x16x32_bf16 v[12:15], v[172:175], v[204:207], v[12:15]
ds_read_b128 v[84:87], v148 offset:8192
v_mfma_f32_16x16x32_bf16 v[16:19], v[172:175], v[208:211], v[16:19]
ds_read_b64 v[56:57], v152 offset:2240
v_mfma_f32_16x16x32_bf16 v[20:23], v[172:175], v[212:215], v[20:23]
ds_read_b64 v[58:59], v152 offset:2248
v_mfma_f32_16x16x32_bf16 v[24:27], v[172:175], v[216:219], v[24:27]
ds_read_b128 v[88:91], v148 offset:12288
s_add_u32 s5, s79, 0
buffer_load_dwordx4 a[4:7], v3, s[12:15], s5 offen offset:1024 sc1
v_mfma_f32_16x16x32_bf16 v[12:15], v[176:179], v[200:203], v[12:15]
ds_read_b64 v[60:61], v152 offset:1728
v_mfma_f32_16x16x32_bf16 v[16:19], v[176:179], v[204:207], v[16:19]
ds_read_b64 v[62:63], v152 offset:1736
v_mfma_f32_16x16x32_bf16 v[20:23], v[176:179], v[208:211], v[20:23]
ds_read_b128 v[92:95], v148 offset:16384
v_mfma_f32_16x16x32_bf16 v[24:27], v[176:179], v[212:215], v[24:27]
ds_read_b64 v[64:65], v152 offset:1216
s_add_u32 s5, s79, 0
buffer_load_dwordx4 a[8:11], v3, s[12:15], s5 offen offset:2048 sc1
v_mfma_f32_16x16x32_bf16 v[12:15], v[180:183], v[196:199], v[12:15]
ds_read_b64 v[66:67], v152 offset:1224
v_mfma_f32_16x16x32_bf16 v[16:19], v[180:183], v[200:203], v[16:19]
ds_read_b128 v[96:99], v148 offset:20480
v_mfma_f32_16x16x32_bf16 v[20:23], v[180:183], v[204:207], v[20:23]
ds_read_b64 v[68:69], v152 offset:704
v_mfma_f32_16x16x32_bf16 v[24:27], v[180:183], v[208:211], v[24:27]
ds_read_b64 v[70:71], v152 offset:712
s_add_u32 m0, s75, 19712
s_add_u32 s5, s77, 4096
buffer_load_dwordx4 v3, s[12:15], s5 offen sc1 lds
v_mfma_f32_16x16x32_bf16 v[16:19], v[184:187], v[196:199], v[16:19]
ds_read_b128 v[100:103], v148 offset:24576
v_mfma_f32_16x16x32_bf16 v[20:23], v[184:187], v[200:203], v[20:23]
ds_read_b64 v[72:73], v152 offset:192
v_mfma_f32_16x16x32_bf16 v[24:27], v[184:187], v[204:207], v[24:27]
ds_read_b64 v[74:75], v152 offset:200
v_mfma_f32_16x16x32_bf16 v[20:23], v[188:191], v[196:199], v[20:23]
ds_read_b128 v[104:107], v148 offset:28672
s_add_u32 s5, s79, 0
buffer_load_dwordx4 a[12:15], v3, s[12:15], s5 offen offset:3072 sc1
v_mfma_f32_16x16x32_bf16 v[24:27], v[188:191], v[200:203], v[24:27]
v_mfma_f32_16x16x32_bf16 v[24:27], v[192:195], v[196:199], v[24:27]
s_waitcnt lgkmcnt(0)
v_mfma_f32_16x16x32_bf16 v[12:15], v[44:47], v[92:95], v[12:15]
ds_read_b64 v[164:165], v152 offset:3712
v_mfma_f32_16x16x32_bf16 v[16:19], v[44:47], v[96:99], v[16:19]
ds_read_b64 v[166:167], v152 offset:3720
s_add_u32 s5, s79, 4096
buffer_load_dwordx4 a[16:19], v3, s[12:15], s5 offen offset:0 sc1
v_mfma_f32_16x16x32_bf16 v[20:23], v[44:47], v[100:103], v[20:23]
ds_read_b128 v[196:199], v149 offset:0
v_mfma_f32_16x16x32_bf16 v[24:27], v[44:47], v[104:107], v[24:27]
ds_read_b64 v[168:169], v152 offset:3200
v_mfma_f32_16x16x32_bf16 v[12:15], v[48:51], v[88:91], v[12:15]
ds_read_b64 v[170:171], v152 offset:3208
v_mfma_f32_16x16x32_bf16 v[16:19], v[48:51], v[92:95], v[16:19]
ds_read_b128 v[200:203], v149 offset:4096
s_add_u32 s5, s79, 4096
buffer_load_dwordx4 a[20:23], v3, s[12:15], s5 offen offset:1024 sc1
v_mfma_f32_16x16x32_bf16 v[20:23], v[48:51], v[96:99], v[20:23]
ds_read_b64 v[172:173], v152 offset:2688
v_mfma_f32_16x16x32_bf16 v[24:27], v[48:51], v[100:103], v[24:27]
ds_read_b64 v[174:175], v152 offset:2696
v_mfma_f32_16x16x32_bf16 v[12:15], v[52:55], v[84:87], v[12:15]
ds_read_b128 v[204:207], v149 offset:8192
v_mfma_f32_16x16x32_bf16 v[16:19], v[52:55], v[88:91], v[16:19]
ds_read_b64 v[176:177], v152 offset:2176
s_add_u32 m0, s75, 20736
s_add_u32 s5, s77, 8192
buffer_load_dwordx4 v3, s[12:15], s5 offen sc1 lds
v_mfma_f32_16x16x32_bf16 v[20:23], v[52:55], v[92:95], v[20:23]
ds_read_b64 v[178:179], v152 offset:2184
v_mfma_f32_16x16x32_bf16 v[24:27], v[52:55], v[96:99], v[24:27]
ds_read_b128 v[208:211], v149 offset:12288
v_mfma_f32_16x16x32_bf16 v[12:15], v[56:59], v[80:83], v[12:15]
ds_read_b64 v[180:181], v152 offset:1664
v_mfma_f32_16x16x32_bf16 v[16:19], v[56:59], v[84:87], v[16:19]
ds_read_b64 v[182:183], v152 offset:1672
s_add_u32 m0, s75, 21760
s_add_u32 s5, s77, 12288
buffer_load_dwordx4 v3, s[12:15], s5 offen sc1 lds
v_mfma_f32_16x16x32_bf16 v[20:23], v[56:59], v[88:91], v[20:23]
ds_read_b128 v[212:215], v149 offset:16384
v_mfma_f32_16x16x32_bf16 v[24:27], v[56:59], v[92:95], v[24:27]
ds_read_b64 v[184:185], v152 offset:1152
v_mfma_f32_16x16x32_bf16 v[12:15], v[60:63], v[76:79], v[12:15]
ds_read_b64 v[186:187], v152 offset:1160
v_mfma_f32_16x16x32_bf16 v[16:19], v[60:63], v[80:83], v[16:19]
ds_read_b128 v[216:219], v149 offset:20480
s_add_u32 m0, s75, 22784
s_add_u32 s5, s77, 16384
buffer_load_dwordx4 v3, s[12:15], s5 offen sc1 lds
v_mfma_f32_16x16x32_bf16 v[20:23], v[60:63], v[84:87], v[20:23]
ds_read_b64 v[188:189], v152 offset:640
v_mfma_f32_16x16x32_bf16 v[24:27], v[60:63], v[88:91], v[24:27]
ds_read_b64 v[190:191], v152 offset:648
v_mfma_f32_16x16x32_bf16 v[16:19], v[64:67], v[76:79], v[16:19]
ds_read_b128 v[220:223], v149 offset:24576
v_mfma_f32_16x16x32_bf16 v[20:23], v[64:67], v[80:83], v[20:23]
ds_read_b64 v[192:193], v152 offset:128
s_add_u32 m0, s75, 23808
s_add_u32 s5, s77, 20480
buffer_load_dwordx4 v3, s[12:15], s5 offen sc1 lds
v_mfma_f32_16x16x32_bf16 v[24:27], v[64:67], v[84:87], v[24:27]
ds_read_b64 v[194:195], v152 offset:136
v_mfma_f32_16x16x32_bf16 v[20:23], v[68:71], v[76:79], v[20:23]
ds_read_b128 v[224:227], v149 offset:28672
v_mfma_f32_16x16x32_bf16 v[24:27], v[68:71], v[80:83], v[24:27]
v_mfma_f32_16x16x32_bf16 v[24:27], v[72:75], v[76:79], v[24:27]
s_add_u32 m0, s75, 24832
s_add_u32 s5, s77, 24576
buffer_load_dwordx4 v3, s[12:15], s5 offen sc1 lds
s_waitcnt lgkmcnt(0)
v_mfma_f32_16x16x32_bf16 v[12:15], v[164:167], v[212:215], v[12:15]
ds_read_b64 v[44:45], v152 offset:3648
v_mfma_f32_16x16x32_bf16 v[16:19], v[164:167], v[216:219], v[16:19]
ds_read_b64 v[46:47], v152 offset:3656
v_mfma_f32_16x16x32_bf16 v[20:23], v[164:167], v[220:223], v[20:23]
ds_read_b128 v[76:79], v150 offset:0
v_mfma_f32_16x16x32_bf16 v[24:27], v[164:167], v[224:227], v[24:27]
ds_read_b64 v[48:49], v152 offset:3136
s_add_u32 m0, s75, 25856
s_add_u32 s5, s77, 28672
buffer_load_dwordx4 v3, s[12:15], s5 offen sc1 lds
v_mfma_f32_16x16x32_bf16 v[12:15], v[168:171], v[208:211], v[12:15]
ds_read_b64 v[50:51], v152 offset:3144
v_mfma_f32_16x16x32_bf16 v[16:19], v[168:171], v[212:215], v[16:19]
ds_read_b128 v[80:83], v150 offset:4096
v_mfma_f32_16x16x32_bf16 v[20:23], v[168:171], v[216:219], v[20:23]
ds_read_b64 v[52:53], v152 offset:2624
v_mfma_f32_16x16x32_bf16 v[24:27], v[168:171], v[220:223], v[24:27]
ds_read_b64 v[54:55], v152 offset:2632
s_add_u32 m0, s75, 26880
s_add_u32 s5, s77, 32768
buffer_load_dwordx4 v3, s[12:15], s5 offen sc1 lds
v_mfma_f32_16x16x32_bf16 v[12:15], v[172:175], v[204:207], v[12:15]
ds_read_b128 v[84:87], v150 offset:8192
v_mfma_f32_16x16x32_bf16 v[16:19], v[172:175], v[208:211], v[16:19]
ds_read_b64 v[56:57], v152 offset:2112
v_mfma_f32_16x16x32_bf16 v[20:23], v[172:175], v[212:215], v[20:23]
ds_read_b64 v[58:59], v152 offset:2120
v_mfma_f32_16x16x32_bf16 v[24:27], v[172:175], v[216:219], v[24:27]
ds_read_b128 v[88:91], v150 offset:12288
s_add_u32 m0, s75, 27904
s_add_u32 s5, s77, 36864
buffer_load_dwordx4 v3, s[12:15], s5 offen sc1 lds
v_mfma_f32_16x16x32_bf16 v[12:15], v[176:179], v[200:203], v[12:15]
ds_read_b64 v[60:61], v152 offset:1600
v_mfma_f32_16x16x32_bf16 v[16:19], v[176:179], v[204:207], v[16:19]
ds_read_b64 v[62:63], v152 offset:1608
v_mfma_f32_16x16x32_bf16 v[20:23], v[176:179], v[208:211], v[20:23]
ds_read_b128 v[92:95], v150 offset:16384
v_mfma_f32_16x16x32_bf16 v[24:27], v[176:179], v[212:215], v[24:27]
ds_read_b64 v[64:65], v152 offset:1088
s_add_u32 m0, s75, 28928
s_add_u32 s5, s77, 40960
buffer_load_dwordx4 v3, s[12:15], s5 offen sc1 lds
v_mfma_f32_16x16x32_bf16 v[12:15], v[180:183], v[196:199], v[12:15]
ds_read_b64 v[66:67], v152 offset:1096
v_mfma_f32_16x16x32_bf16 v[16:19], v[180:183], v[200:203], v[16:19]
ds_read_b128 v[96:99], v150 offset:20480
v_mfma_f32_16x16x32_bf16 v[20:23], v[180:183], v[204:207], v[20:23]
ds_read_b64 v[68:69], v152 offset:576
v_mfma_f32_16x16x32_bf16 v[24:27], v[180:183], v[208:211], v[24:27]
ds_read_b64 v[70:71], v152 offset:584
s_add_u32 m0, s82, 157952
s_add_u32 s5, s77, 45056
buffer_load_dwordx4 v3, s[12:15], s5 offen sc1 lds
v_mfma_f32_16x16x32_bf16 v[16:19], v[184:187], v[196:199], v[16:19]
ds_read_b128 v[100:103], v150 offset:24576
v_mfma_f32_16x16x32_bf16 v[20:23], v[184:187], v[200:203], v[20:23]
ds_read_b64 v[72:73], v152 offset:64
v_mfma_f32_16x16x32_bf16 v[24:27], v[184:187], v[204:207], v[24:27]
ds_read_b64 v[74:75], v152 offset:72
v_mfma_f32_16x16x32_bf16 v[20:23], v[188:191], v[196:199], v[20:23]
ds_read_b128 v[104:107], v150 offset:28672
v_mfma_f32_16x16x32_bf16 v[24:27], v[188:191], v[200:203], v[24:27]
v_mfma_f32_16x16x32_bf16 v[24:27], v[192:195], v[196:199], v[24:27]
v_lshlrev_b32 v7, 4, v2
s_and_b32 s5, s2, 7
s_lshl_b32 s5, s5, 10
s_add_u32 s5, s5, 33566720
buffer_load_dwordx4 v[8:11], v7, s[12:15], s5 offen sc1
s_waitcnt lgkmcnt(0)
v_mfma_f32_16x16x32_bf16 v[12:15], v[44:47], v[92:95], v[12:15]
ds_read_b64 v[164:165], v152 offset:3584
v_mfma_f32_16x16x32_bf16 v[16:19], v[44:47], v[96:99], v[16:19]
ds_read_b64 v[166:167], v152 offset:3592
v_mfma_f32_16x16x32_bf16 v[20:23], v[44:47], v[100:103], v[20:23]
ds_read_b128 v[196:199], v151 offset:0
v_mfma_f32_16x16x32_bf16 v[24:27], v[44:47], v[104:107], v[24:27]
ds_read_b64 v[168:169], v152 offset:3072
v_mfma_f32_16x16x32_bf16 v[12:15], v[48:51], v[88:91], v[12:15]
ds_read_b64 v[170:171], v152 offset:3080
v_mfma_f32_16x16x32_bf16 v[16:19], v[48:51], v[92:95], v[16:19]
ds_read_b128 v[200:203], v151 offset:4096
v_mfma_f32_16x16x32_bf16 v[20:23], v[48:51], v[96:99], v[20:23]
ds_read_b64 v[172:173], v152 offset:2560
v_mfma_f32_16x16x32_bf16 v[24:27], v[48:51], v[100:103], v[24:27]
ds_read_b64 v[174:175], v152 offset:2568
v_mfma_f32_16x16x32_bf16 v[12:15], v[52:55], v[84:87], v[12:15]
ds_read_b128 v[204:207], v151 offset:8192
v_mfma_f32_16x16x32_bf16 v[16:19], v[52:55], v[88:91], v[16:19]
ds_read_b64 v[176:177], v152 offset:2048
v_mfma_f32_16x16x32_bf16 v[20:23], v[52:55], v[92:95], v[20:23]
ds_read_b64 v[178:179], v152 offset:2056
v_mfma_f32_16x16x32_bf16 v[24:27], v[52:55], v[96:99], v[24:27]
ds_read_b128 v[208:211], v151 offset:12288
v_mfma_f32_16x16x32_bf16 v[12:15], v[56:59], v[80:83], v[12:15]
ds_read_b64 v[180:181], v152 offset:1536
v_mfma_f32_16x16x32_bf16 v[16:19], v[56:59], v[84:87], v[16:19]
ds_read_b64 v[182:183], v152 offset:1544
v_mfma_f32_16x16x32_bf16 v[20:23], v[56:59], v[88:91], v[20:23]
ds_read_b128 v[212:215], v151 offset:16384
v_mfma_f32_16x16x32_bf16 v[24:27], v[56:59], v[92:95], v[24:27]
ds_read_b64 v[184:185], v152 offset:1024
v_mfma_f32_16x16x32_bf16 v[12:15], v[60:63], v[76:79], v[12:15]
ds_read_b64 v[186:187], v152 offset:1032
v_mfma_f32_16x16x32_bf16 v[16:19], v[60:63], v[80:83], v[16:19]
ds_read_b128 v[216:219], v151 offset:20480
v_mfma_f32_16x16x32_bf16 v[20:23], v[60:63], v[84:87], v[20:23]
ds_read_b64 v[188:189], v152 offset:512
v_mfma_f32_16x16x32_bf16 v[24:27], v[60:63], v[88:91], v[24:27]
ds_read_b64 v[190:191], v152 offset:520
v_mfma_f32_16x16x32_bf16 v[16:19], v[64:67], v[76:79], v[16:19]
ds_read_b128 v[220:223], v151 offset:24576
v_mfma_f32_16x16x32_bf16 v[20:23], v[64:67], v[80:83], v[20:23]
ds_read_b64 v[192:193], v152 offset:0
v_mfma_f32_16x16x32_bf16 v[24:27], v[64:67], v[84:87], v[24:27]
ds_read_b64 v[194:195], v152 offset:8
v_mfma_f32_16x16x32_bf16 v[20:23], v[68:71], v[76:79], v[20:23]
ds_read_b128 v[224:227], v151 offset:28672
v_mfma_f32_16x16x32_bf16 v[24:27], v[68:71], v[80:83], v[24:27]
v_mfma_f32_16x16x32_bf16 v[24:27], v[72:75], v[76:79], v[24:27]
s_waitcnt lgkmcnt(0)
v_mfma_f32_16x16x32_bf16 v[12:15], v[164:167], v[212:215], v[12:15]
v_mfma_f32_16x16x32_bf16 v[16:19], v[164:167], v[216:219], v[16:19]
v_mfma_f32_16x16x32_bf16 v[20:23], v[164:167], v[220:223], v[20:23]
v_mfma_f32_16x16x32_bf16 v[24:27], v[164:167], v[224:227], v[24:27]
v_mfma_f32_16x16x32_bf16 v[12:15], v[168:171], v[208:211], v[12:15]
v_mfma_f32_16x16x32_bf16 v[16:19], v[168:171], v[212:215], v[16:19]
v_mfma_f32_16x16x32_bf16 v[20:23], v[168:171], v[216:219], v[20:23]
v_mfma_f32_16x16x32_bf16 v[24:27], v[168:171], v[220:223], v[24:27]
v_mfma_f32_16x16x32_bf16 v[12:15], v[172:175], v[204:207], v[12:15]
v_mfma_f32_16x16x32_bf16 v[16:19], v[172:175], v[208:211], v[16:19]
v_mfma_f32_16x16x32_bf16 v[20:23], v[172:175], v[212:215], v[20:23]
v_mfma_f32_16x16x32_bf16 v[24:27], v[172:175], v[216:219], v[24:27]
v_mfma_f32_16x16x32_bf16 v[12:15], v[176:179], v[200:203], v[12:15]
v_mfma_f32_16x16x32_bf16 v[16:19], v[176:179], v[204:207], v[16:19]
v_mfma_f32_16x16x32_bf16 v[20:23], v[176:179], v[208:211], v[20:23]
v_mfma_f32_16x16x32_bf16 v[24:27], v[176:179], v[212:215], v[24:27]
v_mfma_f32_16x16x32_bf16 v[12:15], v[180:183], v[196:199], v[12:15]
v_mfma_f32_16x16x32_bf16 v[16:19], v[180:183], v[200:203], v[16:19]
v_mfma_f32_16x16x32_bf16 v[20:23], v[180:183], v[204:207], v[20:23]
v_mfma_f32_16x16x32_bf16 v[24:27], v[180:183], v[208:211], v[24:27]
v_mfma_f32_16x16x32_bf16 v[16:19], v[184:187], v[196:199], v[16:19]
v_mfma_f32_16x16x32_bf16 v[20:23], v[184:187], v[200:203], v[20:23]
v_mfma_f32_16x16x32_bf16 v[24:27], v[184:187], v[204:207], v[24:27]
v_mfma_f32_16x16x32_bf16 v[20:23], v[188:191], v[196:199], v[20:23]
v_mfma_f32_16x16x32_bf16 v[24:27], v[188:191], v[200:203], v[24:27]
v_mfma_f32_16x16x32_bf16 v[24:27], v[192:195], v[196:199], v[24:27]
s_waitcnt vmcnt(0)
s_cmp_eq_u32 s4, 1
s_cbranch_scc0 Lsb_15
s_mov_b32 exec_hi, 0x00ffffff
v_pk_add_f32 v[28:29], v[28:29], v[30:31]
v_pk_add_f32 v[28:29], v[28:29], v[32:33]
v_lshlrev_b32 v30, 16, v34
v_and_b32 v31, 0xffff0000, v34
v_add_u32 v35, 162048, v35
ds_write_b64 v35, v[28:29]
ds_write_b64 v35, v[30:31] offset:448
s_mov_b64 exec, -1
Lsb_15:
s_mov_b32 s62, 0xffffffff
s_mov_b32 s63, 0xff
s_mov_b32 s7, 0
s_branch Lfc_17
Lfp_16:
s_sleep 1
v_lshlrev_b32 v7, 4, v2
s_and_b32 s5, s2, 7
s_lshl_b32 s5, s5, 10
s_add_u32 s5, s5, 33566720
buffer_load_dwordx4 v[8:11], v7, s[12:15], s5 offen sc1
s_waitcnt vmcnt(0)
Lfc_17:
v_xor_b32 v8, s83, v8
v_xor_b32 v9, s83, v9
v_xor_b32 v10, s83, v10
v_xor_b32 v11, s83, v11
v_or_b32 v8, v8, v9
v_or3_b32 v8, v8, v10, v11
v_cmp_ne_u32 vcc, 0, v8
s_nop 0
s_and_b64 vcc, vcc, s[62:63]
s_cbranch_vccz Lfd_18
s_add_u32 s7, s7, 1
s_cmp_lt_u32 s7, 0x40000
s_cbranch_scc1 Lfp_16
Lfd_18:
buffer_load_dwordx4 v[44:47], v3, s[12:15], s81 offen offset:0 sc1
buffer_load_dwordx4 v[48:51], v3, s[12:15], s81 offen offset:1024 sc1
buffer_load_dwordx4 v[52:55], v3, s[12:15], s81 offen offset:2048 sc1
buffer_load_dwordx4 v[56:59], v3, s[12:15], s81 offen offset:3072 sc1
s_add_u32 s5, s81, 4096
buffer_load_dwordx4 v[60:63], v3, s[12:15], s5 offen offset:0 sc1
s_add_u32 s5, s81, 4096
buffer_load_dwordx4 v[64:67], v3, s[12:15], s5 offen offset:1024 sc1
s_add_u32 s5, s81, 4096
buffer_load_dwordx4 v[68:71], v3, s[12:15], s5 offen offset:2048 sc1
s_add_u32 s5, s81, 4096
buffer_load_dwordx4 v[72:75], v3, s[12:15], s5 offen offset:3072 sc1
s_mov_b32 s70, 0x00003f80
s_mov_b32 s71, 0x3f800000
v_pk_add_f32 v[12:13], v[12:13], v[108:109]
v_pk_add_f32 v[14:15], v[14:15], v[110:111]
v_pk_add_f32 v[16:17], v[16:17], v[112:113]
v_pk_add_f32 v[18:19], v[18:19], v[114:115]
v_pk_add_f32 v[20:21], v[20:21], v[116:117]
v_pk_add_f32 v[22:23], v[22:23], v[118:119]
v_pk_add_f32 v[24:25], v[24:25], v[120:121]
v_pk_add_f32 v[26:27], v[26:27], v[122:123]
v_cvt_pk_bf16_f32 v84, v12, v13
v_cvt_pk_bf16_f32 v85, v14, v15
v_cvt_pk_bf16_f32 v86, v16, v17
v_cvt_pk_bf16_f32 v87, v18, v19
v_cvt_pk_bf16_f32 v88, v20, v21
v_cvt_pk_bf16_f32 v89, v22, v23
v_cvt_pk_bf16_f32 v90, v24, v25
v_cvt_pk_bf16_f32 v91, v26, v27
ds_write_b64 v154, v[84:85] offset:16640
ds_write_b64 v154, v[86:87] offset:17152
ds_write_b64 v154, v[88:89] offset:17664
ds_write_b64 v154, v[90:91] offset:18176
v_bfe_u32 v4, v2, 2, 2
v_mul_u32_u24 v4, 30272, v4
v_lshrrev_b32 v5, 4, v2
v_lshl_add_u32 v4, v5, 5, v4
v_and_b32 v7, 3, v2
v_lshl_add_u32 v4, v7, 3, v4
s_lshl_b32 s5, s4, 9
s_add_u32 s5, s5, 16640
v_add_u32 v4, s5, v4
v_mul_u32_u24 v5, 20480, v5
v_and_b32 v7, 15, v2
v_lshl_add_u32 v5, v7, 4, v5
s_mul_i32 s62, s4, 327680
s_lshr_b32 s6, s2, 3
s_lshl_b32 s6, s6, 10
s_add_u32 s62, s62, s6
s_bfe_u32 s6, s2, 0x20001
s_lshl_b32 s6, s6, 8
s_add_u32 s62, s62, s6
s_and_b32 s6, s2, 1
s_lshl_b32 s6, s6, 3
s_add_u32 s62, s62, s6
s_add_u32 s62, s62, 6553600
s_waitcnt lgkmcnt(0)
s_barrier
ds_read_b64_tr_b16 v[76:77], v4 offset:0
ds_read_b64_tr_b16 v[78:79], v4 offset:128
ds_read_b64_tr_b16 v[80:81], v4 offset:256
ds_read_b64_tr_b16 v[82:83], v4 offset:384
s_waitcnt lgkmcnt(3)
buffer_store_dwordx2 v[76:77], v5, s[12:15], s62 offen sc1
s_add_u32 s62, s62, 81920
s_waitcnt lgkmcnt(2)
buffer_store_dwordx2 v[78:79], v5, s[12:15], s62 offen sc1
s_add_u32 s62, s62, 81920
s_waitcnt lgkmcnt(1)
buffer_store_dwordx2 v[80:81], v5, s[12:15], s62 offen sc1
s_add_u32 s62, s62, 81920
s_waitcnt lgkmcnt(0)
buffer_store_dwordx2 v[82:83], v5, s[12:15], s62 offen sc1
s_branch Lp3_2
Laux_1:
s_getpc_b64 s[46:47]
Lcp_19_pc:
s_sub_u32 s46, s46, Lcp_19_pc-sequential_preLN__ssm_conv_s4d__dense_activation_squared_relu__prompt_kernel
s_subb_u32 s47, s47, 0
s_lshr_b32 s5, s2, 3
s_lshl_b32 s5, s5, 2
s_add_u32 s5, s5, s4
s_min_u32 s5, s5, (L_end_f-sequential_preLN__ssm_conv_s4d__dense_activation_squared_relu__prompt_kernel)/1024-1
s_lshl_b32 s5, s5, 10
v_lshlrev_b32 v97, 4, v2
v_add_u32 v97, s5, v97
global_load_dwordx4 v[232:235], v97, s[46:47]
v_mul_u32_u24 v6, 2624, v3
v_lshl_add_u32 v6, v4, 4, v6
s_mov_b32 s80, 0
s_waitcnt vmcnt(2)
s_sub_u32 s60, s2, 160
s_cmp_lt_u32 s60, 48
s_cbranch_scc0 Lpw2_20
s_mov_b32 s48, s32
s_mov_b32 s49, s33
s_mov_b32 s50, 2211840
s_mov_b32 s51, 0x20000
v_mul_u32_u24 v94, 4682, v2
v_lshrrev_b32 v94, 16, v94
v_mul_u32_u24 v95, 14, v94
v_sub_u32 v95, v2, v95
v_mul_u32_u24 v94, 3456, v94
v_lshl_add_u32 v94, v95, 4, v94
s_mul_i32 s64, s60, 21846
s_lshr_b32 s64, s64, 16
s_mul_i32 s65, s64, 3
s_sub_u32 s65, s60, s65
s_mul_i32 s62, s65, 7
s_lshl_b32 s61, s4, 1
s_add_u32 s62, s62, s61
s_mul_i32 s63, s65, 7
s_add_u32 s63, s63, 7
s_min_u32 s63, s63, 20
s_sub_u32 s63, s63, s62
s_min_i32 s63, s63, 2
s_mul_i32 s6, s62, 110592
s_mul_i32 s7, s64, 216
s_add_u32 s6, s6, s7
s_mul_i32 s61, s61, 7168
s_add_u32 s61, s61, 24576
s_mov_b32 m0, s61
s_mov_b32 exec_hi, 0x00ffffff
s_cmp_lt_i32 s63, 1
s_cbranch_scc1 Lpk0_23
buffer_load_dwordx4 v94, s[48:51], s6 offen lds
s_add_u32 m0, m0, 896
s_add_u32 s6, s6, 13824
buffer_load_dwordx4 v94, s[48:51], s6 offen lds
s_add_u32 m0, m0, 896
s_add_u32 s6, s6, 13824
buffer_load_dwordx4 v94, s[48:51], s6 offen lds
s_add_u32 m0, m0, 896
s_add_u32 s6, s6, 13824
buffer_load_dwordx4 v94, s[48:51], s6 offen lds
s_add_u32 m0, m0, 896
s_add_u32 s6, s6, 13824
buffer_load_dwordx4 v94, s[48:51], s6 offen lds
s_add_u32 m0, m0, 896
s_add_u32 s6, s6, 13824
buffer_load_dwordx4 v94, s[48:51], s6 offen lds
s_add_u32 m0, m0, 896
s_add_u32 s6, s6, 13824
buffer_load_dwordx4 v94, s[48:51], s6 offen lds
s_add_u32 m0, m0, 896
s_add_u32 s6, s6, 13824
buffer_load_dwordx4 v94, s[48:51], s6 offen lds
s_add_u32 m0, m0, 896
s_add_u32 s6, s6, 13824
s_cmp_lt_i32 s63, 2
s_cbranch_scc1 Lpk8_24
buffer_load_dwordx4 v94, s[48:51], s6 offen lds
s_add_u32 m0, m0, 896
s_add_u32 s6, s6, 13824
buffer_load_dwordx4 v94, s[48:51], s6 offen lds
s_add_u32 m0, m0, 896
s_add_u32 s6, s6, 13824
buffer_load_dwordx4 v94, s[48:51], s6 offen lds
s_add_u32 m0, m0, 896
s_add_u32 s6, s6, 13824
buffer_load_dwordx4 v94, s[48:51], s6 offen lds
s_add_u32 m0, m0, 896
s_add_u32 s6, s6, 13824
buffer_load_dwordx4 v94, s[48:51], s6 offen lds
s_add_u32 m0, m0, 896
s_add_u32 s6, s6, 13824
buffer_load_dwordx4 v94, s[48:51], s6 offen lds
s_add_u32 m0, m0, 896
s_add_u32 s6, s6, 13824
buffer_load_dwordx4 v94, s[48:51], s6 offen lds
s_add_u32 m0, m0, 896
s_add_u32 s6, s6, 13824
buffer_load_dwordx4 v94, s[48:51], s6 offen lds
s_waitcnt vmcnt(16)
s_branch Lpk_25
Lpk8_24:
s_waitcnt vmcnt(8)
s_branch Lpk_25
Lpk0_23:
s_waitcnt vmcnt(0)
Lpk_25:
s_mov_b64 exec, -1
s_branch Lpdone_21
Lpw2_20:
s_cmp_lt_u32 s60, 83
s_cbranch_scc0 Lpnone_22
s_sub_u32 s5, s60, 48
s_lshl_b32 s5, s5, 2
s_add_u32 s5, s5, s4
s_mul_i32 s61, s5, 4682
s_lshr_b32 s61, s61, 16
s_mul_i32 s6, s61, 14
s_sub_u32 s62, s5, s6
s_mov_b32 s48, s36
s_mov_b32 s49, s37
s_mov_b32 s50, 2211840
s_mov_b32 s51, 0x20000
v_lshrrev_b32 v94, 3, v2
v_mul_u32_u24 v94, 1280, v94
v_and_b32 v95, 7, v2
v_lshl_add_u32 v94, v95, 4, v94
s_lshl_b32 s63, s4, 14
s_add_u32 s63, s63, 24576
s_mov_b32 m0, s63
s_lshl_b32 s64, s62, 2
s_add_u32 s64, s64, 0
s_mul_i32 s65, s64, 9363
s_lshr_b32 s65, s65, 16
s_mul_i32 s66, s65, 7
s_sub_u32 s66, s64, s66
s_lshl_b32 s67, s65, 1
s_lshl_b32 s68, s66, 1
s_add_u32 s68, s68, 0
s_sub_u32 s69, s68, 8
s_add_u32 s70, s67, 1
s_cmp_gt_u32 s66, 3
s_cselect_b32 s67, s70, s67
s_cselect_b32 s68, s69, s68
s_lshl_b32 s69, s65, 1
s_add_u32 s69, s69, 0
s_cmp_eq_u32 s66, 3
s_cselect_b32 s67, s69, s67
s_cselect_b32 s68, 6, s68
s_mul_i32 s67, s67, 108
s_lshl_b32 s68, s68, 4
s_add_u32 s67, s67, s68
s_mul_i32 s67, s67, 1280
s_lshl_b32 s68, s61, 7
s_add_u32 s67, s67, s68
buffer_load_dwordx4 v94, s[48:51], s67 offen lds
s_add_u32 m0, m0, 1024
s_add_u32 s67, s67, 10240
buffer_load_dwordx4 v94, s[48:51], s67 offen lds
s_add_u32 m0, m0, 1024
s_lshl_b32 s67, s65, 1
s_lshl_b32 s68, s66, 1
s_add_u32 s68, s68, 1
s_sub_u32 s69, s68, 8
s_add_u32 s70, s67, 1
s_cmp_gt_u32 s66, 3
s_cselect_b32 s67, s70, s67
s_cselect_b32 s68, s69, s68
s_lshl_b32 s69, s65, 1
s_add_u32 s69, s69, 1
s_cmp_eq_u32 s66, 3
s_cselect_b32 s67, s69, s67
s_cselect_b32 s68, 6, s68
s_mul_i32 s67, s67, 108
s_lshl_b32 s68, s68, 4
s_add_u32 s67, s67, s68
s_mul_i32 s67, s67, 1280
s_lshl_b32 s68, s61, 7
s_add_u32 s67, s67, s68
buffer_load_dwordx4 v94, s[48:51], s67 offen lds
s_add_u32 m0, m0, 1024
s_add_u32 s67, s67, 10240
buffer_load_dwordx4 v94, s[48:51], s67 offen lds
s_add_u32 m0, m0, 1024
s_lshl_b32 s64, s62, 2
s_add_u32 s64, s64, 1
s_mul_i32 s65, s64, 9363
s_lshr_b32 s65, s65, 16
s_mul_i32 s66, s65, 7
s_sub_u32 s66, s64, s66
s_lshl_b32 s67, s65, 1
s_lshl_b32 s68, s66, 1
s_add_u32 s68, s68, 0
s_sub_u32 s69, s68, 8
s_add_u32 s70, s67, 1
s_cmp_gt_u32 s66, 3
s_cselect_b32 s67, s70, s67
s_cselect_b32 s68, s69, s68
s_lshl_b32 s69, s65, 1
s_add_u32 s69, s69, 0
s_cmp_eq_u32 s66, 3
s_cselect_b32 s67, s69, s67
s_cselect_b32 s68, 6, s68
s_mul_i32 s67, s67, 108
s_lshl_b32 s68, s68, 4
s_add_u32 s67, s67, s68
s_mul_i32 s67, s67, 1280
s_lshl_b32 s68, s61, 7
s_add_u32 s67, s67, s68
buffer_load_dwordx4 v94, s[48:51], s67 offen lds
s_add_u32 m0, m0, 1024
s_add_u32 s67, s67, 10240
buffer_load_dwordx4 v94, s[48:51], s67 offen lds
s_add_u32 m0, m0, 1024
s_lshl_b32 s67, s65, 1
s_lshl_b32 s68, s66, 1
s_add_u32 s68, s68, 1
s_sub_u32 s69, s68, 8
s_add_u32 s70, s67, 1
s_cmp_gt_u32 s66, 3
s_cselect_b32 s67, s70, s67
s_cselect_b32 s68, s69, s68
s_lshl_b32 s69, s65, 1
s_add_u32 s69, s69, 1
s_cmp_eq_u32 s66, 3
s_cselect_b32 s67, s69, s67
s_cselect_b32 s68, 6, s68
s_mul_i32 s67, s67, 108
s_lshl_b32 s68, s68, 4
s_add_u32 s67, s67, s68
s_mul_i32 s67, s67, 1280
s_lshl_b32 s68, s61, 7
s_add_u32 s67, s67, s68
buffer_load_dwordx4 v94, s[48:51], s67 offen lds
s_add_u32 m0, m0, 1024
s_add_u32 s67, s67, 10240
buffer_load_dwordx4 v94, s[48:51], s67 offen lds
s_add_u32 m0, m0, 1024
s_lshl_b32 s64, s62, 2
s_add_u32 s64, s64, 2
s_mul_i32 s65, s64, 9363
s_lshr_b32 s65, s65, 16
s_mul_i32 s66, s65, 7
s_sub_u32 s66, s64, s66
s_lshl_b32 s67, s65, 1
s_lshl_b32 s68, s66, 1
s_add_u32 s68, s68, 0
s_sub_u32 s69, s68, 8
s_add_u32 s70, s67, 1
s_cmp_gt_u32 s66, 3
s_cselect_b32 s67, s70, s67
s_cselect_b32 s68, s69, s68
s_lshl_b32 s69, s65, 1
s_add_u32 s69, s69, 0
s_cmp_eq_u32 s66, 3
s_cselect_b32 s67, s69, s67
s_cselect_b32 s68, 6, s68
s_mul_i32 s67, s67, 108
s_lshl_b32 s68, s68, 4
s_add_u32 s67, s67, s68
s_mul_i32 s67, s67, 1280
s_lshl_b32 s68, s61, 7
s_add_u32 s67, s67, s68
buffer_load_dwordx4 v94, s[48:51], s67 offen lds
s_add_u32 m0, m0, 1024
s_add_u32 s67, s67, 10240
buffer_load_dwordx4 v94, s[48:51], s67 offen lds
s_add_u32 m0, m0, 1024
s_lshl_b32 s67, s65, 1
s_lshl_b32 s68, s66, 1
s_add_u32 s68, s68, 1
s_sub_u32 s69, s68, 8
s_add_u32 s70, s67, 1
s_cmp_gt_u32 s66, 3
s_cselect_b32 s67, s70, s67
s_cselect_b32 s68, s69, s68
s_lshl_b32 s69, s65, 1
s_add_u32 s69, s69, 1
s_cmp_eq_u32 s66, 3
s_cselect_b32 s67, s69, s67
s_cselect_b32 s68, 6, s68
s_mul_i32 s67, s67, 108
s_lshl_b32 s68, s68, 4
s_add_u32 s67, s67, s68
s_mul_i32 s67, s67, 1280
s_lshl_b32 s68, s61, 7
s_add_u32 s67, s67, s68
buffer_load_dwordx4 v94, s[48:51], s67 offen lds
s_add_u32 m0, m0, 1024
s_add_u32 s67, s67, 10240
buffer_load_dwordx4 v94, s[48:51], s67 offen lds
s_add_u32 m0, m0, 1024
s_lshl_b32 s64, s62, 2
s_add_u32 s64, s64, 3
s_mul_i32 s65, s64, 9363
s_lshr_b32 s65, s65, 16
s_mul_i32 s66, s65, 7
s_sub_u32 s66, s64, s66
s_lshl_b32 s67, s65, 1
s_lshl_b32 s68, s66, 1
s_add_u32 s68, s68, 0
s_sub_u32 s69, s68, 8
s_add_u32 s70, s67, 1
s_cmp_gt_u32 s66, 3
s_cselect_b32 s67, s70, s67
s_cselect_b32 s68, s69, s68
s_lshl_b32 s69, s65, 1
s_add_u32 s69, s69, 0
s_cmp_eq_u32 s66, 3
s_cselect_b32 s67, s69, s67
s_cselect_b32 s68, 6, s68
s_mul_i32 s67, s67, 108
s_lshl_b32 s68, s68, 4
s_add_u32 s67, s67, s68
s_mul_i32 s67, s67, 1280
s_lshl_b32 s68, s61, 7
s_add_u32 s67, s67, s68
buffer_load_dwordx4 v94, s[48:51], s67 offen lds
s_add_u32 m0, m0, 1024
s_add_u32 s67, s67, 10240
buffer_load_dwordx4 v94, s[48:51], s67 offen lds
s_add_u32 m0, m0, 1024
s_lshl_b32 s67, s65, 1
s_lshl_b32 s68, s66, 1
s_add_u32 s68, s68, 1
s_sub_u32 s69, s68, 8
s_add_u32 s70, s67, 1
s_cmp_gt_u32 s66, 3
s_cselect_b32 s67, s70, s67
s_cselect_b32 s68, s69, s68
s_lshl_b32 s69, s65, 1
s_add_u32 s69, s69, 1
s_cmp_eq_u32 s66, 3
s_cselect_b32 s67, s69, s67
s_cselect_b32 s68, 6, s68
s_mul_i32 s67, s67, 108
s_lshl_b32 s68, s68, 4
s_add_u32 s67, s67, s68
s_mul_i32 s67, s67, 1280
s_lshl_b32 s68, s61, 7
s_add_u32 s67, s67, s68
buffer_load_dwordx4 v94, s[48:51], s67 offen lds
s_add_u32 m0, m0, 1024
s_add_u32 s67, s67, 10240
buffer_load_dwordx4 v94, s[48:51], s67 offen lds
s_add_u32 m0, m0, 1024
s_waitcnt vmcnt(16)
s_branch Lpdone_21
Lpnone_22:
s_waitcnt vmcnt(0)
Lpdone_21:
Llnl_26:
v_lshlrev_b32 v20, 16, v8
v_and_b32 v21, 0xffff0000, v8
v_lshlrev_b32 v22, 16, v9
v_and_b32 v23, 0xffff0000, v9
v_lshlrev_b32 v24, 16, v10
v_and_b32 v25, 0xffff0000, v10
v_lshlrev_b32 v26, 16, v11
v_and_b32 v27, 0xffff0000, v11
v_lshlrev_b32 v28, 16, v12
v_and_b32 v29, 0xffff0000, v12
v_lshlrev_b32 v30, 16, v13
v_and_b32 v31, 0xffff0000, v13
v_lshlrev_b32 v32, 16, v14
v_and_b32 v33, 0xffff0000, v14
v_lshlrev_b32 v34, 16, v15
v_and_b32 v35, 0xffff0000, v15
v_lshlrev_b32 v36, 16, v16
v_and_b32 v37, 0xffff0000, v16
v_lshlrev_b32 v38, 16, v17
v_and_b32 v39, 0xffff0000, v17
v_pk_add_f32 v[40:41], v[20:21], v[22:23]
v_pk_add_f32 v[42:43], v[24:25], v[26:27]
v_pk_add_f32 v[40:41], v[40:41], v[28:29]
v_pk_add_f32 v[42:43], v[42:43], v[30:31]
v_pk_add_f32 v[40:41], v[40:41], v[32:33]
v_pk_add_f32 v[42:43], v[42:43], v[34:35]
v_pk_add_f32 v[40:41], v[40:41], v[36:37]
v_pk_add_f32 v[42:43], v[42:43], v[38:39]
v_pk_add_f32 v[40:41], v[40:41], v[42:43]
v_add_f32 v40, v40, v41
s_nop 1
v_add_f32_dpp v40, v40, v40 row_ror:8 row_mask:0xf bank_mask:0xf
s_nop 1
v_add_f32_dpp v40, v40, v40 row_ror:4 row_mask:0xf bank_mask:0xf
s_nop 1
v_add_f32_dpp v40, v40, v40 row_ror:2 row_mask:0xf bank_mask:0xf
s_nop 1
v_add_f32_dpp v40, v40, v40 row_ror:1 row_mask:0xf bank_mask:0xf
v_mov_b32 v41, v40
s_nop 1
v_permlane16_swap_b32 v40, v41
v_add_f32 v40, v40, v41
v_mul_f32 v40, 0x3acccccd, v40
v_mov_b32 v41, v40
v_pk_add_f32 v[48:49], v[20:21], v[40:41] neg_lo:[0,1] neg_hi:[0,1]
v_pk_add_f32 v[50:51], v[22:23], v[40:41] neg_lo:[0,1] neg_hi:[0,1]
v_pk_add_f32 v[52:53], v[24:25], v[40:41] neg_lo:[0,1] neg_hi:[0,1]
v_pk_add_f32 v[54:55], v[26:27], v[40:41] neg_lo:[0,1] neg_hi:[0,1]
v_pk_add_f32 v[56:57], v[28:29], v[40:41] neg_lo:[0,1] neg_hi:[0,1]
v_pk_add_f32 v[58:59], v[30:31], v[40:41] neg_lo:[0,1] neg_hi:[0,1]
v_pk_add_f32 v[60:61], v[32:33], v[40:41] neg_lo:[0,1] neg_hi:[0,1]
v_pk_add_f32 v[62:63], v[34:35], v[40:41] neg_lo:[0,1] neg_hi:[0,1]
v_pk_add_f32 v[64:65], v[36:37], v[40:41] neg_lo:[0,1] neg_hi:[0,1]
v_pk_add_f32 v[66:67], v[38:39], v[40:41] neg_lo:[0,1] neg_hi:[0,1]
v_pk_mul_f32 v[42:43], v[48:49], v[48:49]
v_pk_mul_f32 v[44:45], v[50:51], v[50:51]
v_pk_fma_f32 v[42:43], v[52:53], v[52:53], v[42:43]
v_pk_fma_f32 v[44:45], v[54:55], v[54:55], v[44:45]
v_pk_fma_f32 v[42:43], v[56:57], v[56:57], v[42:43]
v_pk_fma_f32 v[44:45], v[58:59], v[58:59], v[44:45]
v_pk_fma_f32 v[42:43], v[60:61], v[60:61], v[42:43]
v_pk_fma_f32 v[44:45], v[62:63], v[62:63], v[44:45]
v_pk_fma_f32 v[42:43], v[64:65], v[64:65], v[42:43]
v_pk_fma_f32 v[44:45], v[66:67], v[66:67], v[44:45]
v_pk_add_f32 v[42:43], v[42:43], v[44:45]
v_add_f32 v42, v42, v43
s_nop 1
v_add_f32_dpp v42, v42, v42 row_ror:8 row_mask:0xf bank_mask:0xf
s_nop 1
v_add_f32_dpp v42, v42, v42 row_ror:4 row_mask:0xf bank_mask:0xf
s_nop 1
v_add_f32_dpp v42, v42, v42 row_ror:2 row_mask:0xf bank_mask:0xf
s_nop 1
v_add_f32_dpp v42, v42, v42 row_ror:1 row_mask:0xf bank_mask:0xf
v_mov_b32 v43, v42
s_nop 1
v_permlane16_swap_b32 v42, v43
v_add_f32 v42, v42, v43
v_mul_f32 v42, 0x3acccccd, v42
v_cvt_pk_bf16_f32 v42, v42, v40
v_and_b32 v40, 0xffff0000, v42
v_lshlrev_b32 v42, 16, v42
v_mov_b32 v41, v40
v_add_f32 v42, 0x3727c5ac, v42
v_cvt_pk_bf16_f32 v42, v42, v42
v_and_b32 v42, 0xffff0000, v42
v_sqrt_f32 v42, v42
s_nop 0
v_cvt_pk_bf16_f32 v42, v42, v42
v_and_b32 v42, 0xffff0000, v42
v_rcp_f32 v42, v42
s_nop 0
v_mov_b32 v43, v42
v_pk_add_f32 v[48:49], v[20:21], v[40:41] neg_lo:[0,1] neg_hi:[0,1]
v_pk_add_f32 v[50:51], v[22:23], v[40:41] neg_lo:[0,1] neg_hi:[0,1]
v_pk_add_f32 v[52:53], v[24:25], v[40:41] neg_lo:[0,1] neg_hi:[0,1]
v_pk_add_f32 v[54:55], v[26:27], v[40:41] neg_lo:[0,1] neg_hi:[0,1]
v_pk_add_f32 v[56:57], v[28:29], v[40:41] neg_lo:[0,1] neg_hi:[0,1]
v_pk_add_f32 v[58:59], v[30:31], v[40:41] neg_lo:[0,1] neg_hi:[0,1]
v_pk_add_f32 v[60:61], v[32:33], v[40:41] neg_lo:[0,1] neg_hi:[0,1]
v_pk_add_f32 v[62:63], v[34:35], v[40:41] neg_lo:[0,1] neg_hi:[0,1]
v_pk_add_f32 v[64:65], v[36:37], v[40:41] neg_lo:[0,1] neg_hi:[0,1]
v_pk_add_f32 v[66:67], v[38:39], v[40:41] neg_lo:[0,1] neg_hi:[0,1]
v_cvt_pk_bf16_f32 v68, v48, v49
v_cvt_pk_bf16_f32 v69, v50, v51
v_cvt_pk_bf16_f32 v70, v52, v53
v_cvt_pk_bf16_f32 v71, v54, v55
v_cvt_pk_bf16_f32 v72, v56, v57
v_cvt_pk_bf16_f32 v73, v58, v59
v_cvt_pk_bf16_f32 v74, v60, v61
v_cvt_pk_bf16_f32 v75, v62, v63
v_cvt_pk_bf16_f32 v76, v64, v65
v_cvt_pk_bf16_f32 v77, v66, v67
v_lshlrev_b32 v48, 16, v68
v_and_b32 v49, 0xffff0000, v68
v_lshlrev_b32 v50, 16, v69
v_and_b32 v51, 0xffff0000, v69
v_lshlrev_b32 v52, 16, v70
v_and_b32 v53, 0xffff0000, v70
v_lshlrev_b32 v54, 16, v71
v_and_b32 v55, 0xffff0000, v71
v_lshlrev_b32 v56, 16, v72
v_and_b32 v57, 0xffff0000, v72
v_lshlrev_b32 v58, 16, v73
v_and_b32 v59, 0xffff0000, v73
v_lshlrev_b32 v60, 16, v74
v_and_b32 v61, 0xffff0000, v74
v_lshlrev_b32 v62, 16, v75
v_and_b32 v63, 0xffff0000, v75
v_lshlrev_b32 v64, 16, v76
v_and_b32 v65, 0xffff0000, v76
v_lshlrev_b32 v66, 16, v77
v_and_b32 v67, 0xffff0000, v77
v_pk_mul_f32 v[48:49], v[48:49], v[42:43]
v_pk_mul_f32 v[50:51], v[50:51], v[42:43]
v_pk_mul_f32 v[52:53], v[52:53], v[42:43]
v_pk_mul_f32 v[54:55], v[54:55], v[42:43]
v_pk_mul_f32 v[56:57], v[56:57], v[42:43]
v_pk_mul_f32 v[58:59], v[58:59], v[42:43]
v_pk_mul_f32 v[60:61], v[60:61], v[42:43]
v_pk_mul_f32 v[62:63], v[62:63], v[42:43]
v_pk_mul_f32 v[64:65], v[64:65], v[42:43]
v_pk_mul_f32 v[66:67], v[66:67], v[42:43]
v_cvt_pk_bf16_f32 v48, v48, v20
v_cvt_pk_bf16_f32 v49, v49, v21
v_cvt_pk_bf16_f32 v50, v50, v22
v_cvt_pk_bf16_f32 v51, v51, v23
v_cvt_pk_bf16_f32 v52, v52, v24
v_cvt_pk_bf16_f32 v53, v53, v25
v_cvt_pk_bf16_f32 v54, v54, v26
v_cvt_pk_bf16_f32 v55, v55, v27
v_cvt_pk_bf16_f32 v56, v56, v28
v_cvt_pk_bf16_f32 v57, v57, v29
v_cvt_pk_bf16_f32 v58, v58, v30
v_cvt_pk_bf16_f32 v59, v59, v31
v_cvt_pk_bf16_f32 v60, v60, v32
v_cvt_pk_bf16_f32 v61, v61, v33
v_cvt_pk_bf16_f32 v62, v62, v34
v_cvt_pk_bf16_f32 v63, v63, v35
v_cvt_pk_bf16_f32 v64, v64, v36
v_cvt_pk_bf16_f32 v65, v65, v37
v_cvt_pk_bf16_f32 v66, v66, v38
v_cvt_pk_bf16_f32 v67, v67, v39
ds_write_b128 v6, v[48:51] offset:0
ds_write_b128 v6, v[52:55] offset:512
ds_write_b128 v6, v[56:59] offset:1024
ds_write_b128 v6, v[60:63] offset:1536
ds_write_b128 v6, v[64:67] offset:2048
v_bfe_u32 v7, v2, 2, 2
v_mul_u32_u24 v7, 2624, v7
v_lshrrev_b32 v6, 4, v2
v_lshl_add_u32 v7, v6, 5, v7
v_and_b32 v6, 3, v2
v_lshl_add_u32 v7, v6, 3, v7
s_lshl_b32 s3, s4, 7
v_add_u32 v7, s3, v7
v_lshlrev_b32 v6, 4, v2
s_lshl_b32 s3, s4, 10
v_add_u32 v6, s3, v6
s_mul_i32 s3, s82, 20480
s_mov_b32 s80, 0
s_waitcnt lgkmcnt(0)
s_barrier
Llns_27:
ds_read_b64_tr_b16 v[68:69], v7 offset:0
ds_read_b64_tr_b16 v[70:71], v7 offset:10496
ds_read_b64_tr_b16 v[72:73], v7 offset:512
ds_read_b64_tr_b16 v[74:75], v7 offset:11008
ds_read_b64_tr_b16 v[76:77], v7 offset:1024
ds_read_b64_tr_b16 v[78:79], v7 offset:11520
ds_read_b64_tr_b16 v[80:81], v7 offset:1536
ds_read_b64_tr_b16 v[82:83], v7 offset:12032
ds_read_b64_tr_b16 v[84:85], v7 offset:2048
ds_read_b64_tr_b16 v[86:87], v7 offset:12544
s_mov_b32 s5, s3
s_waitcnt lgkmcnt(8)
buffer_store_dwordx4 v[68:71], v6, s[12:15], s5 offen sc1
s_add_u32 s5, s5, 4096
s_waitcnt lgkmcnt(6)
buffer_store_dwordx4 v[72:75], v6, s[12:15], s5 offen sc1
s_add_u32 s5, s5, 4096
s_waitcnt lgkmcnt(4)
buffer_store_dwordx4 v[76:79], v6, s[12:15], s5 offen sc1
s_add_u32 s5, s5, 4096
s_waitcnt lgkmcnt(2)
buffer_store_dwordx4 v[80:83], v6, s[12:15], s5 offen sc1
s_add_u32 s5, s5, 4096
s_waitcnt lgkmcnt(0)
buffer_store_dwordx4 v[84:87], v6, s[12:15], s5 offen sc1
s_waitcnt vmcnt(0)
v_readfirstlane_b32 s83, v96
s_nop 0
s_add_u32 s83, s83, 1
s_waitcnt vmcnt(0) lgkmcnt(0)
s_barrier
s_cmp_eq_u32 s4, 0
s_cbranch_scc0 Lsig_28
v_lshlrev_b32 v5, 10, v2
s_lshl_b32 s5, s2, 2
s_add_u32 s5, s5, 33558528
v_mov_b32 v4, s83
s_mov_b64 exec, 0xff
buffer_store_dword v4, v5, s[12:15], s5 offen sc1
s_mov_b64 exec, -1
Lsig_28:
s_waitcnt vmcnt(0)
v_lshrrev_b32 v90, 4, v2
v_bfe_u32 v91, v2, 2, 2
v_and_b32 v92, 3, v2
v_lshlrev_b32 v93, 4, v2
s_cmp_lt_u32 s60, 48
s_cbranch_scc0 Lqw2_29
v_lshl_add_u32 v94, v90, 3, v91
v_mul_u32_u24 v94, 224, v94
v_lshl_add_u32 v94, v92, 3, v94
v_add_u32 v94, s61, v94
s_mov_b32 s70, 0x3f803f80
v_and_b32 v95, 15, v2
v_cmp_lt_u32 s[68:69], 11, v95
v_cmp_eq_u32 vcc, 12, v95
v_mov_b32 v96, 0
v_mov_b32 v97, s70
v_cndmask_b32 v96, v96, v97, vcc
s_mul_i32 s66, s64, 143360
s_mul_i32 s67, s62, 7168
s_add_u32 s66, s66, s67
s_add_u32 s66, s66, 8388608
v_mov_b32 v120, 0
v_mov_b32 v121, 0
v_mov_b32 v122, 0
v_mov_b32 v123, 0
v_mov_b32 v124, 0
v_mov_b32 v125, 0
v_mov_b32 v126, 0
s_cmp_lt_i32 s63, 1
s_cbranch_scc1 Lk3_31
ds_read_b64_tr_b16 v[128:129], v94 offset:0
ds_read_b64_tr_b16 v[130:131], v94 offset:896
ds_read_b64_tr_b16 v[132:133], v94 offset:32
ds_read_b64_tr_b16 v[134:135], v94 offset:928
ds_read_b64_tr_b16 v[136:137], v94 offset:64
ds_read_b64_tr_b16 v[138:139], v94 offset:960
ds_read_b64_tr_b16 v[140:141], v94 offset:96
ds_read_b64_tr_b16 v[142:143], v94 offset:992
ds_read_b64_tr_b16 v[144:145], v94 offset:128
ds_read_b64_tr_b16 v[146:147], v94 offset:1024
ds_read_b64_tr_b16 v[148:149], v94 offset:160
ds_read_b64_tr_b16 v[150:151], v94 offset:1056
ds_read_b64_tr_b16 v[152:153], v94 offset:192
ds_read_b64_tr_b16 v[154:155], v94 offset:1088
s_add_u32 s67, s66, 0
s_waitcnt lgkmcnt(12)
buffer_store_dwordx4 v[128:131], v93, s[12:15], s67 offen offset:0 sc1
v_dot2_f32_bf16 v120, v128, s70, v120
v_dot2_f32_bf16 v120, v129, s70, v120
v_dot2_f32_bf16 v120, v130, s70, v120
v_dot2_f32_bf16 v120, v131, s70, v120
s_waitcnt lgkmcnt(10)
buffer_store_dwordx4 v[132:135], v93, s[12:15], s67 offen offset:1024 sc1
v_dot2_f32_bf16 v121, v132, s70, v121
v_dot2_f32_bf16 v121, v133, s70, v121
v_dot2_f32_bf16 v121, v134, s70, v121
v_dot2_f32_bf16 v121, v135, s70, v121
s_waitcnt lgkmcnt(8)
buffer_store_dwordx4 v[136:139], v93, s[12:15], s67 offen offset:2048 sc1
v_dot2_f32_bf16 v122, v136, s70, v122
v_dot2_f32_bf16 v122, v137, s70, v122
v_dot2_f32_bf16 v122, v138, s70, v122
v_dot2_f32_bf16 v122, v139, s70, v122
s_waitcnt lgkmcnt(6)
buffer_store_dwordx4 v[140:143], v93, s[12:15], s67 offen offset:3072 sc1
v_dot2_f32_bf16 v123, v140, s70, v123
v_dot2_f32_bf16 v123, v141, s70, v123
v_dot2_f32_bf16 v123, v142, s70, v123
v_dot2_f32_bf16 v123, v143, s70, v123
s_waitcnt lgkmcnt(4)
s_add_u32 s67, s67, 4096
buffer_store_dwordx4 v[144:147], v93, s[12:15], s67 offen offset:0 sc1
v_dot2_f32_bf16 v124, v144, s70, v124
v_dot2_f32_bf16 v124, v145, s70, v124
v_dot2_f32_bf16 v124, v146, s70, v124
v_dot2_f32_bf16 v124, v147, s70, v124
s_waitcnt lgkmcnt(2)
buffer_store_dwordx4 v[148:151], v93, s[12:15], s67 offen offset:1024 sc1
v_dot2_f32_bf16 v125, v148, s70, v125
v_dot2_f32_bf16 v125, v149, s70, v125
v_dot2_f32_bf16 v125, v150, s70, v125
v_dot2_f32_bf16 v125, v151, s70, v125
s_waitcnt lgkmcnt(0)
v_cndmask_b32 v152, v152, v96, s[68:69]
v_cndmask_b32 v153, v153, v96, s[68:69]
v_cndmask_b32 v154, v154, v96, s[68:69]
v_cndmask_b32 v155, v155, v96, s[68:69]
buffer_store_dwordx4 v[152:155], v93, s[12:15], s67 offen offset:2048 sc1
v_dot2_f32_bf16 v126, v152, s70, v126
v_dot2_f32_bf16 v126, v153, s70, v126
v_dot2_f32_bf16 v126, v154, s70, v126
v_dot2_f32_bf16 v126, v155, s70, v126
s_cmp_lt_i32 s63, 2
s_cbranch_scc1 Lk3_31
ds_read_b64_tr_b16 v[128:129], v94 offset:7168
ds_read_b64_tr_b16 v[130:131], v94 offset:8064
ds_read_b64_tr_b16 v[132:133], v94 offset:7200
ds_read_b64_tr_b16 v[134:135], v94 offset:8096
ds_read_b64_tr_b16 v[136:137], v94 offset:7232
ds_read_b64_tr_b16 v[138:139], v94 offset:8128
ds_read_b64_tr_b16 v[140:141], v94 offset:7264
ds_read_b64_tr_b16 v[142:143], v94 offset:8160
ds_read_b64_tr_b16 v[144:145], v94 offset:7296
ds_read_b64_tr_b16 v[146:147], v94 offset:8192
ds_read_b64_tr_b16 v[148:149], v94 offset:7328
ds_read_b64_tr_b16 v[150:151], v94 offset:8224
ds_read_b64_tr_b16 v[152:153], v94 offset:7360
ds_read_b64_tr_b16 v[154:155], v94 offset:8256
s_add_u32 s67, s66, 7168
s_waitcnt lgkmcnt(12)
buffer_store_dwordx4 v[128:131], v93, s[12:15], s67 offen offset:0 sc1
v_dot2_f32_bf16 v120, v128, s70, v120
v_dot2_f32_bf16 v120, v129, s70, v120
v_dot2_f32_bf16 v120, v130, s70, v120
v_dot2_f32_bf16 v120, v131, s70, v120
s_waitcnt lgkmcnt(10)
buffer_store_dwordx4 v[132:135], v93, s[12:15], s67 offen offset:1024 sc1
v_dot2_f32_bf16 v121, v132, s70, v121
v_dot2_f32_bf16 v121, v133, s70, v121
v_dot2_f32_bf16 v121, v134, s70, v121
v_dot2_f32_bf16 v121, v135, s70, v121
s_waitcnt lgkmcnt(8)
buffer_store_dwordx4 v[136:139], v93, s[12:15], s67 offen offset:2048 sc1
v_dot2_f32_bf16 v122, v136, s70, v122
v_dot2_f32_bf16 v122, v137, s70, v122
v_dot2_f32_bf16 v122, v138, s70, v122
v_dot2_f32_bf16 v122, v139, s70, v122
s_waitcnt lgkmcnt(6)
buffer_store_dwordx4 v[140:143], v93, s[12:15], s67 offen offset:3072 sc1
v_dot2_f32_bf16 v123, v140, s70, v123
v_dot2_f32_bf16 v123, v141, s70, v123
v_dot2_f32_bf16 v123, v142, s70, v123
v_dot2_f32_bf16 v123, v143, s70, v123
s_waitcnt lgkmcnt(4)
s_add_u32 s67, s67, 4096
buffer_store_dwordx4 v[144:147], v93, s[12:15], s67 offen offset:0 sc1
v_dot2_f32_bf16 v124, v144, s70, v124
v_dot2_f32_bf16 v124, v145, s70, v124
v_dot2_f32_bf16 v124, v146, s70, v124
v_dot2_f32_bf16 v124, v147, s70, v124
s_waitcnt lgkmcnt(2)
buffer_store_dwordx4 v[148:151], v93, s[12:15], s67 offen offset:1024 sc1
v_dot2_f32_bf16 v125, v148, s70, v125
v_dot2_f32_bf16 v125, v149, s70, v125
v_dot2_f32_bf16 v125, v150, s70, v125
v_dot2_f32_bf16 v125, v151, s70, v125
s_waitcnt lgkmcnt(0)
v_cndmask_b32 v152, v152, v96, s[68:69]
v_cndmask_b32 v153, v153, v96, s[68:69]
v_cndmask_b32 v154, v154, v96, s[68:69]
v_cndmask_b32 v155, v155, v96, s[68:69]
buffer_store_dwordx4 v[152:155], v93, s[12:15], s67 offen offset:2048 sc1
v_dot2_f32_bf16 v126, v152, s70, v126
v_dot2_f32_bf16 v126, v153, s70, v126
v_dot2_f32_bf16 v126, v154, s70, v126
v_dot2_f32_bf16 v126, v155, s70, v126
Lk3_31:
v_mov_b32 v98, v120
s_nop 1
v_permlane16_swap_b32 v120, v98
v_add_f32 v120, v120, v98
v_mov_b32 v98, v120
s_nop 1
v_permlane32_swap_b32 v120, v98
v_add_f32 v120, v120, v98
v_mov_b32 v98, v121
s_nop 1
v_permlane16_swap_b32 v121, v98
v_add_f32 v121, v121, v98
v_mov_b32 v98, v121
s_nop 1
v_permlane32_swap_b32 v121, v98
v_add_f32 v121, v121, v98
v_mov_b32 v98, v122
s_nop 1
v_permlane16_swap_b32 v122, v98
v_add_f32 v122, v122, v98
v_mov_b32 v98, v122
s_nop 1
v_permlane32_swap_b32 v122, v98
v_add_f32 v122, v122, v98
v_mov_b32 v98, v123
s_nop 1
v_permlane16_swap_b32 v123, v98
v_add_f32 v123, v123, v98
v_mov_b32 v98, v123
s_nop 1
v_permlane32_swap_b32 v123, v98
v_add_f32 v123, v123, v98
v_mov_b32 v98, v124
s_nop 1
v_permlane16_swap_b32 v124, v98
v_add_f32 v124, v124, v98
v_mov_b32 v98, v124
s_nop 1
v_permlane32_swap_b32 v124, v98
v_add_f32 v124, v124, v98
v_mov_b32 v98, v125
s_nop 1
v_permlane16_swap_b32 v125, v98
v_add_f32 v125, v125, v98
v_mov_b32 v98, v125
s_nop 1
v_permlane32_swap_b32 v125, v98
v_add_f32 v125, v125, v98
v_mov_b32 v98, v126
s_nop 1
v_permlane16_swap_b32 v126, v98
v_add_f32 v126, v126, v98
v_mov_b32 v98, v126
s_nop 1
v_permlane32_swap_b32 v126, v98
v_add_f32 v126, v126, v98
v_lshlrev_b32 v98, 2, v95
s_mul_i32 s66, s4, 448
s_add_u32 s66, s66, 81920
v_add_u32 v97, s66, v98
ds_write_b32 v97, v120 offset:0
ds_write_b32 v97, v121 offset:64
ds_write_b32 v97, v122 offset:128
ds_write_b32 v97, v123 offset:192
ds_write_b32 v97, v124 offset:256
ds_write_b32 v97, v125 offset:320
ds_write_b32 v97, v126 offset:384
s_waitcnt lgkmcnt(0)
s_barrier
v_lshlrev_b32 v97, 2, v0
v_add_u32 v98, 81920, v97
ds_read_b32 v120, v98 offset:0
ds_read_b32 v121, v98 offset:448
ds_read_b32 v122, v98 offset:896
ds_read_b32 v123, v98 offset:1344
s_mul_i32 s66, s64, 448
s_mul_i32 s67, s65, 7168
s_add_u32 s66, s66, s67
s_add_u32 s66, s66, 14680064
s_waitcnt lgkmcnt(0)
v_add_f32 v120, v120, v121
v_add_f32 v122, v122, v123
v_add_f32 v120, v120, v122
v_cmp_gt_u32 vcc, 112, v0
s_nop 0
s_and_saveexec_b64 s[68:69], vcc
s_cbranch_execz Lsp_32
buffer_store_dword v120, v97, s[12:15], s66 offen sc1
Lsp_32:
s_mov_b64 exec, s[68:69]
s_branch Lqdone_30
Lqw2_29:
s_cmp_lt_u32 s60, 83
s_cbranch_scc0 Lqdone_30
v_lshl_add_u32 v94, v90, 2, v91
v_lshlrev_b32 v94, 7, v94
v_lshl_add_u32 v94, v92, 3, v94
v_add_u32 v94, s63, v94
v_cmp_eq_u32 s[68:69], 3, v90
s_lshl_b32 s64, s62, 2
s_add_u32 s64, s64, 0
s_mul_i32 s65, s64, 9363
s_lshr_b32 s65, s65, 16
s_mul_i32 s66, s65, 7
s_sub_u32 s66, s64, s66
ds_read_b64_tr_b16 v[100:101], v94 offset:0
ds_read_b64_tr_b16 v[102:103], v94 offset:2048
ds_read_b64_tr_b16 v[104:105], v94 offset:32
ds_read_b64_tr_b16 v[106:107], v94 offset:2080
ds_read_b64_tr_b16 v[108:109], v94 offset:64
ds_read_b64_tr_b16 v[110:111], v94 offset:2112
ds_read_b64_tr_b16 v[112:113], v94 offset:96
ds_read_b64_tr_b16 v[114:115], v94 offset:2144
s_waitcnt lgkmcnt(0)
s_cmp_eq_u32 s66, 3
s_cbranch_scc0 Lnz_33
v_cndmask_b32 v100, v100, 0, s[68:69]
v_cndmask_b32 v101, v101, 0, s[68:69]
v_cndmask_b32 v102, v102, 0, s[68:69]
v_cndmask_b32 v103, v103, 0, s[68:69]
v_cndmask_b32 v104, v104, 0, s[68:69]
v_cndmask_b32 v105, v105, 0, s[68:69]
v_cndmask_b32 v106, v106, 0, s[68:69]
v_cndmask_b32 v107, v107, 0, s[68:69]
v_cndmask_b32 v108, v108, 0, s[68:69]
v_cndmask_b32 v109, v109, 0, s[68:69]
v_cndmask_b32 v110, v110, 0, s[68:69]
v_cndmask_b32 v111, v111, 0, s[68:69]
v_cndmask_b32 v112, v112, 0, s[68:69]
v_cndmask_b32 v113, v113, 0, s[68:69]
v_cndmask_b32 v114, v114, 0, s[68:69]
v_cndmask_b32 v115, v115, 0, s[68:69]
Lnz_33:
s_lshl_b32 s65, s61, 2
s_add_u32 s65, s65, 0
s_mul_i32 s67, s65, 13108
s_lshr_b32 s67, s67, 16
s_mul_i32 s70, s67, 5
s_sub_u32 s70, s65, s70
s_mul_i32 s67, s67, 56
s_add_u32 s67, s67, s64
s_mul_i32 s67, s67, 5
s_add_u32 s67, s67, s70
s_lshl_b32 s67, s67, 10
s_add_u32 s67, s67, 11534336
buffer_store_dwordx4 v[100:103], v93, s[12:15], s67 offen sc1
s_lshl_b32 s65, s61, 2
s_add_u32 s65, s65, 1
s_mul_i32 s67, s65, 13108
s_lshr_b32 s67, s67, 16
s_mul_i32 s70, s67, 5
s_sub_u32 s70, s65, s70
s_mul_i32 s67, s67, 56
s_add_u32 s67, s67, s64
s_mul_i32 s67, s67, 5
s_add_u32 s67, s67, s70
s_lshl_b32 s67, s67, 10
s_add_u32 s67, s67, 11534336
buffer_store_dwordx4 v[104:107], v93, s[12:15], s67 offen sc1
s_lshl_b32 s65, s61, 2
s_add_u32 s65, s65, 2
s_mul_i32 s67, s65, 13108
s_lshr_b32 s67, s67, 16
s_mul_i32 s70, s67, 5
s_sub_u32 s70, s65, s70
s_mul_i32 s67, s67, 56
s_add_u32 s67, s67, s64
s_mul_i32 s67, s67, 5
s_add_u32 s67, s67, s70
s_lshl_b32 s67, s67, 10
s_add_u32 s67, s67, 11534336
buffer_store_dwordx4 v[108:111], v93, s[12:15], s67 offen sc1
s_lshl_b32 s65, s61, 2
s_add_u32 s65, s65, 3
s_mul_i32 s67, s65, 13108
s_lshr_b32 s67, s67, 16
s_mul_i32 s70, s67, 5
s_sub_u32 s70, s65, s70
s_mul_i32 s67, s67, 56
s_add_u32 s67, s67, s64
s_mul_i32 s67, s67, 5
s_add_u32 s67, s67, s70
s_lshl_b32 s67, s67, 10
s_add_u32 s67, s67, 11534336
buffer_store_dwordx4 v[112:115], v93, s[12:15], s67 offen sc1
s_lshl_b32 s64, s62, 2
s_add_u32 s64, s64, 1
s_mul_i32 s65, s64, 9363
s_lshr_b32 s65, s65, 16
s_mul_i32 s66, s65, 7
s_sub_u32 s66, s64, s66
ds_read_b64_tr_b16 v[116:117], v94 offset:4096
ds_read_b64_tr_b16 v[118:119], v94 offset:6144
ds_read_b64_tr_b16 v[120:121], v94 offset:4128
ds_read_b64_tr_b16 v[122:123], v94 offset:6176
ds_read_b64_tr_b16 v[124:125], v94 offset:4160
ds_read_b64_tr_b16 v[126:127], v94 offset:6208
ds_read_b64_tr_b16 v[128:129], v94 offset:4192
ds_read_b64_tr_b16 v[130:131], v94 offset:6240
s_waitcnt lgkmcnt(0)
s_cmp_eq_u32 s66, 3
s_cbranch_scc0 Lnz_34
v_cndmask_b32 v116, v116, 0, s[68:69]
v_cndmask_b32 v117, v117, 0, s[68:69]
v_cndmask_b32 v118, v118, 0, s[68:69]
v_cndmask_b32 v119, v119, 0, s[68:69]
v_cndmask_b32 v120, v120, 0, s[68:69]
v_cndmask_b32 v121, v121, 0, s[68:69]
v_cndmask_b32 v122, v122, 0, s[68:69]
v_cndmask_b32 v123, v123, 0, s[68:69]
v_cndmask_b32 v124, v124, 0, s[68:69]
v_cndmask_b32 v125, v125, 0, s[68:69]
v_cndmask_b32 v126, v126, 0, s[68:69]
v_cndmask_b32 v127, v127, 0, s[68:69]
v_cndmask_b32 v128, v128, 0, s[68:69]
v_cndmask_b32 v129, v129, 0, s[68:69]
v_cndmask_b32 v130, v130, 0, s[68:69]
v_cndmask_b32 v131, v131, 0, s[68:69]
Lnz_34:
s_lshl_b32 s65, s61, 2
s_add_u32 s65, s65, 0
s_mul_i32 s67, s65, 13108
s_lshr_b32 s67, s67, 16
s_mul_i32 s70, s67, 5
s_sub_u32 s70, s65, s70
s_mul_i32 s67, s67, 56
s_add_u32 s67, s67, s64
s_mul_i32 s67, s67, 5
s_add_u32 s67, s67, s70
s_lshl_b32 s67, s67, 10
s_add_u32 s67, s67, 11534336
buffer_store_dwordx4 v[116:119], v93, s[12:15], s67 offen sc1
s_lshl_b32 s65, s61, 2
s_add_u32 s65, s65, 1
s_mul_i32 s67, s65, 13108
s_lshr_b32 s67, s67, 16
s_mul_i32 s70, s67, 5
s_sub_u32 s70, s65, s70
s_mul_i32 s67, s67, 56
s_add_u32 s67, s67, s64
s_mul_i32 s67, s67, 5
s_add_u32 s67, s67, s70
s_lshl_b32 s67, s67, 10
s_add_u32 s67, s67, 11534336
buffer_store_dwordx4 v[120:123], v93, s[12:15], s67 offen sc1
s_lshl_b32 s65, s61, 2
s_add_u32 s65, s65, 2
s_mul_i32 s67, s65, 13108
s_lshr_b32 s67, s67, 16
s_mul_i32 s70, s67, 5
s_sub_u32 s70, s65, s70
s_mul_i32 s67, s67, 56
s_add_u32 s67, s67, s64
s_mul_i32 s67, s67, 5
s_add_u32 s67, s67, s70
s_lshl_b32 s67, s67, 10
s_add_u32 s67, s67, 11534336
buffer_store_dwordx4 v[124:127], v93, s[12:15], s67 offen sc1
s_lshl_b32 s65, s61, 2
s_add_u32 s65, s65, 3
s_mul_i32 s67, s65, 13108
s_lshr_b32 s67, s67, 16
s_mul_i32 s70, s67, 5
s_sub_u32 s70, s65, s70
s_mul_i32 s67, s67, 56
s_add_u32 s67, s67, s64
s_mul_i32 s67, s67, 5
s_add_u32 s67, s67, s70
s_lshl_b32 s67, s67, 10
s_add_u32 s67, s67, 11534336
buffer_store_dwordx4 v[128:131], v93, s[12:15], s67 offen sc1
s_lshl_b32 s64, s62, 2
s_add_u32 s64, s64, 2
s_mul_i32 s65, s64, 9363
s_lshr_b32 s65, s65, 16
s_mul_i32 s66, s65, 7
s_sub_u32 s66, s64, s66
ds_read_b64_tr_b16 v[100:101], v94 offset:8192
ds_read_b64_tr_b16 v[102:103], v94 offset:10240
ds_read_b64_tr_b16 v[104:105], v94 offset:8224
ds_read_b64_tr_b16 v[106:107], v94 offset:10272
ds_read_b64_tr_b16 v[108:109], v94 offset:8256
ds_read_b64_tr_b16 v[110:111], v94 offset:10304
ds_read_b64_tr_b16 v[112:113], v94 offset:8288
ds_read_b64_tr_b16 v[114:115], v94 offset:10336
s_waitcnt lgkmcnt(0)
s_cmp_eq_u32 s66, 3
s_cbranch_scc0 Lnz_35
v_cndmask_b32 v100, v100, 0, s[68:69]
v_cndmask_b32 v101, v101, 0, s[68:69]
v_cndmask_b32 v102, v102, 0, s[68:69]
v_cndmask_b32 v103, v103, 0, s[68:69]
v_cndmask_b32 v104, v104, 0, s[68:69]
v_cndmask_b32 v105, v105, 0, s[68:69]
v_cndmask_b32 v106, v106, 0, s[68:69]
v_cndmask_b32 v107, v107, 0, s[68:69]
v_cndmask_b32 v108, v108, 0, s[68:69]
v_cndmask_b32 v109, v109, 0, s[68:69]
v_cndmask_b32 v110, v110, 0, s[68:69]
v_cndmask_b32 v111, v111, 0, s[68:69]
v_cndmask_b32 v112, v112, 0, s[68:69]
v_cndmask_b32 v113, v113, 0, s[68:69]
v_cndmask_b32 v114, v114, 0, s[68:69]
v_cndmask_b32 v115, v115, 0, s[68:69]
Lnz_35:
s_lshl_b32 s65, s61, 2
s_add_u32 s65, s65, 0
s_mul_i32 s67, s65, 13108
s_lshr_b32 s67, s67, 16
s_mul_i32 s70, s67, 5
s_sub_u32 s70, s65, s70
s_mul_i32 s67, s67, 56
s_add_u32 s67, s67, s64
s_mul_i32 s67, s67, 5
s_add_u32 s67, s67, s70
s_lshl_b32 s67, s67, 10
s_add_u32 s67, s67, 11534336
buffer_store_dwordx4 v[100:103], v93, s[12:15], s67 offen sc1
s_lshl_b32 s65, s61, 2
s_add_u32 s65, s65, 1
s_mul_i32 s67, s65, 13108
s_lshr_b32 s67, s67, 16
s_mul_i32 s70, s67, 5
s_sub_u32 s70, s65, s70
s_mul_i32 s67, s67, 56
s_add_u32 s67, s67, s64
s_mul_i32 s67, s67, 5
s_add_u32 s67, s67, s70
s_lshl_b32 s67, s67, 10
s_add_u32 s67, s67, 11534336
buffer_store_dwordx4 v[104:107], v93, s[12:15], s67 offen sc1
s_lshl_b32 s65, s61, 2
s_add_u32 s65, s65, 2
s_mul_i32 s67, s65, 13108
s_lshr_b32 s67, s67, 16
s_mul_i32 s70, s67, 5
s_sub_u32 s70, s65, s70
s_mul_i32 s67, s67, 56
s_add_u32 s67, s67, s64
s_mul_i32 s67, s67, 5
s_add_u32 s67, s67, s70
s_lshl_b32 s67, s67, 10
s_add_u32 s67, s67, 11534336
buffer_store_dwordx4 v[108:111], v93, s[12:15], s67 offen sc1
s_lshl_b32 s65, s61, 2
s_add_u32 s65, s65, 3
s_mul_i32 s67, s65, 13108
s_lshr_b32 s67, s67, 16
s_mul_i32 s70, s67, 5
s_sub_u32 s70, s65, s70
s_mul_i32 s67, s67, 56
s_add_u32 s67, s67, s64
s_mul_i32 s67, s67, 5
s_add_u32 s67, s67, s70
s_lshl_b32 s67, s67, 10
s_add_u32 s67, s67, 11534336
buffer_store_dwordx4 v[112:115], v93, s[12:15], s67 offen sc1
s_lshl_b32 s64, s62, 2
s_add_u32 s64, s64, 3
s_mul_i32 s65, s64, 9363
s_lshr_b32 s65, s65, 16
s_mul_i32 s66, s65, 7
s_sub_u32 s66, s64, s66
ds_read_b64_tr_b16 v[116:117], v94 offset:12288
ds_read_b64_tr_b16 v[118:119], v94 offset:14336
ds_read_b64_tr_b16 v[120:121], v94 offset:12320
ds_read_b64_tr_b16 v[122:123], v94 offset:14368
ds_read_b64_tr_b16 v[124:125], v94 offset:12352
ds_read_b64_tr_b16 v[126:127], v94 offset:14400
ds_read_b64_tr_b16 v[128:129], v94 offset:12384
ds_read_b64_tr_b16 v[130:131], v94 offset:14432
s_waitcnt lgkmcnt(0)
s_cmp_eq_u32 s66, 3
s_cbranch_scc0 Lnz_36
v_cndmask_b32 v116, v116, 0, s[68:69]
v_cndmask_b32 v117, v117, 0, s[68:69]
v_cndmask_b32 v118, v118, 0, s[68:69]
v_cndmask_b32 v119, v119, 0, s[68:69]
v_cndmask_b32 v120, v120, 0, s[68:69]
v_cndmask_b32 v121, v121, 0, s[68:69]
v_cndmask_b32 v122, v122, 0, s[68:69]
v_cndmask_b32 v123, v123, 0, s[68:69]
v_cndmask_b32 v124, v124, 0, s[68:69]
v_cndmask_b32 v125, v125, 0, s[68:69]
v_cndmask_b32 v126, v126, 0, s[68:69]
v_cndmask_b32 v127, v127, 0, s[68:69]
v_cndmask_b32 v128, v128, 0, s[68:69]
v_cndmask_b32 v129, v129, 0, s[68:69]
v_cndmask_b32 v130, v130, 0, s[68:69]
v_cndmask_b32 v131, v131, 0, s[68:69]
Lnz_36:
s_lshl_b32 s65, s61, 2
s_add_u32 s65, s65, 0
s_mul_i32 s67, s65, 13108
s_lshr_b32 s67, s67, 16
s_mul_i32 s70, s67, 5
s_sub_u32 s70, s65, s70
s_mul_i32 s67, s67, 56
s_add_u32 s67, s67, s64
s_mul_i32 s67, s67, 5
s_add_u32 s67, s67, s70
s_lshl_b32 s67, s67, 10
s_add_u32 s67, s67, 11534336
buffer_store_dwordx4 v[116:119], v93, s[12:15], s67 offen sc1
s_lshl_b32 s65, s61, 2
s_add_u32 s65, s65, 1
s_mul_i32 s67, s65, 13108
s_lshr_b32 s67, s67, 16
s_mul_i32 s70, s67, 5
s_sub_u32 s70, s65, s70
s_mul_i32 s67, s67, 56
s_add_u32 s67, s67, s64
s_mul_i32 s67, s67, 5
s_add_u32 s67, s67, s70
s_lshl_b32 s67, s67, 10
s_add_u32 s67, s67, 11534336
buffer_store_dwordx4 v[120:123], v93, s[12:15], s67 offen sc1
s_lshl_b32 s65, s61, 2
s_add_u32 s65, s65, 2
s_mul_i32 s67, s65, 13108
s_lshr_b32 s67, s67, 16
s_mul_i32 s70, s67, 5
s_sub_u32 s70, s65, s70
s_mul_i32 s67, s67, 56
s_add_u32 s67, s67, s64
s_mul_i32 s67, s67, 5
s_add_u32 s67, s67, s70
s_lshl_b32 s67, s67, 10
s_add_u32 s67, s67, 11534336
buffer_store_dwordx4 v[124:127], v93, s[12:15], s67 offen sc1
s_lshl_b32 s65, s61, 2
s_add_u32 s65, s65, 3
s_mul_i32 s67, s65, 13108
s_lshr_b32 s67, s67, 16
s_mul_i32 s70, s67, 5
s_sub_u32 s70, s65, s70
s_mul_i32 s67, s67, 56
s_add_u32 s67, s67, s64
s_mul_i32 s67, s67, 5
s_add_u32 s67, s67, s70
s_lshl_b32 s67, s67, 10
s_add_u32 s67, s67, 11534336
buffer_store_dwordx4 v[128:131], v93, s[12:15], s67 offen sc1
Lqdone_30:
s_waitcnt vmcnt(0) lgkmcnt(0)
s_barrier
s_cmp_eq_u32 s4, 0
s_cbranch_scc0 Lsig_37
v_lshlrev_b32 v5, 10, v2
s_lshl_b32 s5, s2, 2
s_add_u32 s5, s5, 33574912
v_mov_b32 v4, s83
s_mov_b64 exec, 0xff
buffer_store_dword v4, v5, s[12:15], s5 offen sc1
s_mov_b64 exec, -1
Lsig_37:
s_and_b32 s5, s2, 7
s_lshr_b32 s6, s2, 3
s_lshr_b32 s66, s5, 1
s_lshl_b32 s66, s66, 2
s_and_b32 s7, s6, 3
s_add_u32 s66, s66, s7
s_and_b32 s67, s5, 1
s_lshl_b32 s67, s67, 3
s_lshr_b32 s7, s6, 2
s_add_u32 s67, s67, s7
s_lshl_b32 s72, s5, 2
s_and_b32 s7, s6, 3
s_add_u32 s72, s72, s7
s_lshr_b32 s73, s6, 2
s_mul_i32 s74, s4, 14
s_mul_i32 s79, s73, 56
s_add_u32 s79, s79, s74
s_mul_i32 s79, s79, 5120
s_add_u32 s79, s79, 11534336
s_mul_i32 s76, s67, 143360
s_add_u32 s76, s76, 8388608
s_mul_i32 s75, s4, 30272
v_lshlrev_b32 v3, 4, v2
s_lshl_b32 s82, s4, 10
s_add_u32 s77, s76, s82
s_lshl_b32 s78, s66, 2
s_add_u32 s78, s78, s4
s_mul_i32 s78, s78, 20480
s_add_u32 s81, s78, 5242880
s_add_u32 s80, s81, 1310720
s_cmp_eq_u32 s4, 0
s_cbranch_scc0 Lpollo_38
v_lshlrev_b32 v4, 4, v2
s_and_b32 s5, s2, 7
s_lshl_b32 s5, s5, 10
s_add_u32 s5, s5, 33595392
s_mov_b32 s6, 0
s_mov_b32 s62, 0xffffffff
s_mov_b32 s63, 0xff
Lpoll_39:
buffer_load_dwordx4 v[8:11], v4, s[12:15], s5 offen sc1
s_waitcnt vmcnt(0)
v_xor_b32 v8, s83, v8
v_xor_b32 v9, s83, v9
v_xor_b32 v10, s83, v10
v_xor_b32 v11, s83, v11
v_or_b32 v8, v8, v9
v_or3_b32 v8, v8, v10, v11
v_cmp_ne_u32 vcc, 0, v8
s_nop 0
s_and_b64 vcc, vcc, s[62:63]
s_cbranch_vccz Lpolld_40
s_sleep 1
s_add_u32 s6, s6, 1
s_cmp_lt_u32 s6, 0x40000
s_cbranch_scc1 Lpoll_39
Lpolld_40:
Lpollo_38:
s_barrier
v_lshlrev_b32 v7, 4, v2
s_and_b32 s5, s2, 7
s_lshl_b32 s5, s5, 10
s_add_u32 s5, s5, 33574912
buffer_load_dwordx4 v[8:11], v7, s[12:15], s5 offen sc1
s_mov_b32 s62, 0x0
s_mov_b32 s63, 0x1fffff00
s_mov_b32 s6, 0
s_waitcnt vmcnt(0)
s_branch Lpfc_43
Lpf_42:
s_sleep 2
v_lshlrev_b32 v7, 4, v2
s_and_b32 s5, s2, 7
s_lshl_b32 s5, s5, 10
s_add_u32 s5, s5, 33574912
buffer_load_dwordx4 v[8:11], v7, s[12:15], s5 offen sc1
s_waitcnt vmcnt(0)
Lpfc_43:
v_xor_b32 v8, s83, v8
v_xor_b32 v9, s83, v9
v_xor_b32 v10, s83, v10
v_xor_b32 v11, s83, v11
v_or_b32 v8, v8, v9
v_or3_b32 v8, v8, v10, v11
v_cmp_ne_u32 vcc, 0, v8
s_nop 0
s_and_b64 vcc, vcc, s[62:63]
s_cbranch_vccz Lpfd_44
s_add_u32 s6, s6, 1
s_cmp_lt_u32 s6, 0x40000
s_cbranch_scc1 Lpf_42
Lpfd_44:
v_lshlrev_b32 v35, 3, v2
s_mul_i32 s64, s67, 448
s_add_u32 s64, s64, 14680064
buffer_load_dwordx2 v[28:29], v35, s[12:15], s64 offen sc1
s_add_u32 s64, s64, 7168
buffer_load_dwordx2 v[30:31], v35, s[12:15], s64 offen sc1
s_add_u32 s64, s64, 7168
buffer_load_dwordx2 v[32:33], v35, s[12:15], s64 offen sc1
s_mov_b32 s48, s34
s_mov_b32 s49, s35
s_mov_b32 s50, 3456
s_mov_b32 s51, 0x20000
s_mul_i32 s64, s67, 216
v_lshlrev_b32 v36, 2, v2
buffer_load_dword v34, v36, s[48:51], s64 offen
s_sub_u32 s5, s2, 160
s_lshr_b32 s5, s5, 3
s_lshl_b32 s5, s5, 2
s_add_u32 s5, s5, s4
s_mul_i32 s6, s5, 10923
s_lshr_b32 s6, s6, 16
s_mul_i32 s7, s6, 6
s_sub_u32 s7, s5, s7
s_and_b32 s62, s2, 1
s_lshl_b32 s62, s62, 3
s_add_u32 s6, s6, s62
s_mul_i32 s6, s6, 143360
s_add_u32 s6, s6, 8388608
s_add_u32 s63, s6, 142336
s_lshl_b32 s7, s7, 14
s_add_u32 s6, s6, s7
s_add_u32 s6, s6, 49152
s_min_u32 s62, s6, s63
buffer_load_dwordx4 v[176:179], v3, s[12:15], s62 offen sc1
s_add_u32 s6, s6, 1024
s_min_u32 s62, s6, s63
buffer_load_dwordx4 v[180:183], v3, s[12:15], s62 offen sc1
s_add_u32 s6, s6, 1024
s_min_u32 s62, s6, s63
buffer_load_dwordx4 v[184:187], v3, s[12:15], s62 offen sc1
s_add_u32 s6, s6, 1024
s_min_u32 s62, s6, s63
buffer_load_dwordx4 v[188:191], v3, s[12:15], s62 offen sc1
s_add_u32 s6, s6, 1024
s_min_u32 s62, s6, s63
buffer_load_dwordx4 v[192:195], v3, s[12:15], s62 offen sc1
s_add_u32 s6, s6, 1024
s_min_u32 s62, s6, s63
buffer_load_dwordx4 v[196:199], v3, s[12:15], s62 offen sc1
s_add_u32 s6, s6, 1024
s_min_u32 s62, s6, s63
buffer_load_dwordx4 v[200:203], v3, s[12:15], s62 offen sc1
s_add_u32 s6, s6, 1024
s_min_u32 s62, s6, s63
buffer_load_dwordx4 v[204:207], v3, s[12:15], s62 offen sc1
s_add_u32 s6, s6, 1024
s_min_u32 s62, s6, s63
buffer_load_dwordx4 v[208:211], v3, s[12:15], s62 offen sc1
s_add_u32 s6, s6, 1024
s_min_u32 s62, s6, s63
buffer_load_dwordx4 v[212:215], v3, s[12:15], s62 offen sc1
s_add_u32 s6, s6, 1024
s_min_u32 s62, s6, s63
buffer_load_dwordx4 v[216:219], v3, s[12:15], s62 offen sc1
s_add_u32 s6, s6, 1024
s_min_u32 s62, s6, s63
buffer_load_dwordx4 v[220:223], v3, s[12:15], s62 offen sc1
s_add_u32 s6, s6, 1024
s_min_u32 s62, s6, s63
buffer_load_dwordx4 v[224:227], v3, s[12:15], s62 offen sc1
s_add_u32 s6, s6, 1024
s_min_u32 s62, s6, s63
buffer_load_dwordx4 v[228:231], v3, s[12:15], s62 offen sc1
s_add_u32 s6, s6, 1024
s_min_u32 s62, s6, s63
buffer_load_dwordx4 v[232:235], v3, s[12:15], s62 offen sc1
s_add_u32 s6, s6, 1024
s_min_u32 s62, s6, s63
buffer_load_dwordx4 v[236:239], v3, s[12:15], s62 offen sc1
s_add_u32 s6, s6, 1024
s_add_u32 m0, s75, 18688
s_add_u32 s5, s77, 0
buffer_load_dwordx4 v3, s[12:15], s5 offen sc1 lds
s_add_u32 m0, s75, 19712
s_add_u32 s5, s77, 4096
buffer_load_dwordx4 v3, s[12:15], s5 offen sc1 lds
s_add_u32 m0, s75, 20736
s_add_u32 s5, s77, 8192
buffer_load_dwordx4 v3, s[12:15], s5 offen sc1 lds
s_add_u32 m0, s75, 21760
s_add_u32 s5, s77, 12288
buffer_load_dwordx4 v3, s[12:15], s5 offen sc1 lds
s_add_u32 m0, s75, 22784
s_add_u32 s5, s77, 16384
buffer_load_dwordx4 v3, s[12:15], s5 offen sc1 lds
s_add_u32 m0, s75, 23808
s_add_u32 s5, s77, 20480
buffer_load_dwordx4 v3, s[12:15], s5 offen sc1 lds
s_add_u32 m0, s75, 24832
s_add_u32 s5, s77, 24576
buffer_load_dwordx4 v3, s[12:15], s5 offen sc1 lds
s_add_u32 m0, s75, 25856
s_add_u32 s5, s77, 28672
buffer_load_dwordx4 v3, s[12:15], s5 offen sc1 lds
s_add_u32 m0, s75, 26880
s_add_u32 s5, s77, 32768
buffer_load_dwordx4 v3, s[12:15], s5 offen sc1 lds
s_add_u32 m0, s75, 27904
s_add_u32 s5, s77, 36864
buffer_load_dwordx4 v3, s[12:15], s5 offen sc1 lds
s_add_u32 m0, s75, 28928
s_add_u32 s5, s77, 40960
buffer_load_dwordx4 v3, s[12:15], s5 offen sc1 lds
s_add_u32 m0, s82, 157952
s_add_u32 s5, s77, 45056
buffer_load_dwordx4 v3, s[12:15], s5 offen sc1 lds
s_add_u32 s5, s79, 0
buffer_load_dwordx4 a[0:3], v3, s[12:15], s5 offen offset:0 sc1
s_add_u32 s5, s79, 0
buffer_load_dwordx4 a[4:7], v3, s[12:15], s5 offen offset:1024 sc1
s_add_u32 s5, s79, 0
buffer_load_dwordx4 a[8:11], v3, s[12:15], s5 offen offset:2048 sc1
s_add_u32 s5, s79, 0
buffer_load_dwordx4 a[12:15], v3, s[12:15], s5 offen offset:3072 sc1
s_add_u32 s5, s79, 4096
buffer_load_dwordx4 a[16:19], v3, s[12:15], s5 offen offset:0 sc1
s_add_u32 s5, s79, 4096
buffer_load_dwordx4 a[20:23], v3, s[12:15], s5 offen offset:1024 sc1
v_lshlrev_b32 v7, 4, v2
s_and_b32 s5, s2, 7
s_lshl_b32 s5, s5, 10
s_add_u32 s5, s5, 33566720
buffer_load_dwordx4 v[8:11], v7, s[12:15], s5 offen sc1
s_waitcnt vmcnt(0)
s_cmp_eq_u32 s4, 1
s_cbranch_scc0 Lsb_45
s_mov_b32 exec_hi, 0x00ffffff
v_pk_add_f32 v[28:29], v[28:29], v[30:31]
v_pk_add_f32 v[28:29], v[28:29], v[32:33]
v_lshlrev_b32 v30, 16, v34
v_and_b32 v31, 0xffff0000, v34
v_add_u32 v35, 162048, v35
ds_write_b64 v35, v[28:29]
ds_write_b64 v35, v[30:31] offset:448
s_mov_b64 exec, -1
Lsb_45:
s_mov_b32 s62, 0xffffffff
s_mov_b32 s63, 0xff
s_mov_b32 s7, 0
s_branch Lfc_47
Lfp_46:
s_sleep 1
v_lshlrev_b32 v7, 4, v2
s_and_b32 s5, s2, 7
s_lshl_b32 s5, s5, 10
s_add_u32 s5, s5, 33566720
buffer_load_dwordx4 v[8:11], v7, s[12:15], s5 offen sc1
s_waitcnt vmcnt(0)
Lfc_47:
v_xor_b32 v8, s83, v8
v_xor_b32 v9, s83, v9
v_xor_b32 v10, s83, v10
v_xor_b32 v11, s83, v11
v_or_b32 v8, v8, v9
v_or3_b32 v8, v8, v10, v11
v_cmp_ne_u32 vcc, 0, v8
s_nop 0
s_and_b64 vcc, vcc, s[62:63]
s_cbranch_vccz Lfd_48
s_add_u32 s7, s7, 1
s_cmp_lt_u32 s7, 0x40000
s_cbranch_scc1 Lfp_46
Lfd_48:
buffer_load_dwordx4 v[44:47], v3, s[12:15], s81 offen offset:0 sc1
buffer_load_dwordx4 v[48:51], v3, s[12:15], s81 offen offset:1024 sc1
buffer_load_dwordx4 v[52:55], v3, s[12:15], s81 offen offset:2048 sc1
buffer_load_dwordx4 v[56:59], v3, s[12:15], s81 offen offset:3072 sc1
s_add_u32 s5, s81, 4096
buffer_load_dwordx4 v[60:63], v3, s[12:15], s5 offen offset:0 sc1
s_add_u32 s5, s81, 4096
buffer_load_dwordx4 v[64:67], v3, s[12:15], s5 offen offset:1024 sc1
s_add_u32 s5, s81, 4096
buffer_load_dwordx4 v[68:71], v3, s[12:15], s5 offen offset:2048 sc1
s_add_u32 s5, s81, 4096
buffer_load_dwordx4 v[72:75], v3, s[12:15], s5 offen offset:3072 sc1
s_waitcnt lgkmcnt(0)
s_barrier
Lp3_2:
v_add_u32 v92, 0x10000, v3
v_add_u32 v93, 0x20000, v3
ds_read_b128 a[172:175], v3 offset:18688
ds_read_b128 a[176:179], v3 offset:48960
ds_read_b128 a[180:183], v92 offset:13696
ds_read_b128 a[184:187], v92 offset:43968
ds_read_b128 a[188:191], v3 offset:19712
ds_read_b128 a[192:195], v3 offset:49984
ds_read_b128 a[196:199], v92 offset:14720
ds_read_b128 a[200:203], v92 offset:44992
ds_read_b128 a[204:207], v3 offset:20736
ds_read_b128 a[208:211], v3 offset:51008
ds_read_b128 a[212:215], v92 offset:15744
ds_read_b128 a[216:219], v92 offset:46016
ds_read_b128 a[220:223], v3 offset:21760
ds_read_b128 a[224:227], v3 offset:52032
s_add_u32 m0, s75, 0
s_add_u32 s5, s77, 49152
buffer_load_dwordx4 v3, s[12:15], s5 offen sc1 lds
s_add_u32 m0, s75, 1024
s_add_u32 s5, s77, 53248
buffer_load_dwordx4 v3, s[12:15], s5 offen sc1 lds
s_add_u32 m0, s75, 2048
s_add_u32 s5, s77, 57344
buffer_load_dwordx4 v3, s[12:15], s5 offen sc1 lds
s_add_u32 m0, s75, 3072
s_add_u32 s5, s77, 61440
buffer_load_dwordx4 v3, s[12:15], s5 offen sc1 lds
s_add_u32 m0, s75, 4096
s_add_u32 s5, s77, 65536
buffer_load_dwordx4 v3, s[12:15], s5 offen sc1 lds
s_add_u32 m0, s75, 5120
s_add_u32 s5, s77, 69632
buffer_load_dwordx4 v3, s[12:15], s5 offen sc1 lds
s_add_u32 m0, s75, 6144
s_add_u32 s5, s77, 73728
buffer_load_dwordx4 v3, s[12:15], s5 offen sc1 lds
s_add_u32 m0, s75, 7168
s_add_u32 s5, s77, 77824
buffer_load_dwordx4 v3, s[12:15], s5 offen sc1 lds
s_waitcnt vmcnt(15) lgkmcnt(7)
v_mfma_f32_16x16x32_bf16 v[8:11], a[172:175], v[44:47], 0
ds_read_b128 a[228:231], v92 offset:16768
v_mfma_f32_16x16x32_bf16 v[12:15], a[176:179], v[44:47], 0
ds_read_b128 a[232:235], v92 offset:47040
v_mfma_f32_16x16x32_bf16 v[16:19], a[180:183], v[44:47], 0
ds_read_b128 a[236:239], v3 offset:22784
s_add_u32 m0, s75, 8192
s_add_u32 s5, s77, 81920
buffer_load_dwordx4 v3, s[12:15], s5 offen sc1 lds
v_mfma_f32_16x16x32_bf16 v[20:23], a[184:187], v[44:47], 0
ds_read_b128 a[240:243], v3 offset:53056
v_mfma_f32_16x16x32_bf16 v[24:27], a[188:191], v[44:47], 0
ds_read_b128 a[244:247], v92 offset:17792
v_mfma_f32_16x16x32_bf16 v[28:31], a[192:195], v[44:47], 0
ds_read_b128 a[248:251], v92 offset:48064
s_add_u32 m0, s75, 9216
s_add_u32 s5, s77, 86016
buffer_load_dwordx4 v3, s[12:15], s5 offen sc1 lds
v_mfma_f32_16x16x32_bf16 v[32:35], a[196:199], v[44:47], 0
ds_read_b128 a[252:255], v3 offset:23808
v_mfma_f32_16x16x32_bf16 a[164:167], v[44:47], v[44:47], 0
s_waitcnt vmcnt(16) lgkmcnt(7)
v_mfma_f32_16x16x32_bf16 v[8:11], a[200:203], v[48:51], v[8:11]
ds_read_b128 a[172:175], v3 offset:54080
v_mfma_f32_16x16x32_bf16 v[12:15], a[204:207], v[48:51], v[12:15]
ds_read_b128 a[176:179], v92 offset:18816
v_mfma_f32_16x16x32_bf16 v[16:19], a[208:211], v[48:51], v[16:19]
ds_read_b128 a[180:183], v92 offset:49088
s_add_u32 m0, s75, 10240
s_add_u32 s5, s77, 90112
buffer_load_dwordx4 v3, s[12:15], s5 offen sc1 lds
v_mfma_f32_16x16x32_bf16 v[20:23], a[212:215], v[48:51], v[20:23]
ds_read_b128 a[184:187], v3 offset:24832
v_mfma_f32_16x16x32_bf16 v[24:27], a[216:219], v[48:51], v[24:27]
ds_read_b128 a[188:191], v3 offset:55104
v_mfma_f32_16x16x32_bf16 v[28:31], a[220:223], v[48:51], v[28:31]
ds_read_b128 a[192:195], v92 offset:19840
s_add_u32 m0, s75, 11264
s_add_u32 s5, s77, 94208
buffer_load_dwordx4 v3, s[12:15], s5 offen sc1 lds
v_mfma_f32_16x16x32_bf16 v[32:35], a[224:227], v[48:51], v[32:35]
ds_read_b128 a[196:199], v92 offset:50112
v_mfma_f32_16x16x32_bf16 a[164:167], v[48:51], v[48:51], a[164:167]
s_waitcnt vmcnt(17) lgkmcnt(7)
v_mfma_f32_16x16x32_bf16 v[8:11], a[228:231], v[52:55], v[8:11]
ds_read_b128 a[200:203], v3 offset:25856
v_mfma_f32_16x16x32_bf16 v[12:15], a[232:235], v[52:55], v[12:15]
ds_read_b128 a[204:207], v3 offset:56128
v_mfma_f32_16x16x32_bf16 v[16:19], a[236:239], v[52:55], v[16:19]
ds_read_b128 a[208:211], v92 offset:20864
s_add_u32 m0, s75, 12288
s_add_u32 s5, s77, 98304
buffer_load_dwordx4 v3, s[12:15], s5 offen sc1 lds
v_mfma_f32_16x16x32_bf16 v[20:23], a[240:243], v[52:55], v[20:23]
ds_read_b128 a[212:215], v92 offset:51136
v_mfma_f32_16x16x32_bf16 v[24:27], a[244:247], v[52:55], v[24:27]
ds_read_b128 a[216:219], v3 offset:26880
v_mfma_f32_16x16x32_bf16 v[28:31], a[248:251], v[52:55], v[28:31]
ds_read_b128 a[220:223], v3 offset:57152
s_add_u32 m0, s75, 13312
s_add_u32 s5, s77, 102400
buffer_load_dwordx4 v3, s[12:15], s5 offen sc1 lds
v_mfma_f32_16x16x32_bf16 v[32:35], a[252:255], v[52:55], v[32:35]
ds_read_b128 a[224:227], v92 offset:21888
v_mfma_f32_16x16x32_bf16 a[164:167], v[52:55], v[52:55], a[164:167]
s_waitcnt vmcnt(18) lgkmcnt(7)
v_mfma_f32_16x16x32_bf16 v[8:11], a[172:175], v[56:59], v[8:11]
ds_read_b128 a[228:231], v92 offset:52160
v_mfma_f32_16x16x32_bf16 v[12:15], a[176:179], v[56:59], v[12:15]
ds_read_b128 a[232:235], v3 offset:27904
v_mfma_f32_16x16x32_bf16 v[16:19], a[180:183], v[56:59], v[16:19]
ds_read_b128 a[236:239], v3 offset:58176
s_add_u32 m0, s75, 14336
s_add_u32 s5, s77, 106496
buffer_load_dwordx4 v3, s[12:15], s5 offen sc1 lds
v_mfma_f32_16x16x32_bf16 v[20:23], a[184:187], v[56:59], v[20:23]
ds_read_b128 a[240:243], v92 offset:22912
v_mfma_f32_16x16x32_bf16 v[24:27], a[188:191], v[56:59], v[24:27]
ds_read_b128 a[244:247], v92 offset:53184
v_mfma_f32_16x16x32_bf16 v[28:31], a[192:195], v[56:59], v[28:31]
ds_read_b128 a[248:251], v3 offset:28928
s_add_u32 m0, s75, 15360
s_add_u32 s5, s77, 110592
buffer_load_dwordx4 v3, s[12:15], s5 offen sc1 lds
v_mfma_f32_16x16x32_bf16 v[32:35], a[196:199], v[56:59], v[32:35]
ds_read_b128 a[252:255], v3 offset:59200
v_mfma_f32_16x16x32_bf16 a[164:167], v[56:59], v[56:59], a[164:167]
s_waitcnt vmcnt(8)
s_barrier
s_cmp_eq_u32 s4, 0
s_cbranch_scc0 Lsig_49
s_cmp_lt_u32 s2, 160
s_cbranch_scc0 Lsig_49
v_lshlrev_b32 v5, 10, v2
s_lshl_b32 s5, s2, 2
s_add_u32 s5, s5, 33603584
v_mov_b32 v4, s83
s_mov_b64 exec, 0xff
buffer_store_dword v4, v5, s[12:15], s5 offen sc1
s_mov_b64 exec, -1
Lsig_49:
s_waitcnt vmcnt(19) lgkmcnt(7)
v_mfma_f32_16x16x32_bf16 v[8:11], a[200:203], v[60:63], v[8:11]
ds_read_b128 a[172:175], v92 offset:23936
v_mfma_f32_16x16x32_bf16 v[12:15], a[204:207], v[60:63], v[12:15]
ds_read_b128 a[176:179], v92 offset:54208
v_mfma_f32_16x16x32_bf16 v[16:19], a[208:211], v[60:63], v[16:19]
ds_read_b128 a[180:183], v93 offset:26880
s_add_u32 s5, s81, 8192
buffer_load_dwordx4 v[128:131], v3, s[12:15], s5 offen offset:0 sc1
v_mfma_f32_16x16x32_bf16 v[20:23], a[212:215], v[60:63], v[20:23]
ds_read_b128 a[184:187], v93 offset:27904
v_mfma_f32_16x16x32_bf16 v[24:27], a[216:219], v[60:63], v[24:27]
ds_read_b128 a[188:191], v93 offset:28928
v_mfma_f32_16x16x32_bf16 v[28:31], a[220:223], v[60:63], v[28:31]
ds_read_b128 a[192:195], v93 offset:29952
s_add_u32 s5, s81, 8192
buffer_load_dwordx4 v[132:135], v3, s[12:15], s5 offen offset:1024 sc1
v_mfma_f32_16x16x32_bf16 v[32:35], a[224:227], v[60:63], v[32:35]
ds_read_b128 a[196:199], v3 offset:0
v_mfma_f32_16x16x32_bf16 a[164:167], v[60:63], v[60:63], a[164:167]
s_waitcnt vmcnt(20) lgkmcnt(7)
v_mfma_f32_16x16x32_bf16 v[8:11], a[228:231], v[64:67], v[8:11]
ds_read_b128 a[200:203], v3 offset:30272
v_mfma_f32_16x16x32_bf16 v[12:15], a[232:235], v[64:67], v[12:15]
ds_read_b128 a[204:207], v3 offset:60544
v_mfma_f32_16x16x32_bf16 v[16:19], a[236:239], v[64:67], v[16:19]
ds_read_b128 a[208:211], v92 offset:25280
s_add_u32 m0, s82, 121088
s_add_u32 s5, s77, 114688
buffer_load_dwordx4 v3, s[12:15], s5 offen sc1 lds
v_mfma_f32_16x16x32_bf16 v[20:23], a[240:243], v[64:67], v[20:23]
ds_read_b128 a[212:215], v3 offset:1024
v_mfma_f32_16x16x32_bf16 v[24:27], a[244:247], v[64:67], v[24:27]
ds_read_b128 a[216:219], v3 offset:31296
v_mfma_f32_16x16x32_bf16 v[28:31], a[248:251], v[64:67], v[28:31]
ds_read_b128 a[220:223], v3 offset:61568
s_add_u32 s5, s81, 8192
buffer_load_dwordx4 v[136:139], v3, s[12:15], s5 offen offset:2048 sc1
v_mfma_f32_16x16x32_bf16 v[32:35], a[252:255], v[64:67], v[32:35]
ds_read_b128 a[224:227], v92 offset:26304
v_mfma_f32_16x16x32_bf16 a[164:167], v[64:67], v[64:67], a[164:167]
s_waitcnt vmcnt(21) lgkmcnt(7)
v_mfma_f32_16x16x32_bf16 v[8:11], a[172:175], v[68:71], v[8:11]
ds_read_b128 a[228:231], v3 offset:2048
v_mfma_f32_16x16x32_bf16 v[12:15], a[176:179], v[68:71], v[12:15]
ds_read_b128 a[232:235], v3 offset:32320
v_mfma_f32_16x16x32_bf16 v[16:19], a[180:183], v[68:71], v[16:19]
ds_read_b128 a[236:239], v3 offset:62592
s_add_u32 m0, s82, 125184
s_add_u32 s5, s77, 118784
buffer_load_dwordx4 v3, s[12:15], s5 offen sc1 lds
v_mfma_f32_16x16x32_bf16 v[20:23], a[184:187], v[68:71], v[20:23]
ds_read_b128 a[240:243], v92 offset:27328
v_mfma_f32_16x16x32_bf16 v[24:27], a[188:191], v[68:71], v[24:27]
ds_read_b128 a[244:247], v3 offset:3072
v_mfma_f32_16x16x32_bf16 v[28:31], a[192:195], v[68:71], v[28:31]
ds_read_b128 a[248:251], v3 offset:33344
s_add_u32 s5, s81, 8192
buffer_load_dwordx4 v[140:143], v3, s[12:15], s5 offen offset:3072 sc1
v_mfma_f32_16x16x32_bf16 v[32:35], a[196:199], v[68:71], v[32:35]
ds_read_b128 a[252:255], v3 offset:63616
v_mfma_f32_16x16x32_bf16 a[164:167], v[68:71], v[68:71], a[164:167]
s_waitcnt vmcnt(22) lgkmcnt(7)
v_mfma_f32_16x16x32_bf16 v[8:11], a[200:203], v[72:75], v[8:11]
ds_read_b128 a[172:175], v92 offset:28352
v_mfma_f32_16x16x32_bf16 v[12:15], a[204:207], v[72:75], v[12:15]
ds_read_b128 a[176:179], v3 offset:4096
v_mfma_f32_16x16x32_bf16 v[16:19], a[208:211], v[72:75], v[16:19]
ds_read_b128 a[180:183], v3 offset:34368
s_add_u32 m0, s82, 129280
s_add_u32 s5, s77, 122880
buffer_load_dwordx4 v3, s[12:15], s5 offen sc1 lds
v_mfma_f32_16x16x32_bf16 v[20:23], a[212:215], v[72:75], v[20:23]
ds_read_b128 a[184:187], v3 offset:64640
v_mfma_f32_16x16x32_bf16 v[24:27], a[216:219], v[72:75], v[24:27]
ds_read_b128 a[188:191], v92 offset:29376
v_mfma_f32_16x16x32_bf16 v[28:31], a[220:223], v[72:75], v[28:31]
ds_read_b128 a[192:195], v3 offset:5120
s_add_u32 s5, s81, 12288
buffer_load_dwordx4 v[144:147], v3, s[12:15], s5 offen offset:0 sc1
v_mfma_f32_16x16x32_bf16 v[32:35], a[224:227], v[72:75], v[32:35]
ds_read_b128 a[196:199], v3 offset:35392
v_mfma_f32_16x16x32_bf16 a[164:167], v[72:75], v[72:75], a[164:167]
s_waitcnt vmcnt(7) lgkmcnt(7)
v_mfma_f32_16x16x32_bf16 v[8:11], a[228:231], v[128:131], v[8:11]
ds_read_b128 a[200:203], v92 offset:128
v_mfma_f32_16x16x32_bf16 v[12:15], a[232:235], v[128:131], v[12:15]
ds_read_b128 a[204:207], v92 offset:30400
v_mfma_f32_16x16x32_bf16 v[16:19], a[236:239], v[128:131], v[16:19]
ds_read_b128 a[208:211], v3 offset:6144
s_add_u32 m0, s82, 133376
s_add_u32 s5, s77, 126976
buffer_load_dwordx4 v3, s[12:15], s5 offen sc1 lds
v_mfma_f32_16x16x32_bf16 v[20:23], a[240:243], v[128:131], v[20:23]
ds_read_b128 a[212:215], v3 offset:36416
v_mfma_f32_16x16x32_bf16 v[24:27], a[244:247], v[128:131], v[24:27]
ds_read_b128 a[216:219], v92 offset:1152
v_mfma_f32_16x16x32_bf16 v[28:31], a[248:251], v[128:131], v[28:31]
ds_read_b128 a[220:223], v92 offset:31424
s_add_u32 s5, s81, 12288
buffer_load_dwordx4 v[148:151], v3, s[12:15], s5 offen offset:1024 sc1
v_mfma_f32_16x16x32_bf16 v[32:35], a[252:255], v[128:131], v[32:35]
ds_read_b128 a[224:227], v3 offset:7168
v_mfma_f32_16x16x32_bf16 a[164:167], v[128:131], v[128:131], a[164:167]
s_waitcnt vmcnt(10)
s_barrier
s_waitcnt vmcnt(8) lgkmcnt(7)
v_mfma_f32_16x16x32_bf16 v[8:11], a[172:175], v[132:135], v[8:11]
ds_read_b128 a[228:231], v3 offset:37440
v_mfma_f32_16x16x32_bf16 v[12:15], a[176:179], v[132:135], v[12:15]
ds_read_b128 a[232:235], v92 offset:2176
v_mfma_f32_16x16x32_bf16 v[16:19], a[180:183], v[132:135], v[16:19]
ds_read_b128 a[236:239], v92 offset:32448
s_add_u32 m0, s82, 137472
s_add_u32 s5, s77, 131072
buffer_load_dwordx4 v3, s[12:15], s5 offen sc1 lds
v_mfma_f32_16x16x32_bf16 v[20:23], a[184:187], v[132:135], v[20:23]
ds_read_b128 a[240:243], v3 offset:8192
v_mfma_f32_16x16x32_bf16 v[24:27], a[188:191], v[132:135], v[24:27]
ds_read_b128 a[244:247], v3 offset:38464
v_mfma_f32_16x16x32_bf16 v[28:31], a[192:195], v[132:135], v[28:31]
ds_read_b128 a[248:251], v92 offset:3200
s_add_u32 s5, s81, 12288
buffer_load_dwordx4 v[152:155], v3, s[12:15], s5 offen offset:2048 sc1
v_mfma_f32_16x16x32_bf16 v[32:35], a[196:199], v[132:135], v[32:35]
ds_read_b128 a[252:255], v92 offset:33472
v_mfma_f32_16x16x32_bf16 a[164:167], v[132:135], v[132:135], a[164:167]
s_waitcnt vmcnt(8) lgkmcnt(7)
v_mfma_f32_16x16x32_bf16 v[8:11], a[200:203], v[136:139], v[8:11]
ds_read_b128 a[172:175], v3 offset:9216
v_mfma_f32_16x16x32_bf16 v[12:15], a[204:207], v[136:139], v[12:15]
ds_read_b128 a[176:179], v3 offset:39488
v_mfma_f32_16x16x32_bf16 v[16:19], a[208:211], v[136:139], v[16:19]
ds_read_b128 a[180:183], v92 offset:4224
s_add_u32 m0, s82, 141568
s_add_u32 s5, s77, 135168
buffer_load_dwordx4 v3, s[12:15], s5 offen sc1 lds
v_mfma_f32_16x16x32_bf16 v[20:23], a[212:215], v[136:139], v[20:23]
ds_read_b128 a[184:187], v92 offset:34496
v_mfma_f32_16x16x32_bf16 v[24:27], a[216:219], v[136:139], v[24:27]
ds_read_b128 a[188:191], v3 offset:10240
v_mfma_f32_16x16x32_bf16 v[28:31], a[220:223], v[136:139], v[28:31]
ds_read_b128 a[192:195], v3 offset:40512
s_add_u32 s5, s81, 12288
buffer_load_dwordx4 v[156:159], v3, s[12:15], s5 offen offset:3072 sc1
v_mfma_f32_16x16x32_bf16 v[32:35], a[224:227], v[136:139], v[32:35]
ds_read_b128 a[196:199], v92 offset:5248
v_mfma_f32_16x16x32_bf16 a[164:167], v[136:139], v[136:139], a[164:167]
s_waitcnt vmcnt(8) lgkmcnt(7)
v_mfma_f32_16x16x32_bf16 v[8:11], a[228:231], v[140:143], v[8:11]
ds_read_b128 a[200:203], v92 offset:35520
v_mfma_f32_16x16x32_bf16 v[12:15], a[232:235], v[140:143], v[12:15]
ds_read_b128 a[204:207], v3 offset:11264
v_mfma_f32_16x16x32_bf16 v[16:19], a[236:239], v[140:143], v[16:19]
ds_read_b128 a[208:211], v3 offset:41536
s_add_u32 m0, s82, 145664
s_add_u32 s5, s77, 139264
buffer_load_dwordx4 v3, s[12:15], s5 offen sc1 lds
v_mfma_f32_16x16x32_bf16 v[20:23], a[240:243], v[140:143], v[20:23]
ds_read_b128 a[212:215], v92 offset:6272
v_mfma_f32_16x16x32_bf16 v[24:27], a[244:247], v[140:143], v[24:27]
ds_read_b128 a[216:219], v92 offset:36544
v_mfma_f32_16x16x32_bf16 v[28:31], a[248:251], v[140:143], v[28:31]
ds_read_b128 a[220:223], v3 offset:12288
s_add_u32 s5, s81, 16384
buffer_load_dwordx4 v[160:163], v3, s[12:15], s5 offen offset:0 sc1
v_mfma_f32_16x16x32_bf16 v[32:35], a[252:255], v[140:143], v[32:35]
ds_read_b128 a[224:227], v3 offset:42560
v_mfma_f32_16x16x32_bf16 a[164:167], v[140:143], v[140:143], a[164:167]
s_waitcnt vmcnt(8) lgkmcnt(7)
v_mfma_f32_16x16x32_bf16 v[8:11], a[172:175], v[144:147], v[8:11]
ds_read_b128 a[228:231], v92 offset:7296
v_mfma_f32_16x16x32_bf16 v[12:15], a[176:179], v[144:147], v[12:15]
ds_read_b128 a[232:235], v92 offset:37568
v_mfma_f32_16x16x32_bf16 v[16:19], a[180:183], v[144:147], v[16:19]
ds_read_b128 a[236:239], v3 offset:13312
s_add_u32 s5, s81, 16384
buffer_load_dwordx4 v[164:167], v3, s[12:15], s5 offen offset:1024 sc1
v_mfma_f32_16x16x32_bf16 v[20:23], a[184:187], v[144:147], v[20:23]
ds_read_b128 a[240:243], v3 offset:43584
v_mfma_f32_16x16x32_bf16 v[24:27], a[188:191], v[144:147], v[24:27]
ds_read_b128 a[244:247], v92 offset:8320
v_mfma_f32_16x16x32_bf16 v[28:31], a[192:195], v[144:147], v[28:31]
ds_read_b128 a[248:251], v92 offset:38592
s_add_u32 s5, s81, 16384
buffer_load_dwordx4 v[168:171], v3, s[12:15], s5 offen offset:2048 sc1
v_mfma_f32_16x16x32_bf16 v[32:35], a[196:199], v[144:147], v[32:35]
ds_read_b128 a[252:255], v3 offset:14336
v_mfma_f32_16x16x32_bf16 a[164:167], v[144:147], v[144:147], a[164:167]
s_waitcnt vmcnt(8) lgkmcnt(7)
v_mfma_f32_16x16x32_bf16 v[8:11], a[200:203], v[148:151], v[8:11]
ds_read_b128 a[172:175], v3 offset:44608
v_mfma_f32_16x16x32_bf16 v[12:15], a[204:207], v[148:151], v[12:15]
ds_read_b128 a[176:179], v92 offset:9344
v_mfma_f32_16x16x32_bf16 v[16:19], a[208:211], v[148:151], v[16:19]
ds_read_b128 a[180:183], v92 offset:39616
s_add_u32 s5, s81, 16384
buffer_load_dwordx4 v[172:175], v3, s[12:15], s5 offen offset:3072 sc1
v_mfma_f32_16x16x32_bf16 v[20:23], a[212:215], v[148:151], v[20:23]
ds_read_b128 a[184:187], v3 offset:15360
v_mfma_f32_16x16x32_bf16 v[24:27], a[216:219], v[148:151], v[24:27]
ds_read_b128 a[188:191], v3 offset:45632
v_mfma_f32_16x16x32_bf16 v[28:31], a[220:223], v[148:151], v[28:31]
ds_read_b128 a[192:195], v92 offset:10368
v_mfma_f32_16x16x32_bf16 v[32:35], a[224:227], v[148:151], v[32:35]
ds_read_b128 a[196:199], v92 offset:40640
v_mfma_f32_16x16x32_bf16 a[164:167], v[148:151], v[148:151], a[164:167]
s_waitcnt vmcnt(4)
s_barrier
s_waitcnt vmcnt(7) lgkmcnt(7)
v_mfma_f32_16x16x32_bf16 v[8:11], a[228:231], v[152:155], v[8:11]
ds_read_b128 a[200:203], v92 offset:55552
v_mfma_f32_16x16x32_bf16 v[12:15], a[232:235], v[152:155], v[12:15]
ds_read_b128 a[204:207], v92 offset:56576
v_mfma_f32_16x16x32_bf16 v[16:19], a[236:239], v[152:155], v[16:19]
ds_read_b128 a[208:211], v92 offset:57600
v_mfma_f32_16x16x32_bf16 v[20:23], a[240:243], v[152:155], v[20:23]
ds_read_b128 a[212:215], v92 offset:58624
v_mfma_f32_16x16x32_bf16 v[24:27], a[244:247], v[152:155], v[24:27]
ds_read_b128 a[216:219], v92 offset:59648
v_mfma_f32_16x16x32_bf16 v[28:31], a[248:251], v[152:155], v[28:31]
ds_read_b128 a[220:223], v92 offset:60672
v_mfma_f32_16x16x32_bf16 v[32:35], a[252:255], v[152:155], v[32:35]
ds_read_b128 a[224:227], v92 offset:61696
v_mfma_f32_16x16x32_bf16 a[164:167], v[152:155], v[152:155], a[164:167]
s_waitcnt vmcnt(5) lgkmcnt(7)
v_mfma_f32_16x16x32_bf16 v[8:11], a[172:175], v[156:159], v[8:11]
ds_read_b128 a[228:231], v92 offset:62720
v_mfma_f32_16x16x32_bf16 v[12:15], a[176:179], v[156:159], v[12:15]
ds_read_b128 a[232:235], v92 offset:63744
v_mfma_f32_16x16x32_bf16 v[16:19], a[180:183], v[156:159], v[16:19]
ds_read_b128 a[236:239], v92 offset:64768
v_mfma_f32_16x16x32_bf16 v[20:23], a[184:187], v[156:159], v[20:23]
ds_read_b128 a[240:243], v93 offset:256
v_mfma_f32_16x16x32_bf16 v[24:27], a[188:191], v[156:159], v[24:27]
ds_read_b128 a[244:247], v93 offset:1280
v_mfma_f32_16x16x32_bf16 v[28:31], a[192:195], v[156:159], v[28:31]
ds_read_b128 a[248:251], v93 offset:2304
v_mfma_f32_16x16x32_bf16 v[32:35], a[196:199], v[156:159], v[32:35]
ds_read_b128 a[252:255], v93 offset:3328
v_mfma_f32_16x16x32_bf16 a[164:167], v[156:159], v[156:159], a[164:167]
v_lshlrev_b32 v94, 4, v2
s_and_b32 s5, s2, 7
s_lshl_b32 s5, s5, 10
s_add_u32 s5, s5, 33603584
buffer_load_dwordx4 v[4:7], v94, s[12:15], s5 offen sc1
s_waitcnt vmcnt(4) lgkmcnt(7)
v_mfma_f32_16x16x32_bf16 v[8:11], a[200:203], v[160:163], v[8:11]
ds_read_b128 a[172:175], v93 offset:4352
v_mfma_f32_16x16x32_bf16 v[12:15], a[204:207], v[160:163], v[12:15]
ds_read_b128 a[176:179], v93 offset:5376
v_mfma_f32_16x16x32_bf16 v[16:19], a[208:211], v[160:163], v[16:19]
ds_read_b128 a[180:183], v93 offset:6400
v_mfma_f32_16x16x32_bf16 v[20:23], a[212:215], v[160:163], v[20:23]
ds_read_b128 a[184:187], v93 offset:7424
v_mfma_f32_16x16x32_bf16 v[24:27], a[216:219], v[160:163], v[24:27]
ds_read_b128 a[188:191], v93 offset:8448
v_mfma_f32_16x16x32_bf16 v[28:31], a[220:223], v[160:163], v[28:31]
ds_read_b128 a[192:195], v93 offset:9472
v_mfma_f32_16x16x32_bf16 v[32:35], a[224:227], v[160:163], v[32:35]
ds_read_b128 a[196:199], v93 offset:10496
v_mfma_f32_16x16x32_bf16 a[164:167], v[160:163], v[160:163], a[164:167]
s_waitcnt vmcnt(3) lgkmcnt(7)
v_mfma_f32_16x16x32_bf16 v[8:11], a[228:231], v[164:167], v[8:11]
ds_read_b128 a[200:203], v93 offset:11520
v_mfma_f32_16x16x32_bf16 v[12:15], a[232:235], v[164:167], v[12:15]
ds_read_b128 a[204:207], v93 offset:12544
v_mfma_f32_16x16x32_bf16 v[16:19], a[236:239], v[164:167], v[16:19]
ds_read_b128 a[208:211], v93 offset:13568
v_mfma_f32_16x16x32_bf16 v[20:23], a[240:243], v[164:167], v[20:23]
ds_read_b128 a[212:215], v93 offset:14592
v_mfma_f32_16x16x32_bf16 v[24:27], a[244:247], v[164:167], v[24:27]
ds_read_b128 a[216:219], v93 offset:15616
v_mfma_f32_16x16x32_bf16 v[28:31], a[248:251], v[164:167], v[28:31]
ds_read_b128 a[220:223], v93 offset:16640
v_mfma_f32_16x16x32_bf16 v[32:35], a[252:255], v[164:167], v[32:35]
ds_read_b128 a[224:227], v93 offset:17664
v_mfma_f32_16x16x32_bf16 a[164:167], v[164:167], v[164:167], a[164:167]
s_waitcnt vmcnt(2) lgkmcnt(7)
v_mfma_f32_16x16x32_bf16 v[8:11], a[172:175], v[168:171], v[8:11]
ds_read_b128 a[228:231], v3 offset:18688
v_mfma_f32_16x16x32_bf16 v[12:15], a[176:179], v[168:171], v[12:15]
ds_read_b128 a[232:235], v3 offset:48960
v_mfma_f32_16x16x32_bf16 v[16:19], a[180:183], v[168:171], v[16:19]
ds_read_b128 a[236:239], v92 offset:13696
v_mfma_f32_16x16x32_bf16 v[20:23], a[184:187], v[168:171], v[20:23]
ds_read_b128 a[240:243], v92 offset:43968
v_mfma_f32_16x16x32_bf16 v[24:27], a[188:191], v[168:171], v[24:27]
ds_read_b128 a[244:247], v3 offset:19712
v_mfma_f32_16x16x32_bf16 v[28:31], a[192:195], v[168:171], v[28:31]
ds_read_b128 a[248:251], v3 offset:49984
v_mfma_f32_16x16x32_bf16 v[32:35], a[196:199], v[168:171], v[32:35]
ds_read_b128 a[252:255], v92 offset:14720
v_mfma_f32_16x16x32_bf16 a[164:167], v[168:171], v[168:171], a[164:167]
s_waitcnt vmcnt(1) lgkmcnt(7)
v_mfma_f32_16x16x32_bf16 v[8:11], a[200:203], v[172:175], v[8:11]
ds_read_b128 a[172:175], v92 offset:44992
v_mfma_f32_16x16x32_bf16 v[12:15], a[204:207], v[172:175], v[12:15]
ds_read_b128 a[176:179], v3 offset:20736
v_mfma_f32_16x16x32_bf16 v[16:19], a[208:211], v[172:175], v[16:19]
ds_read_b128 a[180:183], v3 offset:51008
v_mfma_f32_16x16x32_bf16 v[20:23], a[212:215], v[172:175], v[20:23]
ds_read_b128 a[184:187], v92 offset:15744
v_mfma_f32_16x16x32_bf16 v[24:27], a[216:219], v[172:175], v[24:27]
ds_read_b128 a[188:191], v92 offset:46016
v_mfma_f32_16x16x32_bf16 v[28:31], a[220:223], v[172:175], v[28:31]
ds_read_b128 a[192:195], v3 offset:21760
v_mfma_f32_16x16x32_bf16 v[32:35], a[224:227], v[172:175], v[32:35]
ds_read_b128 a[196:199], v3 offset:52032
v_mfma_f32_16x16x32_bf16 a[164:167], v[172:175], v[172:175], a[164:167]
s_waitcnt vmcnt(0)
s_mov_b32 s62, 0xffffffff
s_mov_b32 s63, 0xff
s_mov_b32 s7, 0
s_branch Lfc_51
Lfp_50:
s_sleep 1
v_lshlrev_b32 v94, 4, v2
s_and_b32 s5, s2, 7
s_lshl_b32 s5, s5, 10
s_add_u32 s5, s5, 33603584
buffer_load_dwordx4 v[4:7], v94, s[12:15], s5 offen sc1
s_waitcnt vmcnt(0)
Lfc_51:
v_xor_b32 v4, s83, v4
v_xor_b32 v5, s83, v5
v_xor_b32 v6, s83, v6
v_xor_b32 v7, s83, v7
v_or_b32 v4, v4, v5
v_or3_b32 v4, v4, v6, v7
v_cmp_ne_u32 vcc, 0, v4
s_nop 0
s_and_b64 vcc, vcc, s[62:63]
s_cbranch_vccz Lfd_52
s_add_u32 s7, s7, 1
s_cmp_lt_u32 s7, 0x40000
s_cbranch_scc1 Lfp_50
Lfd_52:
s_cmp_eq_u32 s2, 0
s_cbranch_scc0 Lep_53
s_cmp_eq_u32 s4, 0
s_cbranch_scc0 Lep_53
s_mov_b64 exec, 1
v_mov_b32 v4, s83
v_mov_b32 v5, 33554432
buffer_store_dword v4, v5, s[12:15], 0 offen sc1
s_mov_b64 exec, -1
Lep_53:
buffer_load_dwordx4 v[176:179], v3, s[12:15], s80 offen offset:0 sc1
buffer_load_dwordx4 v[180:183], v3, s[12:15], s80 offen offset:1024 sc1
buffer_load_dwordx4 v[184:187], v3, s[12:15], s80 offen offset:2048 sc1
buffer_load_dwordx4 v[188:191], v3, s[12:15], s80 offen offset:3072 sc1
s_add_u32 s5, s80, 4096
buffer_load_dwordx4 v[192:195], v3, s[12:15], s5 offen offset:0 sc1
s_add_u32 s5, s80, 4096
buffer_load_dwordx4 v[196:199], v3, s[12:15], s5 offen offset:1024 sc1
v_lshrrev_b32 v5, 4, v2
v_lshlrev_b32 v6, 4, v5
v_add_u32 v6, 162048, v6
ds_read_b128 v[64:67], v6 offset:0
ds_read_b128 v[124:127], v6 offset:448
ds_read_b128 v[68:71], v6 offset:64
ds_read_b128 v[128:131], v6 offset:512
ds_read_b128 v[72:75], v6 offset:128
ds_read_b128 v[132:135], v6 offset:576
ds_read_b128 v[76:79], v6 offset:192
ds_read_b128 v[136:139], v6 offset:640
ds_read_b128 v[80:83], v6 offset:256
ds_read_b128 v[140:143], v6 offset:704
ds_read_b128 v[84:87], v6 offset:320
ds_read_b128 v[144:147], v6 offset:768
ds_read_b128 v[88:91], v6 offset:384
ds_read_b128 v[148:151], v6 offset:832
v_and_b32 v4, 15, v2
v_cmp_eq_u32 s[62:63], 3, v5
v_lshrrev_b32 v6, 2, v4
v_cmp_eq_u32 s[64:65], v6, v5
v_and_b32 v6, 3, v4
v_cmp_eq_u32 s[68:69], 1, v6
v_cmp_eq_u32 s[70:71], 2, v6
v_cmp_eq_u32 vcc, 3, v6
v_accvgpr_read_b32 v96, a164
v_accvgpr_read_b32 v97, a165
v_accvgpr_read_b32 v98, a166
v_accvgpr_read_b32 v99, a167
v_cndmask_b32 v112, 0, v32, s[62:63]
v_cndmask_b32 v96, v96, v97, s[68:69]
v_cndmask_b32 v96, v96, v98, s[70:71]
v_cndmask_b32 v96, v96, v99, vcc
v_cndmask_b32 v113, 0, v96, s[64:65]
v_mov_b32 v104, v112
v_mov_b32 v105, v113
s_nop 0
v_permlane16_swap_b32 v112, v104
v_permlane16_swap_b32 v113, v105
v_add_f32 v112, v112, v104
v_add_f32 v113, v113, v105
v_mov_b32 v104, v112
v_mov_b32 v105, v113
s_nop 0
v_permlane32_swap_b32 v112, v104
v_permlane32_swap_b32 v113, v105
v_add_f32 v112, v112, v104
v_add_f32 v113, v113, v105
v_mul_f32 v112, 0x3acccccd, v112
v_mul_f32 v113, 0x3acccccd, v113
v_fma_f32 v113, -v112, v112, v113
v_max_f32 v113, 0, v113
v_cvt_pk_bf16_f32 v113, v113, v112
v_and_b32 v112, 0xffff0000, v113
v_lshlrev_b32 v113, 16, v113
v_add_f32 v113, 0x3727c5ac, v113
v_cvt_pk_bf16_f32 v113, v113, v113
v_and_b32 v113, 0xffff0000, v113
v_sqrt_f32 v113, v113
s_nop 0
v_cvt_pk_bf16_f32 v113, v113, v113
v_and_b32 v113, 0xffff0000, v113
v_rcp_f32 v116, v113
v_mov_b32 v118, v112
v_mov_b32 v119, v112
v_mov_b32 v117, v116
s_lshl_b32 s6, s66, 2
s_add_u32 s6, s6, s4
s_mul_i32 s6, s6, 57344
s_add_u32 s6, s6, 16777216
s_lshr_b32 s7, s67, 1
s_mul_i32 s7, s7, 7
s_and_b32 s63, s67, 1
s_lshl_b32 s62, s63, 2
s_add_u32 s62, s62, s7
s_lshl_b32 s62, s62, 10
s_add_u32 s62, s62, s6
s_add_u32 s64, s7, 3
s_lshl_b32 s64, s64, 10
s_lshl_b32 s63, s63, 3
s_add_u32 s64, s64, s63
s_add_u32 s64, s64, s6
s_mov_b32 s70, 0x00003f80
s_mov_b32 s71, 0x3f800000
s_waitcnt lgkmcnt(0)
v_pk_fma_f32 v[8:9], v[64:65], v[118:119], v[8:9] neg_lo:[1,0,0] neg_hi:[1,0,0]
v_pk_fma_f32 v[10:11], v[66:67], v[118:119], v[10:11] neg_lo:[1,0,0] neg_hi:[1,0,0]
v_pk_fma_f32 v[12:13], v[68:69], v[118:119], v[12:13] neg_lo:[1,0,0] neg_hi:[1,0,0]
v_pk_fma_f32 v[14:15], v[70:71], v[118:119], v[14:15] neg_lo:[1,0,0] neg_hi:[1,0,0]
v_pk_fma_f32 v[8:9], v[8:9], v[116:117], v[124:125]
v_pk_fma_f32 v[10:11], v[10:11], v[116:117], v[126:127]
v_pk_fma_f32 v[12:13], v[12:13], v[116:117], v[128:129]
v_pk_fma_f32 v[14:15], v[14:15], v[116:117], v[130:131]
v_max_f32 v8, 0, v8
v_max_f32 v10, 0, v10
v_max_f32 v12, 0, v12
v_max_f32 v14, 0, v14
v_max_f32 v9, 0, v9
v_max_f32 v11, 0, v11
v_max_f32 v13, 0, v13
v_max_f32 v15, 0, v15
v_pk_mul_f32 v[8:9], v[8:9], v[8:9]
v_pk_mul_f32 v[10:11], v[10:11], v[10:11]
v_pk_mul_f32 v[12:13], v[12:13], v[12:13]
v_pk_mul_f32 v[14:15], v[14:15], v[14:15]
v_cvt_pk_bf16_f32 v152, v8, v9
v_cvt_pk_bf16_f32 v153, v10, v11
v_cvt_pk_bf16_f32 v154, v12, v13
v_cvt_pk_bf16_f32 v155, v14, v15
s_add_u32 s5, s80, 4096
buffer_load_dwordx4 v[200:203], v3, s[12:15], s5 offen offset:2048 sc1
s_add_u32 s5, s80, 4096
buffer_load_dwordx4 v[204:207], v3, s[12:15], s5 offen offset:3072 sc1
s_add_u32 s5, s80, 8192
buffer_load_dwordx4 v[208:211], v3, s[12:15], s5 offen offset:0 sc1
buffer_store_dwordx4 v[152:155], v3, s[12:15], s62 offen offset:0 sc1
v_pk_fma_f32 v[16:17], v[72:73], v[118:119], v[16:17] neg_lo:[1,0,0] neg_hi:[1,0,0]
v_pk_fma_f32 v[18:19], v[74:75], v[118:119], v[18:19] neg_lo:[1,0,0] neg_hi:[1,0,0]
v_pk_fma_f32 v[20:21], v[76:77], v[118:119], v[20:21] neg_lo:[1,0,0] neg_hi:[1,0,0]
v_pk_fma_f32 v[22:23], v[78:79], v[118:119], v[22:23] neg_lo:[1,0,0] neg_hi:[1,0,0]
v_pk_fma_f32 v[16:17], v[16:17], v[116:117], v[132:133]
v_pk_fma_f32 v[18:19], v[18:19], v[116:117], v[134:135]
v_pk_fma_f32 v[20:21], v[20:21], v[116:117], v[136:137]
v_pk_fma_f32 v[22:23], v[22:23], v[116:117], v[138:139]
v_max_f32 v16, 0, v16
v_max_f32 v18, 0, v18
v_max_f32 v20, 0, v20
v_max_f32 v22, 0, v22
v_max_f32 v17, 0, v17
v_max_f32 v19, 0, v19
v_max_f32 v21, 0, v21
v_max_f32 v23, 0, v23
v_pk_mul_f32 v[16:17], v[16:17], v[16:17]
v_pk_mul_f32 v[18:19], v[18:19], v[18:19]
v_pk_mul_f32 v[20:21], v[20:21], v[20:21]
v_pk_mul_f32 v[22:23], v[22:23], v[22:23]
v_cvt_pk_bf16_f32 v156, v16, v17
v_cvt_pk_bf16_f32 v157, v18, v19
v_cvt_pk_bf16_f32 v158, v20, v21
v_cvt_pk_bf16_f32 v159, v22, v23
s_add_u32 s5, s80, 8192
buffer_load_dwordx4 v[212:215], v3, s[12:15], s5 offen offset:1024 sc1
s_add_u32 s5, s80, 8192
buffer_load_dwordx4 v[216:219], v3, s[12:15], s5 offen offset:2048 sc1
s_add_u32 s5, s80, 8192
buffer_load_dwordx4 v[220:223], v3, s[12:15], s5 offen offset:3072 sc1
buffer_store_dwordx4 v[156:159], v3, s[12:15], s62 offen offset:1024 sc1
v_pk_fma_f32 v[24:25], v[80:81], v[118:119], v[24:25] neg_lo:[1,0,0] neg_hi:[1,0,0]
v_pk_fma_f32 v[26:27], v[82:83], v[118:119], v[26:27] neg_lo:[1,0,0] neg_hi:[1,0,0]
v_pk_fma_f32 v[28:29], v[84:85], v[118:119], v[28:29] neg_lo:[1,0,0] neg_hi:[1,0,0]
v_pk_fma_f32 v[30:31], v[86:87], v[118:119], v[30:31] neg_lo:[1,0,0] neg_hi:[1,0,0]
v_pk_fma_f32 v[24:25], v[24:25], v[116:117], v[140:141]
v_pk_fma_f32 v[26:27], v[26:27], v[116:117], v[142:143]
v_pk_fma_f32 v[28:29], v[28:29], v[116:117], v[144:145]
v_pk_fma_f32 v[30:31], v[30:31], v[116:117], v[146:147]
v_max_f32 v24, 0, v24
v_max_f32 v26, 0, v26
v_max_f32 v28, 0, v28
v_max_f32 v30, 0, v30
v_max_f32 v25, 0, v25
v_max_f32 v27, 0, v27
v_max_f32 v29, 0, v29
v_max_f32 v31, 0, v31
v_pk_mul_f32 v[24:25], v[24:25], v[24:25]
v_pk_mul_f32 v[26:27], v[26:27], v[26:27]
v_pk_mul_f32 v[28:29], v[28:29], v[28:29]
v_pk_mul_f32 v[30:31], v[30:31], v[30:31]
v_cvt_pk_bf16_f32 v160, v24, v25
v_cvt_pk_bf16_f32 v161, v26, v27
v_cvt_pk_bf16_f32 v162, v28, v29
v_cvt_pk_bf16_f32 v163, v30, v31
s_add_u32 s5, s80, 12288
buffer_load_dwordx4 v[224:227], v3, s[12:15], s5 offen offset:0 sc1
s_add_u32 s5, s80, 12288
buffer_load_dwordx4 v[228:231], v3, s[12:15], s5 offen offset:1024 sc1
buffer_store_dwordx4 v[160:163], v3, s[12:15], s62 offen offset:2048 sc1
v_pk_fma_f32 v[32:33], v[88:89], v[118:119], v[32:33] neg_lo:[1,0,0] neg_hi:[1,0,0]
v_pk_fma_f32 v[34:35], v[90:91], v[118:119], v[34:35] neg_lo:[1,0,0] neg_hi:[1,0,0]
v_pk_fma_f32 v[32:33], v[32:33], v[116:117], v[148:149]
v_pk_fma_f32 v[34:35], v[34:35], v[116:117], v[150:151]
v_max_f32 v32, 0, v32
v_max_f32 v34, 0, v34
v_max_f32 v33, 0, v33
v_max_f32 v35, 0, v35
v_pk_mul_f32 v[32:33], v[32:33], v[32:33]
v_pk_mul_f32 v[34:35], v[34:35], v[34:35]
v_cvt_pk_bf16_f32 v164, v32, v33
v_cvt_pk_bf16_f32 v165, v34, v35
buffer_store_dwordx2 v[164:165], v3, s[12:15], s64 offen sc1
s_waitcnt vmcnt(17) lgkmcnt(7)
v_mfma_f32_16x16x32_bf16 v[36:39], a[228:231], v[176:179], 0
ds_read_b128 a[200:203], v92 offset:16768
v_mfma_f32_16x16x32_bf16 v[40:43], a[232:235], v[176:179], 0
ds_read_b128 a[204:207], v92 offset:47040
v_mfma_f32_16x16x32_bf16 v[44:47], a[236:239], v[176:179], 0
ds_read_b128 a[208:211], v3 offset:22784
s_add_u32 s5, s80, 12288
buffer_load_dwordx4 v[232:235], v3, s[12:15], s5 offen offset:2048 sc1
v_mfma_f32_16x16x32_bf16 v[48:51], a[240:243], v[176:179], 0
ds_read_b128 a[212:215], v3 offset:53056
v_mfma_f32_16x16x32_bf16 v[52:55], a[244:247], v[176:179], 0
ds_read_b128 a[216:219], v92 offset:17792
v_mfma_f32_16x16x32_bf16 v[56:59], a[248:251], v[176:179], 0
ds_read_b128 a[220:223], v92 offset:48064
s_add_u32 s5, s80, 12288
buffer_load_dwordx4 v[236:239], v3, s[12:15], s5 offen offset:3072 sc1
v_mfma_f32_16x16x32_bf16 v[60:63], a[252:255], v[176:179], 0
ds_read_b128 a[224:227], v3 offset:23808
v_mfma_f32_16x16x32_bf16 a[168:171], v[176:179], v[176:179], 0
s_waitcnt vmcnt(18) lgkmcnt(7)
v_mfma_f32_16x16x32_bf16 v[36:39], a[172:175], v[180:183], v[36:39]
ds_read_b128 a[228:231], v3 offset:54080
v_mfma_f32_16x16x32_bf16 v[40:43], a[176:179], v[180:183], v[40:43]
ds_read_b128 a[232:235], v92 offset:18816
v_mfma_f32_16x16x32_bf16 v[44:47], a[180:183], v[180:183], v[44:47]
ds_read_b128 a[236:239], v92 offset:49088
s_add_u32 s5, s80, 16384
buffer_load_dwordx4 v[240:243], v3, s[12:15], s5 offen offset:0 sc1
v_mfma_f32_16x16x32_bf16 v[48:51], a[184:187], v[180:183], v[48:51]
ds_read_b128 a[240:243], v3 offset:24832
v_mfma_f32_16x16x32_bf16 v[52:55], a[188:191], v[180:183], v[52:55]
ds_read_b128 a[244:247], v3 offset:55104
v_mfma_f32_16x16x32_bf16 v[56:59], a[192:195], v[180:183], v[56:59]
ds_read_b128 a[248:251], v92 offset:19840
s_add_u32 s5, s80, 16384
buffer_load_dwordx4 v[244:247], v3, s[12:15], s5 offen offset:1024 sc1
v_mfma_f32_16x16x32_bf16 v[60:63], a[196:199], v[180:183], v[60:63]
ds_read_b128 a[252:255], v92 offset:50112
v_mfma_f32_16x16x32_bf16 a[168:171], v[180:183], v[180:183], a[168:171]
s_waitcnt vmcnt(19) lgkmcnt(7)
v_mfma_f32_16x16x32_bf16 v[36:39], a[200:203], v[184:187], v[36:39]
ds_read_b128 a[172:175], v3 offset:25856
v_mfma_f32_16x16x32_bf16 v[40:43], a[204:207], v[184:187], v[40:43]
ds_read_b128 a[176:179], v3 offset:56128
v_mfma_f32_16x16x32_bf16 v[44:47], a[208:211], v[184:187], v[44:47]
ds_read_b128 a[180:183], v92 offset:20864
s_add_u32 s5, s80, 16384
buffer_load_dwordx4 v[248:251], v3, s[12:15], s5 offen offset:2048 sc1
v_mfma_f32_16x16x32_bf16 v[48:51], a[212:215], v[184:187], v[48:51]
ds_read_b128 a[184:187], v92 offset:51136
v_mfma_f32_16x16x32_bf16 v[52:55], a[216:219], v[184:187], v[52:55]
ds_read_b128 a[188:191], v3 offset:26880
v_mfma_f32_16x16x32_bf16 v[56:59], a[220:223], v[184:187], v[56:59]
ds_read_b128 a[192:195], v3 offset:57152
s_add_u32 s5, s80, 16384
buffer_load_dwordx4 v[252:255], v3, s[12:15], s5 offen offset:3072 sc1
v_mfma_f32_16x16x32_bf16 v[60:63], a[224:227], v[184:187], v[60:63]
ds_read_b128 a[196:199], v92 offset:21888
v_mfma_f32_16x16x32_bf16 a[168:171], v[184:187], v[184:187], a[168:171]
s_waitcnt vmcnt(20) lgkmcnt(7)
v_mfma_f32_16x16x32_bf16 v[36:39], a[228:231], v[188:191], v[36:39]
ds_read_b128 a[200:203], v92 offset:52160
v_mfma_f32_16x16x32_bf16 v[40:43], a[232:235], v[188:191], v[40:43]
ds_read_b128 a[204:207], v3 offset:27904
v_mfma_f32_16x16x32_bf16 v[44:47], a[236:239], v[188:191], v[44:47]
ds_read_b128 a[208:211], v3 offset:58176
s_add_u32 s5, s79, 4096
buffer_load_dwordx4 a[24:27], v3, s[12:15], s5 offen offset:2048 sc1
v_mfma_f32_16x16x32_bf16 v[48:51], a[240:243], v[188:191], v[48:51]
ds_read_b128 a[212:215], v92 offset:22912
v_mfma_f32_16x16x32_bf16 v[52:55], a[244:247], v[188:191], v[52:55]
ds_read_b128 a[216:219], v92 offset:53184
v_mfma_f32_16x16x32_bf16 v[56:59], a[248:251], v[188:191], v[56:59]
ds_read_b128 a[220:223], v3 offset:28928
s_add_u32 s5, s79, 4096
buffer_load_dwordx4 a[28:31], v3, s[12:15], s5 offen offset:3072 sc1
v_mfma_f32_16x16x32_bf16 v[60:63], a[252:255], v[188:191], v[60:63]
ds_read_b128 a[224:227], v3 offset:59200
v_mfma_f32_16x16x32_bf16 a[168:171], v[188:191], v[188:191], a[168:171]
s_waitcnt vmcnt(21) lgkmcnt(7)
v_mfma_f32_16x16x32_bf16 v[36:39], a[172:175], v[192:195], v[36:39]
ds_read_b128 a[228:231], v92 offset:23936
v_mfma_f32_16x16x32_bf16 v[40:43], a[176:179], v[192:195], v[40:43]
ds_read_b128 a[232:235], v92 offset:54208
v_mfma_f32_16x16x32_bf16 v[44:47], a[180:183], v[192:195], v[44:47]
ds_read_b128 a[236:239], v93 offset:26880
s_add_u32 s5, s79, 8192
buffer_load_dwordx4 a[32:35], v3, s[12:15], s5 offen offset:0 sc1
v_mfma_f32_16x16x32_bf16 v[48:51], a[184:187], v[192:195], v[48:51]
ds_read_b128 a[240:243], v93 offset:27904
v_mfma_f32_16x16x32_bf16 v[52:55], a[188:191], v[192:195], v[52:55]
ds_read_b128 a[244:247], v93 offset:28928
v_mfma_f32_16x16x32_bf16 v[56:59], a[192:195], v[192:195], v[56:59]
ds_read_b128 a[248:251], v93 offset:29952
s_add_u32 s5, s79, 8192
buffer_load_dwordx4 a[36:39], v3, s[12:15], s5 offen offset:1024 sc1
v_mfma_f32_16x16x32_bf16 v[60:63], a[196:199], v[192:195], v[60:63]
ds_read_b128 a[252:255], v3 offset:0
v_mfma_f32_16x16x32_bf16 a[168:171], v[192:195], v[192:195], a[168:171]
s_waitcnt vmcnt(10)
s_barrier
s_cmp_eq_u32 s4, 0
s_cbranch_scc0 Lsig_54
s_lshl_b32 s5, s66, 7
s_lshl_b32 s6, s67, 2
s_add_u32 s5, s5, s6
s_add_u32 s5, s5, 33587200
s_mov_b64 exec, 1
v_mov_b32 v4, s83
v_mov_b32 v5, 0
buffer_store_dword v4, v5, s[12:15], s5 offen sc1
s_mov_b64 exec, -1
Lsig_54:
s_waitcnt vmcnt(22) lgkmcnt(7)
v_mfma_f32_16x16x32_bf16 v[36:39], a[200:203], v[196:199], v[36:39]
ds_read_b128 a[172:175], v3 offset:30272
v_mfma_f32_16x16x32_bf16 v[40:43], a[204:207], v[196:199], v[40:43]
ds_read_b128 a[176:179], v3 offset:60544
v_mfma_f32_16x16x32_bf16 v[44:47], a[208:211], v[196:199], v[44:47]
ds_read_b128 a[180:183], v92 offset:25280
s_add_u32 s5, s79, 8192
buffer_load_dwordx4 a[40:43], v3, s[12:15], s5 offen offset:2048 sc1
v_mfma_f32_16x16x32_bf16 v[48:51], a[212:215], v[196:199], v[48:51]
ds_read_b128 a[184:187], v3 offset:1024
v_mfma_f32_16x16x32_bf16 v[52:55], a[216:219], v[196:199], v[52:55]
ds_read_b128 a[188:191], v3 offset:31296
v_mfma_f32_16x16x32_bf16 v[56:59], a[220:223], v[196:199], v[56:59]
ds_read_b128 a[192:195], v3 offset:61568
s_add_u32 s5, s79, 8192
buffer_load_dwordx4 a[44:47], v3, s[12:15], s5 offen offset:3072 sc1
v_mfma_f32_16x16x32_bf16 v[60:63], a[224:227], v[196:199], v[60:63]
ds_read_b128 a[196:199], v92 offset:26304
v_mfma_f32_16x16x32_bf16 a[168:171], v[196:199], v[196:199], a[168:171]
s_waitcnt vmcnt(23) lgkmcnt(7)
v_mfma_f32_16x16x32_bf16 v[36:39], a[228:231], v[200:203], v[36:39]
ds_read_b128 a[200:203], v3 offset:2048
v_mfma_f32_16x16x32_bf16 v[40:43], a[232:235], v[200:203], v[40:43]
ds_read_b128 a[204:207], v3 offset:32320
v_mfma_f32_16x16x32_bf16 v[44:47], a[236:239], v[200:203], v[44:47]
ds_read_b128 a[208:211], v3 offset:62592
s_add_u32 s5, s79, 12288
buffer_load_dwordx4 a[48:51], v3, s[12:15], s5 offen offset:0 sc1
v_mfma_f32_16x16x32_bf16 v[48:51], a[240:243], v[200:203], v[48:51]
ds_read_b128 a[212:215], v92 offset:27328
v_mfma_f32_16x16x32_bf16 v[52:55], a[244:247], v[200:203], v[52:55]
ds_read_b128 a[216:219], v3 offset:3072
v_mfma_f32_16x16x32_bf16 v[56:59], a[248:251], v[200:203], v[56:59]
ds_read_b128 a[220:223], v3 offset:33344
s_add_u32 s5, s79, 12288
buffer_load_dwordx4 a[52:55], v3, s[12:15], s5 offen offset:1024 sc1
v_mfma_f32_16x16x32_bf16 v[60:63], a[252:255], v[200:203], v[60:63]
ds_read_b128 a[224:227], v3 offset:63616
v_mfma_f32_16x16x32_bf16 a[168:171], v[200:203], v[200:203], a[168:171]
s_waitcnt vmcnt(24) lgkmcnt(7)
v_mfma_f32_16x16x32_bf16 v[36:39], a[172:175], v[204:207], v[36:39]
ds_read_b128 a[228:231], v92 offset:28352
v_mfma_f32_16x16x32_bf16 v[40:43], a[176:179], v[204:207], v[40:43]
ds_read_b128 a[232:235], v3 offset:4096
v_mfma_f32_16x16x32_bf16 v[44:47], a[180:183], v[204:207], v[44:47]
ds_read_b128 a[236:239], v3 offset:34368
s_add_u32 s5, s79, 12288
buffer_load_dwordx4 a[56:59], v3, s[12:15], s5 offen offset:2048 sc1
v_mfma_f32_16x16x32_bf16 v[48:51], a[184:187], v[204:207], v[48:51]
ds_read_b128 a[240:243], v3 offset:64640
v_mfma_f32_16x16x32_bf16 v[52:55], a[188:191], v[204:207], v[52:55]
ds_read_b128 a[244:247], v92 offset:29376
v_mfma_f32_16x16x32_bf16 v[56:59], a[192:195], v[204:207], v[56:59]
ds_read_b128 a[248:251], v3 offset:5120
s_add_u32 s5, s79, 12288
buffer_load_dwordx4 a[60:63], v3, s[12:15], s5 offen offset:3072 sc1
v_mfma_f32_16x16x32_bf16 v[60:63], a[196:199], v[204:207], v[60:63]
ds_read_b128 a[252:255], v3 offset:35392
v_mfma_f32_16x16x32_bf16 a[168:171], v[204:207], v[204:207], a[168:171]
s_waitcnt vmcnt(25) lgkmcnt(7)
v_mfma_f32_16x16x32_bf16 v[36:39], a[200:203], v[208:211], v[36:39]
ds_read_b128 a[172:175], v92 offset:128
v_mfma_f32_16x16x32_bf16 v[40:43], a[204:207], v[208:211], v[40:43]
ds_read_b128 a[176:179], v92 offset:30400
v_mfma_f32_16x16x32_bf16 v[44:47], a[208:211], v[208:211], v[44:47]
ds_read_b128 a[180:183], v3 offset:6144
s_add_u32 s5, s79, 16384
buffer_load_dwordx4 a[64:67], v3, s[12:15], s5 offen offset:0 sc1
v_mfma_f32_16x16x32_bf16 v[48:51], a[212:215], v[208:211], v[48:51]
ds_read_b128 a[184:187], v3 offset:36416
v_mfma_f32_16x16x32_bf16 v[52:55], a[216:219], v[208:211], v[52:55]
ds_read_b128 a[188:191], v92 offset:1152
v_mfma_f32_16x16x32_bf16 v[56:59], a[220:223], v[208:211], v[56:59]
ds_read_b128 a[192:195], v92 offset:31424
s_add_u32 s5, s79, 16384
buffer_load_dwordx4 a[68:71], v3, s[12:15], s5 offen offset:1024 sc1
v_mfma_f32_16x16x32_bf16 v[60:63], a[224:227], v[208:211], v[60:63]
ds_read_b128 a[196:199], v3 offset:7168
v_mfma_f32_16x16x32_bf16 a[168:171], v[208:211], v[208:211], a[168:171]
s_waitcnt vmcnt(25) lgkmcnt(7)
v_mfma_f32_16x16x32_bf16 v[36:39], a[228:231], v[212:215], v[36:39]
ds_read_b128 a[200:203], v3 offset:37440
v_mfma_f32_16x16x32_bf16 v[40:43], a[232:235], v[212:215], v[40:43]
ds_read_b128 a[204:207], v92 offset:2176
v_mfma_f32_16x16x32_bf16 v[44:47], a[236:239], v[212:215], v[44:47]
ds_read_b128 a[208:211], v92 offset:32448
s_add_u32 s5, s79, 16384
buffer_load_dwordx4 a[72:75], v3, s[12:15], s5 offen offset:2048 sc1
v_mfma_f32_16x16x32_bf16 v[48:51], a[240:243], v[212:215], v[48:51]
ds_read_b128 a[212:215], v3 offset:8192
v_mfma_f32_16x16x32_bf16 v[52:55], a[244:247], v[212:215], v[52:55]
ds_read_b128 a[216:219], v3 offset:38464
v_mfma_f32_16x16x32_bf16 v[56:59], a[248:251], v[212:215], v[56:59]
ds_read_b128 a[220:223], v92 offset:3200
s_add_u32 s5, s79, 16384
buffer_load_dwordx4 a[76:79], v3, s[12:15], s5 offen offset:3072 sc1
v_mfma_f32_16x16x32_bf16 v[60:63], a[252:255], v[212:215], v[60:63]
ds_read_b128 a[224:227], v92 offset:33472
v_mfma_f32_16x16x32_bf16 a[168:171], v[212:215], v[212:215], a[168:171]
s_waitcnt vmcnt(26) lgkmcnt(7)
v_mfma_f32_16x16x32_bf16 v[36:39], a[172:175], v[216:219], v[36:39]
ds_read_b128 a[228:231], v3 offset:9216
v_mfma_f32_16x16x32_bf16 v[40:43], a[176:179], v[216:219], v[40:43]
ds_read_b128 a[232:235], v3 offset:39488
v_mfma_f32_16x16x32_bf16 v[44:47], a[180:183], v[216:219], v[44:47]
ds_read_b128 a[236:239], v92 offset:4224
s_add_u32 s5, s79, 20480
buffer_load_dwordx4 a[80:83], v3, s[12:15], s5 offen offset:0 sc1
v_mfma_f32_16x16x32_bf16 v[48:51], a[184:187], v[216:219], v[48:51]
ds_read_b128 a[240:243], v92 offset:34496
v_mfma_f32_16x16x32_bf16 v[52:55], a[188:191], v[216:219], v[52:55]
ds_read_b128 a[244:247], v3 offset:10240
v_mfma_f32_16x16x32_bf16 v[56:59], a[192:195], v[216:219], v[56:59]
ds_read_b128 a[248:251], v3 offset:40512
s_add_u32 s5, s79, 20480
buffer_load_dwordx4 a[84:87], v3, s[12:15], s5 offen offset:1024 sc1
v_mfma_f32_16x16x32_bf16 v[60:63], a[196:199], v[216:219], v[60:63]
ds_read_b128 a[252:255], v92 offset:5248
v_mfma_f32_16x16x32_bf16 a[168:171], v[216:219], v[216:219], a[168:171]
s_waitcnt vmcnt(27) lgkmcnt(7)
v_mfma_f32_16x16x32_bf16 v[36:39], a[200:203], v[220:223], v[36:39]
ds_read_b128 a[172:175], v92 offset:35520
v_mfma_f32_16x16x32_bf16 v[40:43], a[204:207], v[220:223], v[40:43]
ds_read_b128 a[176:179], v3 offset:11264
v_mfma_f32_16x16x32_bf16 v[44:47], a[208:211], v[220:223], v[44:47]
ds_read_b128 a[180:183], v3 offset:41536
s_add_u32 s5, s79, 20480
buffer_load_dwordx4 a[88:91], v3, s[12:15], s5 offen offset:2048 sc1
v_mfma_f32_16x16x32_bf16 v[48:51], a[212:215], v[220:223], v[48:51]
ds_read_b128 a[184:187], v92 offset:6272
v_mfma_f32_16x16x32_bf16 v[52:55], a[216:219], v[220:223], v[52:55]
ds_read_b128 a[188:191], v92 offset:36544
v_mfma_f32_16x16x32_bf16 v[56:59], a[220:223], v[220:223], v[56:59]
ds_read_b128 a[192:195], v3 offset:12288
s_add_u32 s5, s79, 20480
buffer_load_dwordx4 a[92:95], v3, s[12:15], s5 offen offset:3072 sc1
v_mfma_f32_16x16x32_bf16 v[60:63], a[224:227], v[220:223], v[60:63]
ds_read_b128 a[196:199], v3 offset:42560
v_mfma_f32_16x16x32_bf16 a[168:171], v[220:223], v[220:223], a[168:171]
s_waitcnt vmcnt(27) lgkmcnt(7)
v_mfma_f32_16x16x32_bf16 v[36:39], a[228:231], v[224:227], v[36:39]
ds_read_b128 a[200:203], v92 offset:7296
v_mfma_f32_16x16x32_bf16 v[40:43], a[232:235], v[224:227], v[40:43]
ds_read_b128 a[204:207], v92 offset:37568
v_mfma_f32_16x16x32_bf16 v[44:47], a[236:239], v[224:227], v[44:47]
ds_read_b128 a[208:211], v3 offset:13312
s_add_u32 s5, s79, 24576
buffer_load_dwordx4 a[96:99], v3, s[12:15], s5 offen offset:0 sc1
v_mfma_f32_16x16x32_bf16 v[48:51], a[240:243], v[224:227], v[48:51]
ds_read_b128 a[212:215], v3 offset:43584
v_mfma_f32_16x16x32_bf16 v[52:55], a[244:247], v[224:227], v[52:55]
ds_read_b128 a[216:219], v92 offset:8320
v_mfma_f32_16x16x32_bf16 v[56:59], a[248:251], v[224:227], v[56:59]
ds_read_b128 a[220:223], v92 offset:38592
s_add_u32 s5, s79, 24576
buffer_load_dwordx4 a[100:103], v3, s[12:15], s5 offen offset:1024 sc1
v_mfma_f32_16x16x32_bf16 v[60:63], a[252:255], v[224:227], v[60:63]
ds_read_b128 a[224:227], v3 offset:14336
v_mfma_f32_16x16x32_bf16 a[168:171], v[224:227], v[224:227], a[168:171]
s_waitcnt vmcnt(28) lgkmcnt(7)
v_mfma_f32_16x16x32_bf16 v[36:39], a[172:175], v[228:231], v[36:39]
ds_read_b128 a[228:231], v3 offset:44608
v_mfma_f32_16x16x32_bf16 v[40:43], a[176:179], v[228:231], v[40:43]
ds_read_b128 a[232:235], v92 offset:9344
v_mfma_f32_16x16x32_bf16 v[44:47], a[180:183], v[228:231], v[44:47]
ds_read_b128 a[236:239], v92 offset:39616
s_add_u32 s5, s79, 24576
buffer_load_dwordx4 a[104:107], v3, s[12:15], s5 offen offset:2048 sc1
v_mfma_f32_16x16x32_bf16 v[48:51], a[184:187], v[228:231], v[48:51]
ds_read_b128 a[240:243], v3 offset:15360
v_mfma_f32_16x16x32_bf16 v[52:55], a[188:191], v[228:231], v[52:55]
ds_read_b128 a[244:247], v3 offset:45632
v_mfma_f32_16x16x32_bf16 v[56:59], a[192:195], v[228:231], v[56:59]
ds_read_b128 a[248:251], v92 offset:10368
s_add_u32 s5, s79, 24576
buffer_load_dwordx4 a[108:111], v3, s[12:15], s5 offen offset:3072 sc1
v_mfma_f32_16x16x32_bf16 v[60:63], a[196:199], v[228:231], v[60:63]
ds_read_b128 a[252:255], v92 offset:40640
v_mfma_f32_16x16x32_bf16 a[168:171], v[228:231], v[228:231], a[168:171]
v_and_b32 v5, 3, v2
v_lshlrev_b32 v5, 2, v5
s_lshr_b32 s5, s72, 1
s_lshl_b32 s5, s5, 7
s_lshl_b32 s6, s4, 4
s_add_u32 s5, s5, s6
s_add_u32 s5, s5, 33587200
buffer_load_dword v4, v5, s[12:15], s5 offen sc1
s_waitcnt vmcnt(28) lgkmcnt(7)
v_mfma_f32_16x16x32_bf16 v[36:39], a[200:203], v[232:235], v[36:39]
ds_read_b128 a[172:175], v92 offset:55552
v_mfma_f32_16x16x32_bf16 v[40:43], a[204:207], v[232:235], v[40:43]
ds_read_b128 a[176:179], v92 offset:56576
v_mfma_f32_16x16x32_bf16 v[44:47], a[208:211], v[232:235], v[44:47]
ds_read_b128 a[180:183], v92 offset:57600
s_add_u32 s5, s79, 28672
buffer_load_dwordx4 a[112:115], v3, s[12:15], s5 offen offset:0 sc1
v_mfma_f32_16x16x32_bf16 v[48:51], a[212:215], v[232:235], v[48:51]
ds_read_b128 a[184:187], v92 offset:58624
v_mfma_f32_16x16x32_bf16 v[52:55], a[216:219], v[232:235], v[52:55]
ds_read_b128 a[188:191], v92 offset:59648
v_mfma_f32_16x16x32_bf16 v[56:59], a[220:223], v[232:235], v[56:59]
ds_read_b128 a[192:195], v92 offset:60672
s_add_u32 s5, s79, 28672
buffer_load_dwordx4 a[116:119], v3, s[12:15], s5 offen offset:1024 sc1
v_mfma_f32_16x16x32_bf16 v[60:63], a[224:227], v[232:235], v[60:63]
ds_read_b128 a[196:199], v92 offset:61696
v_mfma_f32_16x16x32_bf16 a[168:171], v[232:235], v[232:235], a[168:171]
s_waitcnt vmcnt(29) lgkmcnt(7)
v_mfma_f32_16x16x32_bf16 v[36:39], a[228:231], v[236:239], v[36:39]
ds_read_b128 a[200:203], v92 offset:62720
v_mfma_f32_16x16x32_bf16 v[40:43], a[232:235], v[236:239], v[40:43]
ds_read_b128 a[204:207], v92 offset:63744
v_mfma_f32_16x16x32_bf16 v[44:47], a[236:239], v[236:239], v[44:47]
ds_read_b128 a[208:211], v92 offset:64768
s_add_u32 s5, s79, 28672
buffer_load_dwordx4 a[120:123], v3, s[12:15], s5 offen offset:2048 sc1
v_mfma_f32_16x16x32_bf16 v[48:51], a[240:243], v[236:239], v[48:51]
ds_read_b128 a[212:215], v93 offset:256
v_mfma_f32_16x16x32_bf16 v[52:55], a[244:247], v[236:239], v[52:55]
ds_read_b128 a[216:219], v93 offset:1280
v_mfma_f32_16x16x32_bf16 v[56:59], a[248:251], v[236:239], v[56:59]
ds_read_b128 a[220:223], v93 offset:2304
s_add_u32 s5, s79, 28672
buffer_load_dwordx4 a[124:127], v3, s[12:15], s5 offen offset:3072 sc1
v_mfma_f32_16x16x32_bf16 v[60:63], a[252:255], v[236:239], v[60:63]
ds_read_b128 a[224:227], v93 offset:3328
v_mfma_f32_16x16x32_bf16 a[168:171], v[236:239], v[236:239], a[168:171]
s_waitcnt vmcnt(30) lgkmcnt(7)
v_mfma_f32_16x16x32_bf16 v[36:39], a[172:175], v[240:243], v[36:39]
ds_read_b128 a[228:231], v93 offset:4352
v_mfma_f32_16x16x32_bf16 v[40:43], a[176:179], v[240:243], v[40:43]
ds_read_b128 a[232:235], v93 offset:5376
v_mfma_f32_16x16x32_bf16 v[44:47], a[180:183], v[240:243], v[44:47]
ds_read_b128 a[236:239], v93 offset:6400
s_add_u32 s5, s79, 32768
buffer_load_dwordx4 a[128:131], v3, s[12:15], s5 offen offset:0 sc1
v_mfma_f32_16x16x32_bf16 v[48:51], a[184:187], v[240:243], v[48:51]
ds_read_b128 a[240:243], v93 offset:7424
v_mfma_f32_16x16x32_bf16 v[52:55], a[188:191], v[240:243], v[52:55]
ds_read_b128 a[244:247], v93 offset:8448
v_mfma_f32_16x16x32_bf16 v[56:59], a[192:195], v[240:243], v[56:59]
ds_read_b128 a[248:251], v93 offset:9472
s_add_u32 s5, s79, 32768
buffer_load_dwordx4 a[132:135], v3, s[12:15], s5 offen offset:1024 sc1
v_mfma_f32_16x16x32_bf16 v[60:63], a[196:199], v[240:243], v[60:63]
ds_read_b128 a[252:255], v93 offset:10496
v_mfma_f32_16x16x32_bf16 a[168:171], v[240:243], v[240:243], a[168:171]
s_waitcnt vmcnt(31) lgkmcnt(7)
v_mfma_f32_16x16x32_bf16 v[36:39], a[200:203], v[244:247], v[36:39]
ds_read_b128 a[172:175], v93 offset:11520
v_mfma_f32_16x16x32_bf16 v[40:43], a[204:207], v[244:247], v[40:43]
ds_read_b128 a[176:179], v93 offset:12544
v_mfma_f32_16x16x32_bf16 v[44:47], a[208:211], v[244:247], v[44:47]
ds_read_b128 a[180:183], v93 offset:13568
s_add_u32 s5, s79, 32768
buffer_load_dwordx4 a[136:139], v3, s[12:15], s5 offen offset:2048 sc1
v_mfma_f32_16x16x32_bf16 v[48:51], a[212:215], v[244:247], v[48:51]
ds_read_b128 a[184:187], v93 offset:14592
v_mfma_f32_16x16x32_bf16 v[52:55], a[216:219], v[244:247], v[52:55]
ds_read_b128 a[188:191], v93 offset:15616
v_mfma_f32_16x16x32_bf16 v[56:59], a[220:223], v[244:247], v[56:59]
ds_read_b128 a[192:195], v93 offset:16640
s_add_u32 s5, s79, 32768
buffer_load_dwordx4 a[140:143], v3, s[12:15], s5 offen offset:3072 sc1
v_mfma_f32_16x16x32_bf16 v[60:63], a[224:227], v[244:247], v[60:63]
ds_read_b128 a[196:199], v93 offset:17664
v_mfma_f32_16x16x32_bf16 a[168:171], v[244:247], v[244:247], a[168:171]
s_waitcnt vmcnt(32) lgkmcnt(7)
v_mfma_f32_16x16x32_bf16 v[36:39], a[228:231], v[248:251], v[36:39]
v_mfma_f32_16x16x32_bf16 v[40:43], a[232:235], v[248:251], v[40:43]
v_mfma_f32_16x16x32_bf16 v[44:47], a[236:239], v[248:251], v[44:47]
v_mfma_f32_16x16x32_bf16 v[48:51], a[240:243], v[248:251], v[48:51]
v_mfma_f32_16x16x32_bf16 v[52:55], a[244:247], v[248:251], v[52:55]
v_mfma_f32_16x16x32_bf16 v[56:59], a[248:251], v[248:251], v[56:59]
v_mfma_f32_16x16x32_bf16 v[60:63], a[252:255], v[248:251], v[60:63]
v_mfma_f32_16x16x32_bf16 a[168:171], v[248:251], v[248:251], a[168:171]
s_waitcnt vmcnt(31) lgkmcnt(0)
v_mfma_f32_16x16x32_bf16 v[36:39], a[172:175], v[252:255], v[36:39]
v_mfma_f32_16x16x32_bf16 v[40:43], a[176:179], v[252:255], v[40:43]
v_mfma_f32_16x16x32_bf16 v[44:47], a[180:183], v[252:255], v[44:47]
v_mfma_f32_16x16x32_bf16 v[48:51], a[184:187], v[252:255], v[48:51]
v_mfma_f32_16x16x32_bf16 v[52:55], a[188:191], v[252:255], v[52:55]
v_mfma_f32_16x16x32_bf16 v[56:59], a[192:195], v[252:255], v[56:59]
v_mfma_f32_16x16x32_bf16 v[60:63], a[196:199], v[252:255], v[60:63]
v_mfma_f32_16x16x32_bf16 a[168:171], v[252:255], v[252:255], a[168:171]
s_waitcnt vmcnt(8)
s_mov_b32 s7, 0
s_branch Lrc_56
Lrp_55:
s_sleep 1
v_and_b32 v5, 3, v2
v_lshlrev_b32 v5, 2, v5
s_lshr_b32 s5, s72, 1
s_lshl_b32 s5, s5, 7
s_lshl_b32 s6, s4, 4
s_add_u32 s5, s5, s6
s_add_u32 s5, s5, 33587200
buffer_load_dword v4, v5, s[12:15], s5 offen sc1
s_waitcnt vmcnt(0)
Lrc_56:
v_cmp_ne_u32 vcc, s83, v4
s_cbranch_vccz Lrd_57
s_add_u32 s7, s7, 1
s_cmp_lt_u32 s7, 0x40000
s_cbranch_scc1 Lrp_55
Lrd_57:
s_lshl_b32 s78, s72, 1
s_mul_i32 s78, s78, 56
s_add_u32 s78, s78, s74
s_lshl_b32 s78, s78, 10
s_add_u32 s78, s78, 16777216
v_lshrrev_b32 v5, 4, v2
v_lshlrev_b32 v6, 4, v5
v_add_u32 v6, 162048, v6
ds_read_b128 v[64:67], v6 offset:0
ds_read_b128 v[124:127], v6 offset:448
ds_read_b128 v[68:71], v6 offset:64
ds_read_b128 v[128:131], v6 offset:512
ds_read_b128 v[72:75], v6 offset:128
ds_read_b128 v[132:135], v6 offset:576
ds_read_b128 v[76:79], v6 offset:192
ds_read_b128 v[136:139], v6 offset:640
ds_read_b128 v[80:83], v6 offset:256
ds_read_b128 v[140:143], v6 offset:704
ds_read_b128 v[84:87], v6 offset:320
ds_read_b128 v[144:147], v6 offset:768
ds_read_b128 v[88:91], v6 offset:384
ds_read_b128 v[148:151], v6 offset:832
v_and_b32 v4, 15, v2
v_cmp_eq_u32 s[62:63], 3, v5
v_lshrrev_b32 v6, 2, v4
v_cmp_eq_u32 s[64:65], v6, v5
v_and_b32 v6, 3, v4
v_cmp_eq_u32 s[68:69], 1, v6
v_cmp_eq_u32 s[70:71], 2, v6
v_cmp_eq_u32 vcc, 3, v6
v_accvgpr_read_b32 v96, a168
v_accvgpr_read_b32 v97, a169
v_accvgpr_read_b32 v98, a170
v_accvgpr_read_b32 v99, a171
v_cndmask_b32 v112, 0, v60, s[62:63]
v_cndmask_b32 v96, v96, v97, s[68:69]
v_cndmask_b32 v96, v96, v98, s[70:71]
v_cndmask_b32 v96, v96, v99, vcc
v_cndmask_b32 v113, 0, v96, s[64:65]
s_add_u32 s5, s78, 0
buffer_load_dwordx4 v[176:179], v3, s[12:15], s5 offen offset:0 sc1
s_add_u32 s5, s78, 57344
buffer_load_dwordx4 v[180:183], v3, s[12:15], s5 offen offset:0 sc1
s_add_u32 s5, s78, 0
buffer_load_dwordx4 v[184:187], v3, s[12:15], s5 offen offset:1024 sc1
s_add_u32 s5, s78, 57344
buffer_load_dwordx4 v[188:191], v3, s[12:15], s5 offen offset:1024 sc1
s_add_u32 s5, s78, 0
buffer_load_dwordx4 v[192:195], v3, s[12:15], s5 offen offset:2048 sc1
s_add_u32 s5, s78, 57344
buffer_load_dwordx4 v[196:199], v3, s[12:15], s5 offen offset:2048 sc1
v_mov_b32 v104, v112
v_mov_b32 v105, v113
s_nop 0
v_permlane16_swap_b32 v112, v104
v_permlane16_swap_b32 v113, v105
v_add_f32 v112, v112, v104
v_add_f32 v113, v113, v105
v_mov_b32 v104, v112
v_mov_b32 v105, v113
s_nop 0
v_permlane32_swap_b32 v112, v104
v_permlane32_swap_b32 v113, v105
v_add_f32 v112, v112, v104
v_add_f32 v113, v113, v105
v_mul_f32 v112, 0x3acccccd, v112
v_mul_f32 v113, 0x3acccccd, v113
v_fma_f32 v113, -v112, v112, v113
v_max_f32 v113, 0, v113
v_cvt_pk_bf16_f32 v113, v113, v112
v_and_b32 v112, 0xffff0000, v113
v_lshlrev_b32 v113, 16, v113
v_add_f32 v113, 0x3727c5ac, v113
v_cvt_pk_bf16_f32 v113, v113, v113
v_and_b32 v113, 0xffff0000, v113
v_sqrt_f32 v113, v113
s_nop 0
v_cvt_pk_bf16_f32 v113, v113, v113
v_and_b32 v113, 0xffff0000, v113
v_rcp_f32 v116, v113
v_mov_b32 v118, v112
v_mov_b32 v119, v112
v_mov_b32 v117, v116
s_lshl_b32 s6, s66, 2
s_add_u32 s6, s6, s4
s_mul_i32 s6, s6, 57344
s_add_u32 s6, s6, 20447232
s_lshr_b32 s7, s67, 1
s_mul_i32 s7, s7, 7
s_and_b32 s63, s67, 1
s_lshl_b32 s62, s63, 2
s_add_u32 s62, s62, s7
s_lshl_b32 s62, s62, 10
s_add_u32 s62, s62, s6
s_add_u32 s64, s7, 3
s_lshl_b32 s64, s64, 10
s_lshl_b32 s63, s63, 3
s_add_u32 s64, s64, s63
s_add_u32 s64, s64, s6
s_mov_b32 s70, 0x00003f80
s_mov_b32 s71, 0x3f800000
s_waitcnt lgkmcnt(0)
v_pk_fma_f32 v[36:37], v[64:65], v[118:119], v[36:37] neg_lo:[1,0,0] neg_hi:[1,0,0]
v_pk_fma_f32 v[38:39], v[66:67], v[118:119], v[38:39] neg_lo:[1,0,0] neg_hi:[1,0,0]
v_pk_fma_f32 v[40:41], v[68:69], v[118:119], v[40:41] neg_lo:[1,0,0] neg_hi:[1,0,0]
v_pk_fma_f32 v[42:43], v[70:71], v[118:119], v[42:43] neg_lo:[1,0,0] neg_hi:[1,0,0]
v_pk_fma_f32 v[36:37], v[36:37], v[116:117], v[124:125]
v_pk_fma_f32 v[38:39], v[38:39], v[116:117], v[126:127]
v_pk_fma_f32 v[40:41], v[40:41], v[116:117], v[128:129]
v_pk_fma_f32 v[42:43], v[42:43], v[116:117], v[130:131]
v_max_f32 v36, 0, v36
v_max_f32 v38, 0, v38
v_max_f32 v40, 0, v40
v_max_f32 v42, 0, v42
v_max_f32 v37, 0, v37
v_max_f32 v39, 0, v39
v_max_f32 v41, 0, v41
v_max_f32 v43, 0, v43
v_pk_mul_f32 v[36:37], v[36:37], v[36:37]
v_pk_mul_f32 v[38:39], v[38:39], v[38:39]
v_pk_mul_f32 v[40:41], v[40:41], v[40:41]
v_pk_mul_f32 v[42:43], v[42:43], v[42:43]
v_cvt_pk_bf16_f32 v152, v36, v37
v_cvt_pk_bf16_f32 v153, v38, v39
v_cvt_pk_bf16_f32 v154, v40, v41
v_cvt_pk_bf16_f32 v155, v42, v43
s_add_u32 s5, s78, 0
buffer_load_dwordx4 v[200:203], v3, s[12:15], s5 offen offset:3072 sc1
s_add_u32 s5, s78, 57344
buffer_load_dwordx4 v[204:207], v3, s[12:15], s5 offen offset:3072 sc1
s_add_u32 s5, s78, 4096
buffer_load_dwordx4 v[208:211], v3, s[12:15], s5 offen offset:0 sc1
buffer_store_dwordx4 v[152:155], v3, s[12:15], s62 offen offset:0 sc1
v_pk_fma_f32 v[44:45], v[72:73], v[118:119], v[44:45] neg_lo:[1,0,0] neg_hi:[1,0,0]
v_pk_fma_f32 v[46:47], v[74:75], v[118:119], v[46:47] neg_lo:[1,0,0] neg_hi:[1,0,0]
v_pk_fma_f32 v[48:49], v[76:77], v[118:119], v[48:49] neg_lo:[1,0,0] neg_hi:[1,0,0]
v_pk_fma_f32 v[50:51], v[78:79], v[118:119], v[50:51] neg_lo:[1,0,0] neg_hi:[1,0,0]
v_pk_fma_f32 v[44:45], v[44:45], v[116:117], v[132:133]
v_pk_fma_f32 v[46:47], v[46:47], v[116:117], v[134:135]
v_pk_fma_f32 v[48:49], v[48:49], v[116:117], v[136:137]
v_pk_fma_f32 v[50:51], v[50:51], v[116:117], v[138:139]
v_max_f32 v44, 0, v44
v_max_f32 v46, 0, v46
v_max_f32 v48, 0, v48
v_max_f32 v50, 0, v50
v_max_f32 v45, 0, v45
v_max_f32 v47, 0, v47
v_max_f32 v49, 0, v49
v_max_f32 v51, 0, v51
v_pk_mul_f32 v[44:45], v[44:45], v[44:45]
v_pk_mul_f32 v[46:47], v[46:47], v[46:47]
v_pk_mul_f32 v[48:49], v[48:49], v[48:49]
v_pk_mul_f32 v[50:51], v[50:51], v[50:51]
v_cvt_pk_bf16_f32 v156, v44, v45
v_cvt_pk_bf16_f32 v157, v46, v47
v_cvt_pk_bf16_f32 v158, v48, v49
v_cvt_pk_bf16_f32 v159, v50, v51
s_add_u32 s5, s78, 61440
buffer_load_dwordx4 v[212:215], v3, s[12:15], s5 offen offset:0 sc1
s_add_u32 s5, s78, 4096
buffer_load_dwordx4 v[216:219], v3, s[12:15], s5 offen offset:1024 sc1
s_add_u32 s5, s78, 61440
buffer_load_dwordx4 v[220:223], v3, s[12:15], s5 offen offset:1024 sc1
buffer_store_dwordx4 v[156:159], v3, s[12:15], s62 offen offset:1024 sc1
v_pk_fma_f32 v[52:53], v[80:81], v[118:119], v[52:53] neg_lo:[1,0,0] neg_hi:[1,0,0]
v_pk_fma_f32 v[54:55], v[82:83], v[118:119], v[54:55] neg_lo:[1,0,0] neg_hi:[1,0,0]
v_pk_fma_f32 v[56:57], v[84:85], v[118:119], v[56:57] neg_lo:[1,0,0] neg_hi:[1,0,0]
v_pk_fma_f32 v[58:59], v[86:87], v[118:119], v[58:59] neg_lo:[1,0,0] neg_hi:[1,0,0]
v_pk_fma_f32 v[52:53], v[52:53], v[116:117], v[140:141]
v_pk_fma_f32 v[54:55], v[54:55], v[116:117], v[142:143]
v_pk_fma_f32 v[56:57], v[56:57], v[116:117], v[144:145]
v_pk_fma_f32 v[58:59], v[58:59], v[116:117], v[146:147]
v_max_f32 v52, 0, v52
v_max_f32 v54, 0, v54
v_max_f32 v56, 0, v56
v_max_f32 v58, 0, v58
v_max_f32 v53, 0, v53
v_max_f32 v55, 0, v55
v_max_f32 v57, 0, v57
v_max_f32 v59, 0, v59
v_pk_mul_f32 v[52:53], v[52:53], v[52:53]
v_pk_mul_f32 v[54:55], v[54:55], v[54:55]
v_pk_mul_f32 v[56:57], v[56:57], v[56:57]
v_pk_mul_f32 v[58:59], v[58:59], v[58:59]
v_cvt_pk_bf16_f32 v160, v52, v53
v_cvt_pk_bf16_f32 v161, v54, v55
v_cvt_pk_bf16_f32 v162, v56, v57
v_cvt_pk_bf16_f32 v163, v58, v59
s_add_u32 s5, s79, 36864
buffer_load_dwordx4 a[144:147], v3, s[12:15], s5 offen offset:0 sc1
s_add_u32 s5, s79, 36864
buffer_load_dwordx4 a[148:151], v3, s[12:15], s5 offen offset:1024 sc1
s_add_u32 s5, s79, 36864
buffer_load_dwordx4 a[152:155], v3, s[12:15], s5 offen offset:2048 sc1
buffer_store_dwordx4 v[160:163], v3, s[12:15], s62 offen offset:2048 sc1
v_pk_fma_f32 v[60:61], v[88:89], v[118:119], v[60:61] neg_lo:[1,0,0] neg_hi:[1,0,0]
v_pk_fma_f32 v[62:63], v[90:91], v[118:119], v[62:63] neg_lo:[1,0,0] neg_hi:[1,0,0]
v_pk_fma_f32 v[60:61], v[60:61], v[116:117], v[148:149]
v_pk_fma_f32 v[62:63], v[62:63], v[116:117], v[150:151]
v_max_f32 v60, 0, v60
v_max_f32 v62, 0, v62
v_max_f32 v61, 0, v61
v_max_f32 v63, 0, v63
v_pk_mul_f32 v[60:61], v[60:61], v[60:61]
v_pk_mul_f32 v[62:63], v[62:63], v[62:63]
v_cvt_pk_bf16_f32 v164, v60, v61
v_cvt_pk_bf16_f32 v165, v62, v63
s_add_u32 s5, s79, 36864
buffer_load_dwordx4 a[156:159], v3, s[12:15], s5 offen offset:3072 sc1
s_add_u32 s5, s79, 40960
buffer_load_dwordx4 a[160:163], v3, s[12:15], s5 offen offset:0 sc1
s_add_u32 s5, s79, 40960
buffer_load_dwordx4 a[164:167], v3, s[12:15], s5 offen offset:1024 sc1
buffer_store_dwordx2 v[164:165], v3, s[12:15], s64 offen sc1
s_add_u32 s5, s79, 40960
buffer_load_dwordx4 a[168:171], v3, s[12:15], s5 offen offset:2048 sc1
s_add_u32 s5, s79, 40960
buffer_load_dwordx4 a[172:175], v3, s[12:15], s5 offen offset:3072 sc1
s_add_u32 s5, s79, 45056
buffer_load_dwordx4 a[176:179], v3, s[12:15], s5 offen offset:0 sc1
s_add_u32 s5, s79, 45056
buffer_load_dwordx4 a[180:183], v3, s[12:15], s5 offen offset:1024 sc1
s_add_u32 s5, s79, 45056
buffer_load_dwordx4 a[184:187], v3, s[12:15], s5 offen offset:2048 sc1
s_add_u32 s5, s79, 45056
buffer_load_dwordx4 a[188:191], v3, s[12:15], s5 offen offset:3072 sc1
s_waitcnt vmcnt(26)
v_mfma_f32_16x16x32_bf16 v[8:11], a[0:3], v[176:179], 0
v_mfma_f32_16x16x32_bf16 v[12:15], a[0:3], v[180:183], 0
s_add_u32 s5, s78, 4096
buffer_load_dwordx4 v[224:227], v3, s[12:15], s5 offen offset:2048 sc1
v_mfma_f32_16x16x32_bf16 v[24:27], a[4:7], v[176:179], 0
v_mfma_f32_16x16x32_bf16 v[28:31], a[4:7], v[180:183], 0
s_add_u32 s5, s78, 61440
buffer_load_dwordx4 v[228:231], v3, s[12:15], s5 offen offset:2048 sc1
v_mfma_f32_16x16x32_bf16 v[40:43], a[8:11], v[176:179], 0
v_mfma_f32_16x16x32_bf16 v[44:47], a[8:11], v[180:183], 0
v_mfma_f32_16x16x32_bf16 v[56:59], a[12:15], v[176:179], 0
s_add_u32 s5, s79, 49152
buffer_load_dwordx4 a[192:195], v3, s[12:15], s5 offen offset:0 sc1
v_mfma_f32_16x16x32_bf16 v[60:63], a[12:15], v[180:183], 0
v_mfma_f32_16x16x32_bf16 v[72:75], a[16:19], v[176:179], 0
s_add_u32 s5, s79, 49152
buffer_load_dwordx4 a[196:199], v3, s[12:15], s5 offen offset:1024 sc1
v_mfma_f32_16x16x32_bf16 v[76:79], a[16:19], v[180:183], 0
s_waitcnt vmcnt(28)
v_mfma_f32_16x16x32_bf16 v[8:11], a[20:23], v[184:187], v[8:11]
v_mfma_f32_16x16x32_bf16 v[12:15], a[20:23], v[188:191], v[12:15]
s_add_u32 s5, s79, 49152
buffer_load_dwordx4 a[200:203], v3, s[12:15], s5 offen offset:2048 sc1
v_mfma_f32_16x16x32_bf16 v[24:27], a[24:27], v[184:187], v[24:27]
v_mfma_f32_16x16x32_bf16 v[28:31], a[24:27], v[188:191], v[28:31]
s_add_u32 s5, s78, 4096
buffer_load_dwordx4 v[176:179], v3, s[12:15], s5 offen offset:3072 sc1
v_mfma_f32_16x16x32_bf16 v[40:43], a[28:31], v[184:187], v[40:43]
v_mfma_f32_16x16x32_bf16 v[44:47], a[28:31], v[188:191], v[44:47]
v_mfma_f32_16x16x32_bf16 v[56:59], a[32:35], v[184:187], v[56:59]
s_add_u32 s5, s78, 61440
buffer_load_dwordx4 v[180:183], v3, s[12:15], s5 offen offset:3072 sc1
v_mfma_f32_16x16x32_bf16 v[60:63], a[32:35], v[188:191], v[60:63]
v_mfma_f32_16x16x32_bf16 v[72:75], a[36:39], v[184:187], v[72:75]
s_add_u32 s5, s79, 49152
buffer_load_dwordx4 a[204:207], v3, s[12:15], s5 offen offset:3072 sc1
v_mfma_f32_16x16x32_bf16 v[76:79], a[36:39], v[188:191], v[76:79]
s_waitcnt vmcnt(30)
v_mfma_f32_16x16x32_bf16 v[8:11], a[40:43], v[192:195], v[8:11]
v_mfma_f32_16x16x32_bf16 v[12:15], a[40:43], v[196:199], v[12:15]
s_add_u32 s5, s79, 53248
buffer_load_dwordx4 a[208:211], v3, s[12:15], s5 offen offset:0 sc1
v_mfma_f32_16x16x32_bf16 v[24:27], a[44:47], v[192:195], v[24:27]
v_mfma_f32_16x16x32_bf16 v[28:31], a[44:47], v[196:199], v[28:31]
s_add_u32 s5, s79, 53248
buffer_load_dwordx4 a[212:215], v3, s[12:15], s5 offen offset:1024 sc1
v_mfma_f32_16x16x32_bf16 v[40:43], a[48:51], v[192:195], v[40:43]
v_mfma_f32_16x16x32_bf16 v[44:47], a[48:51], v[196:199], v[44:47]
v_mfma_f32_16x16x32_bf16 v[56:59], a[52:55], v[192:195], v[56:59]
s_add_u32 s5, s78, 8192
buffer_load_dwordx4 v[184:187], v3, s[12:15], s5 offen offset:0 sc1
v_mfma_f32_16x16x32_bf16 v[60:63], a[52:55], v[196:199], v[60:63]
v_mfma_f32_16x16x32_bf16 v[72:75], a[56:59], v[192:195], v[72:75]
s_add_u32 s5, s78, 65536
buffer_load_dwordx4 v[188:191], v3, s[12:15], s5 offen offset:0 sc1
v_mfma_f32_16x16x32_bf16 v[76:79], a[56:59], v[196:199], v[76:79]
s_waitcnt vmcnt(32)
v_mfma_f32_16x16x32_bf16 v[8:11], a[60:63], v[200:203], v[8:11]
v_mfma_f32_16x16x32_bf16 v[12:15], a[60:63], v[204:207], v[12:15]
s_add_u32 s5, s79, 53248
buffer_load_dwordx4 a[216:219], v3, s[12:15], s5 offen offset:2048 sc1
v_mfma_f32_16x16x32_bf16 v[24:27], a[64:67], v[200:203], v[24:27]
v_mfma_f32_16x16x32_bf16 v[28:31], a[64:67], v[204:207], v[28:31]
s_add_u32 s5, s79, 53248
buffer_load_dwordx4 a[220:223], v3, s[12:15], s5 offen offset:3072 sc1
v_mfma_f32_16x16x32_bf16 v[40:43], a[68:71], v[200:203], v[40:43]
v_mfma_f32_16x16x32_bf16 v[44:47], a[68:71], v[204:207], v[44:47]
v_mfma_f32_16x16x32_bf16 v[56:59], a[72:75], v[200:203], v[56:59]
s_add_u32 s5, s79, 57344
buffer_load_dwordx4 a[224:227], v3, s[12:15], s5 offen offset:0 sc1
v_mfma_f32_16x16x32_bf16 v[60:63], a[72:75], v[204:207], v[60:63]
v_mfma_f32_16x16x32_bf16 v[72:75], a[76:79], v[200:203], v[72:75]
s_add_u32 s5, s78, 8192
buffer_load_dwordx4 v[192:195], v3, s[12:15], s5 offen offset:1024 sc1
v_mfma_f32_16x16x32_bf16 v[76:79], a[76:79], v[204:207], v[76:79]
s_waitcnt vmcnt(22)
s_barrier
s_cmp_eq_u32 s4, 0
s_cbranch_scc0 Lsig_58
s_lshl_b32 s5, s66, 7
s_lshl_b32 s6, s67, 2
s_add_u32 s5, s5, s6
s_add_u32 s5, s5, 33591296
s_mov_b64 exec, 1
v_mov_b32 v4, s83
v_mov_b32 v5, 0
buffer_store_dword v4, v5, s[12:15], s5 offen sc1
s_mov_b64 exec, -1
Lsig_58:
s_waitcnt vmcnt(33)
v_mfma_f32_16x16x32_bf16 v[8:11], a[80:83], v[208:211], v[8:11]
v_mfma_f32_16x16x32_bf16 v[12:15], a[80:83], v[212:215], v[12:15]
s_add_u32 s5, s78, 65536
buffer_load_dwordx4 v[196:199], v3, s[12:15], s5 offen offset:1024 sc1
v_mfma_f32_16x16x32_bf16 v[24:27], a[84:87], v[208:211], v[24:27]
v_mfma_f32_16x16x32_bf16 v[28:31], a[84:87], v[212:215], v[28:31]
s_add_u32 s5, s79, 57344
buffer_load_dwordx4 a[228:231], v3, s[12:15], s5 offen offset:1024 sc1
v_mfma_f32_16x16x32_bf16 v[40:43], a[88:91], v[208:211], v[40:43]
v_mfma_f32_16x16x32_bf16 v[44:47], a[88:91], v[212:215], v[44:47]
v_mfma_f32_16x16x32_bf16 v[56:59], a[92:95], v[208:211], v[56:59]
s_add_u32 s5, s79, 57344
buffer_load_dwordx4 a[232:235], v3, s[12:15], s5 offen offset:2048 sc1
v_mfma_f32_16x16x32_bf16 v[60:63], a[92:95], v[212:215], v[60:63]
v_mfma_f32_16x16x32_bf16 v[72:75], a[96:99], v[208:211], v[72:75]
s_add_u32 s5, s78, 8192
buffer_load_dwordx4 v[200:203], v3, s[12:15], s5 offen offset:2048 sc1
v_mfma_f32_16x16x32_bf16 v[76:79], a[96:99], v[212:215], v[76:79]
s_waitcnt vmcnt(35)
v_mfma_f32_16x16x32_bf16 v[8:11], a[100:103], v[216:219], v[8:11]
v_mfma_f32_16x16x32_bf16 v[12:15], a[100:103], v[220:223], v[12:15]
s_add_u32 s5, s78, 65536
buffer_load_dwordx4 v[204:207], v3, s[12:15], s5 offen offset:2048 sc1
v_mfma_f32_16x16x32_bf16 v[24:27], a[104:107], v[216:219], v[24:27]
v_mfma_f32_16x16x32_bf16 v[28:31], a[104:107], v[220:223], v[28:31]
s_add_u32 s5, s79, 57344
buffer_load_dwordx4 a[236:239], v3, s[12:15], s5 offen offset:3072 sc1
v_mfma_f32_16x16x32_bf16 v[40:43], a[108:111], v[216:219], v[40:43]
v_mfma_f32_16x16x32_bf16 v[44:47], a[108:111], v[220:223], v[44:47]
v_mfma_f32_16x16x32_bf16 v[56:59], a[112:115], v[216:219], v[56:59]
s_add_u32 s5, s79, 61440
buffer_load_dwordx4 a[240:243], v3, s[12:15], s5 offen offset:0 sc1
v_mfma_f32_16x16x32_bf16 v[60:63], a[112:115], v[220:223], v[60:63]
v_mfma_f32_16x16x32_bf16 v[72:75], a[116:119], v[216:219], v[72:75]
s_add_u32 s5, s78, 8192
buffer_load_dwordx4 v[208:211], v3, s[12:15], s5 offen offset:3072 sc1
v_mfma_f32_16x16x32_bf16 v[76:79], a[116:119], v[220:223], v[76:79]
s_waitcnt vmcnt(22)
v_mfma_f32_16x16x32_bf16 v[8:11], a[120:123], v[224:227], v[8:11]
v_mfma_f32_16x16x32_bf16 v[12:15], a[120:123], v[228:231], v[12:15]
s_add_u32 s5, s78, 65536
buffer_load_dwordx4 v[212:215], v3, s[12:15], s5 offen offset:3072 sc1
v_mfma_f32_16x16x32_bf16 v[24:27], a[124:127], v[224:227], v[24:27]
v_mfma_f32_16x16x32_bf16 v[28:31], a[124:127], v[228:231], v[28:31]
s_add_u32 s5, s79, 61440
buffer_load_dwordx4 a[244:247], v3, s[12:15], s5 offen offset:1024 sc1
v_mfma_f32_16x16x32_bf16 v[40:43], a[128:131], v[224:227], v[40:43]
v_mfma_f32_16x16x32_bf16 v[44:47], a[128:131], v[228:231], v[44:47]
v_mfma_f32_16x16x32_bf16 v[56:59], a[132:135], v[224:227], v[56:59]
s_add_u32 s5, s79, 61440
buffer_load_dwordx4 a[248:251], v3, s[12:15], s5 offen offset:2048 sc1
v_mfma_f32_16x16x32_bf16 v[60:63], a[132:135], v[228:231], v[60:63]
v_mfma_f32_16x16x32_bf16 v[72:75], a[136:139], v[224:227], v[72:75]
s_add_u32 s5, s78, 12288
buffer_load_dwordx4 v[216:219], v3, s[12:15], s5 offen offset:0 sc1
v_mfma_f32_16x16x32_bf16 v[76:79], a[136:139], v[228:231], v[76:79]
s_waitcnt vmcnt(21)
v_mfma_f32_16x16x32_bf16 v[8:11], a[140:143], v[176:179], v[8:11]
v_mfma_f32_16x16x32_bf16 v[12:15], a[140:143], v[180:183], v[12:15]
s_add_u32 s5, s78, 69632
buffer_load_dwordx4 v[220:223], v3, s[12:15], s5 offen offset:0 sc1
v_mfma_f32_16x16x32_bf16 v[24:27], a[144:147], v[176:179], v[24:27]
v_mfma_f32_16x16x32_bf16 v[28:31], a[144:147], v[180:183], v[28:31]
s_add_u32 s5, s79, 61440
buffer_load_dwordx4 a[252:255], v3, s[12:15], s5 offen offset:3072 sc1
v_mfma_f32_16x16x32_bf16 v[40:43], a[148:151], v[176:179], v[40:43]
v_mfma_f32_16x16x32_bf16 v[44:47], a[148:151], v[180:183], v[44:47]
v_mfma_f32_16x16x32_bf16 v[56:59], a[152:155], v[176:179], v[56:59]
s_add_u32 s5, s79, 65536
buffer_load_dwordx4 v[88:91], v3, s[12:15], s5 offen offset:0 sc1
v_mfma_f32_16x16x32_bf16 v[60:63], a[152:155], v[180:183], v[60:63]
v_mfma_f32_16x16x32_bf16 v[72:75], a[156:159], v[176:179], v[72:75]
s_add_u32 s5, s78, 12288
buffer_load_dwordx4 v[224:227], v3, s[12:15], s5 offen offset:1024 sc1
v_mfma_f32_16x16x32_bf16 v[76:79], a[156:159], v[180:183], v[76:79]
v_and_b32 v5, 3, v2
v_lshlrev_b32 v5, 2, v5
s_lshr_b32 s5, s72, 1
s_lshl_b32 s5, s5, 7
s_lshl_b32 s6, s4, 4
s_add_u32 s5, s5, s6
s_add_u32 s5, s5, 33591296
buffer_load_dword v4, v5, s[12:15], s5 offen sc1
s_waitcnt vmcnt(21)
v_mfma_f32_16x16x32_bf16 v[8:11], a[160:163], v[184:187], v[8:11]
v_mfma_f32_16x16x32_bf16 v[12:15], a[160:163], v[188:191], v[12:15]
s_add_u32 s5, s78, 69632
buffer_load_dwordx4 v[228:231], v3, s[12:15], s5 offen offset:1024 sc1
v_mfma_f32_16x16x32_bf16 v[24:27], a[164:167], v[184:187], v[24:27]
v_mfma_f32_16x16x32_bf16 v[28:31], a[164:167], v[188:191], v[28:31]
s_add_u32 s5, s79, 65536
buffer_load_dwordx4 v[92:95], v3, s[12:15], s5 offen offset:1024 sc1
v_mfma_f32_16x16x32_bf16 v[40:43], a[168:171], v[184:187], v[40:43]
v_mfma_f32_16x16x32_bf16 v[44:47], a[168:171], v[188:191], v[44:47]
v_mfma_f32_16x16x32_bf16 v[56:59], a[172:175], v[184:187], v[56:59]
s_add_u32 s5, s79, 65536
buffer_load_dwordx4 v[96:99], v3, s[12:15], s5 offen offset:2048 sc1
v_mfma_f32_16x16x32_bf16 v[60:63], a[172:175], v[188:191], v[60:63]
v_mfma_f32_16x16x32_bf16 v[72:75], a[176:179], v[184:187], v[72:75]
s_mov_b32 s48, s38
s_mov_b32 s49, s39
s_mov_b32 s50, 1280
s_mov_b32 s51, 0x20000
v_and_b32 v168, 15, v2
v_lshrrev_b32 v169, 4, v2
s_mul_i32 s62, s73, 20
s_lshl_b32 s63, s72, 1
s_add_u32 s63, s63, s4
s_add_u32 s64, s63, 62
s_cmp_ge_u32 s4, 2
s_cselect_b32 s63, s64, s63
s_mov_b32 s81, s63
s_mul_i32 s63, s63, 20480
s_add_u32 s63, s63, 5242880
v_add_u32 v170, s62, v169
v_add_u32 v170, 0, v170
v_lshrrev_b32 v171, 3, v170
v_lshlrev_b32 v171, 10, v171
v_bfe_u32 v172, v170, 1, 2
v_lshl_add_u32 v171, v172, 8, v171
v_and_b32 v172, 1, v170
v_lshl_add_u32 v171, v172, 3, v171
v_lshl_add_u32 v171, v168, 4, v171
buffer_load_dwordx2 v[232:233], v171, s[12:15], s63 offen sc1
v_lshlrev_b32 v170, 3, v170
buffer_load_dwordx2 v[242:243], v170, s[48:51], 0 offen
v_mfma_f32_16x16x32_bf16 v[76:79], a[176:179], v[188:191], v[76:79]
s_waitcnt vmcnt(21)
v_mfma_f32_16x16x32_bf16 v[8:11], a[180:183], v[192:195], v[8:11]
v_mfma_f32_16x16x32_bf16 v[12:15], a[180:183], v[196:199], v[12:15]
s_add_u32 s5, s79, 65536
buffer_load_dwordx4 v[100:103], v3, s[12:15], s5 offen offset:3072 sc1
v_mfma_f32_16x16x32_bf16 v[24:27], a[184:187], v[192:195], v[24:27]
v_mfma_f32_16x16x32_bf16 v[28:31], a[184:187], v[196:199], v[28:31]
s_add_u32 s5, s79, 69632
buffer_load_dwordx4 v[104:107], v3, s[12:15], s5 offen offset:0 sc1
v_mfma_f32_16x16x32_bf16 v[40:43], a[188:191], v[192:195], v[40:43]
v_mfma_f32_16x16x32_bf16 v[44:47], a[188:191], v[196:199], v[44:47]
v_mfma_f32_16x16x32_bf16 v[56:59], a[192:195], v[192:195], v[56:59]
v_add_u32 v170, s62, v169
v_add_u32 v170, 4, v170
v_lshrrev_b32 v171, 3, v170
v_lshlrev_b32 v171, 10, v171
v_bfe_u32 v172, v170, 1, 2
v_lshl_add_u32 v171, v172, 8, v171
v_and_b32 v172, 1, v170
v_lshl_add_u32 v171, v172, 3, v171
v_lshl_add_u32 v171, v168, 4, v171
buffer_load_dwordx2 v[234:235], v171, s[12:15], s63 offen sc1
v_lshlrev_b32 v170, 3, v170
buffer_load_dwordx2 v[244:245], v170, s[48:51], 0 offen
v_mfma_f32_16x16x32_bf16 v[60:63], a[192:195], v[196:199], v[60:63]
v_mfma_f32_16x16x32_bf16 v[72:75], a[196:199], v[192:195], v[72:75]
s_add_u32 s5, s79, 69632
buffer_load_dwordx4 v[108:111], v3, s[12:15], s5 offen offset:1024 sc1
v_mfma_f32_16x16x32_bf16 v[76:79], a[196:199], v[196:199], v[76:79]
s_waitcnt vmcnt(22)
v_mfma_f32_16x16x32_bf16 v[8:11], a[200:203], v[200:203], v[8:11]
v_mfma_f32_16x16x32_bf16 v[12:15], a[200:203], v[204:207], v[12:15]
v_add_u32 v170, s62, v169
v_add_u32 v170, 8, v170
v_lshrrev_b32 v171, 3, v170
v_lshlrev_b32 v171, 10, v171
v_bfe_u32 v172, v170, 1, 2
v_lshl_add_u32 v171, v172, 8, v171
v_and_b32 v172, 1, v170
v_lshl_add_u32 v171, v172, 3, v171
v_lshl_add_u32 v171, v168, 4, v171
buffer_load_dwordx2 v[236:237], v171, s[12:15], s63 offen sc1
v_lshlrev_b32 v170, 3, v170
buffer_load_dwordx2 v[246:247], v170, s[48:51], 0 offen
v_mfma_f32_16x16x32_bf16 v[24:27], a[204:207], v[200:203], v[24:27]
v_mfma_f32_16x16x32_bf16 v[28:31], a[204:207], v[204:207], v[28:31]
v_add_u32 v170, s62, v169
v_add_u32 v170, 12, v170
v_lshrrev_b32 v171, 3, v170
v_lshlrev_b32 v171, 10, v171
v_bfe_u32 v172, v170, 1, 2
v_lshl_add_u32 v171, v172, 8, v171
v_and_b32 v172, 1, v170
v_lshl_add_u32 v171, v172, 3, v171
v_lshl_add_u32 v171, v168, 4, v171
buffer_load_dwordx2 v[238:239], v171, s[12:15], s63 offen sc1
v_lshlrev_b32 v170, 3, v170
buffer_load_dwordx2 v[248:249], v170, s[48:51], 0 offen
v_mfma_f32_16x16x32_bf16 v[40:43], a[208:211], v[200:203], v[40:43]
v_mfma_f32_16x16x32_bf16 v[44:47], a[208:211], v[204:207], v[44:47]
v_mfma_f32_16x16x32_bf16 v[56:59], a[212:215], v[200:203], v[56:59]
v_mfma_f32_16x16x32_bf16 v[60:63], a[212:215], v[204:207], v[60:63]
v_mfma_f32_16x16x32_bf16 v[72:75], a[216:219], v[200:203], v[72:75]
v_mfma_f32_16x16x32_bf16 v[76:79], a[216:219], v[204:207], v[76:79]
s_waitcnt vmcnt(14)
s_mov_b32 s7, 0
s_branch Lrc_60
Lrp_59:
s_sleep 1
v_and_b32 v5, 3, v2
v_lshlrev_b32 v5, 2, v5
s_lshr_b32 s5, s72, 1
s_lshl_b32 s5, s5, 7
s_lshl_b32 s6, s4, 4
s_add_u32 s5, s5, s6
s_add_u32 s5, s5, 33591296
buffer_load_dword v4, v5, s[12:15], s5 offen sc1
s_waitcnt vmcnt(0)
Lrc_60:
v_cmp_ne_u32 vcc, s83, v4
s_cbranch_vccz Lrd_61
s_add_u32 s7, s7, 1
s_cmp_lt_u32 s7, 0x40000
s_cbranch_scc1 Lrp_59
Lrd_61:
s_add_u32 s5, s78, 3670016
buffer_load_dwordx4 v[112:115], v3, s[12:15], s5 offen offset:0 sc1
s_add_u32 s5, s78, 3727360
buffer_load_dwordx4 v[116:119], v3, s[12:15], s5 offen offset:0 sc1
s_add_u32 s5, s78, 3670016
buffer_load_dwordx4 v[120:123], v3, s[12:15], s5 offen offset:1024 sc1
s_add_u32 s5, s78, 3727360
buffer_load_dwordx4 v[124:127], v3, s[12:15], s5 offen offset:1024 sc1
s_waitcnt vmcnt(26)
v_mfma_f32_16x16x32_bf16 v[8:11], a[220:223], v[208:211], v[8:11]
v_mfma_f32_16x16x32_bf16 v[12:15], a[220:223], v[212:215], v[12:15]
v_add_u32 v170, s62, v169
v_add_u32 v170, 16, v170
v_lshrrev_b32 v171, 3, v170
v_lshlrev_b32 v171, 10, v171
v_bfe_u32 v172, v170, 1, 2
v_lshl_add_u32 v171, v172, 8, v171
v_and_b32 v172, 1, v170
v_lshl_add_u32 v171, v172, 3, v171
v_lshl_add_u32 v171, v168, 4, v171
buffer_load_dwordx2 v[240:241], v171, s[12:15], s63 offen sc1
v_lshlrev_b32 v170, 3, v170
buffer_load_dwordx2 v[250:251], v170, s[48:51], 0 offen
v_mfma_f32_16x16x32_bf16 v[24:27], a[224:227], v[208:211], v[24:27]
v_mfma_f32_16x16x32_bf16 v[28:31], a[224:227], v[212:215], v[28:31]
s_add_u32 s5, s78, 3670016
buffer_load_dwordx4 v[128:131], v3, s[12:15], s5 offen offset:2048 sc1
v_mfma_f32_16x16x32_bf16 v[40:43], a[228:231], v[208:211], v[40:43]
v_mfma_f32_16x16x32_bf16 v[44:47], a[228:231], v[212:215], v[44:47]
v_mfma_f32_16x16x32_bf16 v[56:59], a[232:235], v[208:211], v[56:59]
s_add_u32 s5, s78, 3727360
buffer_load_dwordx4 v[132:135], v3, s[12:15], s5 offen offset:2048 sc1
v_mfma_f32_16x16x32_bf16 v[60:63], a[232:235], v[212:215], v[60:63]
v_mfma_f32_16x16x32_bf16 v[72:75], a[236:239], v[208:211], v[72:75]
s_add_u32 s5, s78, 3670016
buffer_load_dwordx4 v[136:139], v3, s[12:15], s5 offen offset:3072 sc1
v_mfma_f32_16x16x32_bf16 v[76:79], a[236:239], v[212:215], v[76:79]
s_waitcnt vmcnt(25)
v_mfma_f32_16x16x32_bf16 v[8:11], a[240:243], v[216:219], v[8:11]
v_mfma_f32_16x16x32_bf16 v[12:15], a[240:243], v[220:223], v[12:15]
s_add_u32 s5, s78, 3727360
buffer_load_dwordx4 v[140:143], v3, s[12:15], s5 offen offset:3072 sc1
v_mfma_f32_16x16x32_bf16 v[24:27], a[244:247], v[216:219], v[24:27]
v_mfma_f32_16x16x32_bf16 v[28:31], a[244:247], v[220:223], v[28:31]
s_add_u32 s5, s78, 3674112
buffer_load_dwordx4 v[144:147], v3, s[12:15], s5 offen offset:0 sc1
v_mfma_f32_16x16x32_bf16 v[40:43], a[248:251], v[216:219], v[40:43]
v_mfma_f32_16x16x32_bf16 v[44:47], a[248:251], v[220:223], v[44:47]
v_mfma_f32_16x16x32_bf16 v[56:59], a[252:255], v[216:219], v[56:59]
s_add_u32 s5, s78, 3731456
buffer_load_dwordx4 v[148:151], v3, s[12:15], s5 offen offset:0 sc1
v_mfma_f32_16x16x32_bf16 v[60:63], a[252:255], v[220:223], v[60:63]
v_mfma_f32_16x16x32_bf16 v[72:75], v[88:91], v[216:219], v[72:75]
s_add_u32 s5, s78, 3674112
buffer_load_dwordx4 v[152:155], v3, s[12:15], s5 offen offset:1024 sc1
v_mfma_f32_16x16x32_bf16 v[76:79], v[88:91], v[220:223], v[76:79]
s_waitcnt vmcnt(17)
v_mfma_f32_16x16x32_bf16 v[8:11], v[92:95], v[224:227], v[8:11]
v_mfma_f32_16x16x32_bf16 v[12:15], v[92:95], v[228:231], v[12:15]
s_add_u32 s5, s78, 3731456
buffer_load_dwordx4 v[156:159], v3, s[12:15], s5 offen offset:1024 sc1
v_mfma_f32_16x16x32_bf16 v[24:27], v[96:99], v[224:227], v[24:27]
v_mfma_f32_16x16x32_bf16 v[28:31], v[96:99], v[228:231], v[28:31]
v_mfma_f32_16x16x32_bf16 v[40:43], v[100:103], v[224:227], v[40:43]
v_mfma_f32_16x16x32_bf16 v[44:47], v[100:103], v[228:231], v[44:47]
v_mfma_f32_16x16x32_bf16 v[56:59], v[104:107], v[224:227], v[56:59]
v_mfma_f32_16x16x32_bf16 v[60:63], v[104:107], v[228:231], v[60:63]
v_mfma_f32_16x16x32_bf16 v[72:75], v[108:111], v[224:227], v[72:75]
v_mfma_f32_16x16x32_bf16 v[76:79], v[108:111], v[228:231], v[76:79]
s_mul_i32 s5, s4, 20480
v_add_u32 v6, s5, v3
s_waitcnt vmcnt(12)
v_mfma_f32_16x16x32_bf16 v[16:19], a[0:3], v[112:115], 0
v_mfma_f32_16x16x32_bf16 v[20:23], a[0:3], v[116:119], 0
s_add_u32 s5, s78, 3674112
buffer_load_dwordx4 v[160:163], v3, s[12:15], s5 offen offset:2048 sc1
v_mfma_f32_16x16x32_bf16 v[32:35], a[4:7], v[112:115], 0
v_mfma_f32_16x16x32_bf16 v[36:39], a[4:7], v[116:119], 0
s_add_u32 s5, s78, 3731456
buffer_load_dwordx4 v[164:167], v3, s[12:15], s5 offen offset:2048 sc1
v_mfma_f32_16x16x32_bf16 v[48:51], a[8:11], v[112:115], 0
v_mfma_f32_16x16x32_bf16 v[52:55], a[8:11], v[116:119], 0
v_mfma_f32_16x16x32_bf16 v[64:67], a[12:15], v[112:115], 0
v_mfma_f32_16x16x32_bf16 v[68:71], a[12:15], v[116:119], 0
v_mfma_f32_16x16x32_bf16 v[80:83], a[16:19], v[112:115], 0
v_mfma_f32_16x16x32_bf16 v[84:87], a[16:19], v[116:119], 0
s_waitcnt vmcnt(12)
v_mfma_f32_16x16x32_bf16 v[16:19], a[20:23], v[120:123], v[16:19]
v_mfma_f32_16x16x32_bf16 v[20:23], a[20:23], v[124:127], v[20:23]
s_add_u32 s5, s78, 3674112
buffer_load_dwordx4 v[112:115], v3, s[12:15], s5 offen offset:3072 sc1
v_mfma_f32_16x16x32_bf16 v[32:35], a[24:27], v[120:123], v[32:35]
v_mfma_f32_16x16x32_bf16 v[36:39], a[24:27], v[124:127], v[36:39]
s_add_u32 s5, s78, 3731456
buffer_load_dwordx4 v[116:119], v3, s[12:15], s5 offen offset:3072 sc1
v_mfma_f32_16x16x32_bf16 v[48:51], a[28:31], v[120:123], v[48:51]
ds_write_b128 v6, v[8:11] offset:0
v_mfma_f32_16x16x32_bf16 v[52:55], a[28:31], v[124:127], v[52:55]
v_mfma_f32_16x16x32_bf16 v[64:67], a[32:35], v[120:123], v[64:67]
v_mfma_f32_16x16x32_bf16 v[68:71], a[32:35], v[124:127], v[68:71]
v_mfma_f32_16x16x32_bf16 v[80:83], a[36:39], v[120:123], v[80:83]
v_mfma_f32_16x16x32_bf16 v[84:87], a[36:39], v[124:127], v[84:87]
s_waitcnt vmcnt(10)
v_mfma_f32_16x16x32_bf16 v[16:19], a[40:43], v[128:131], v[16:19]
v_mfma_f32_16x16x32_bf16 v[20:23], a[40:43], v[132:135], v[20:23]
s_add_u32 s5, s78, 3678208
buffer_load_dwordx4 v[120:123], v3, s[12:15], s5 offen offset:0 sc1
v_mfma_f32_16x16x32_bf16 v[32:35], a[44:47], v[128:131], v[32:35]
v_mfma_f32_16x16x32_bf16 v[36:39], a[44:47], v[132:135], v[36:39]
s_add_u32 s5, s78, 3735552
buffer_load_dwordx4 v[124:127], v3, s[12:15], s5 offen offset:0 sc1
v_mfma_f32_16x16x32_bf16 v[48:51], a[48:51], v[128:131], v[48:51]
ds_write_b128 v6, v[24:27] offset:1024
v_mfma_f32_16x16x32_bf16 v[52:55], a[48:51], v[132:135], v[52:55]
v_mfma_f32_16x16x32_bf16 v[64:67], a[52:55], v[128:131], v[64:67]
v_mfma_f32_16x16x32_bf16 v[68:71], a[52:55], v[132:135], v[68:71]
v_mfma_f32_16x16x32_bf16 v[80:83], a[56:59], v[128:131], v[80:83]
v_mfma_f32_16x16x32_bf16 v[84:87], a[56:59], v[132:135], v[84:87]
s_waitcnt vmcnt(10)
v_mfma_f32_16x16x32_bf16 v[16:19], a[60:63], v[136:139], v[16:19]
v_mfma_f32_16x16x32_bf16 v[20:23], a[60:63], v[140:143], v[20:23]
s_add_u32 s5, s78, 3678208
buffer_load_dwordx4 v[128:131], v3, s[12:15], s5 offen offset:1024 sc1
v_mfma_f32_16x16x32_bf16 v[32:35], a[64:67], v[136:139], v[32:35]
v_mfma_f32_16x16x32_bf16 v[36:39], a[64:67], v[140:143], v[36:39]
s_add_u32 s5, s78, 3735552
buffer_load_dwordx4 v[132:135], v3, s[12:15], s5 offen offset:1024 sc1
v_mfma_f32_16x16x32_bf16 v[48:51], a[68:71], v[136:139], v[48:51]
ds_write_b128 v6, v[40:43] offset:2048
v_mfma_f32_16x16x32_bf16 v[52:55], a[68:71], v[140:143], v[52:55]
v_mfma_f32_16x16x32_bf16 v[64:67], a[72:75], v[136:139], v[64:67]
v_mfma_f32_16x16x32_bf16 v[68:71], a[72:75], v[140:143], v[68:71]
v_mfma_f32_16x16x32_bf16 v[80:83], a[76:79], v[136:139], v[80:83]
v_mfma_f32_16x16x32_bf16 v[84:87], a[76:79], v[140:143], v[84:87]
s_waitcnt vmcnt(10)
v_mfma_f32_16x16x32_bf16 v[16:19], a[80:83], v[144:147], v[16:19]
v_mfma_f32_16x16x32_bf16 v[20:23], a[80:83], v[148:151], v[20:23]
s_add_u32 s5, s78, 3678208
buffer_load_dwordx4 v[136:139], v3, s[12:15], s5 offen offset:2048 sc1
v_mfma_f32_16x16x32_bf16 v[32:35], a[84:87], v[144:147], v[32:35]
v_mfma_f32_16x16x32_bf16 v[36:39], a[84:87], v[148:151], v[36:39]
s_add_u32 s5, s78, 3735552
buffer_load_dwordx4 v[140:143], v3, s[12:15], s5 offen offset:2048 sc1
v_mfma_f32_16x16x32_bf16 v[48:51], a[88:91], v[144:147], v[48:51]
ds_write_b128 v6, v[56:59] offset:3072
v_mfma_f32_16x16x32_bf16 v[52:55], a[88:91], v[148:151], v[52:55]
v_mfma_f32_16x16x32_bf16 v[64:67], a[92:95], v[144:147], v[64:67]
v_mfma_f32_16x16x32_bf16 v[68:71], a[92:95], v[148:151], v[68:71]
v_mfma_f32_16x16x32_bf16 v[80:83], a[96:99], v[144:147], v[80:83]
v_mfma_f32_16x16x32_bf16 v[84:87], a[96:99], v[148:151], v[84:87]
s_waitcnt vmcnt(10)
v_mfma_f32_16x16x32_bf16 v[16:19], a[100:103], v[152:155], v[16:19]
v_mfma_f32_16x16x32_bf16 v[20:23], a[100:103], v[156:159], v[20:23]
s_add_u32 s5, s78, 3678208
buffer_load_dwordx4 v[144:147], v3, s[12:15], s5 offen offset:3072 sc1
v_mfma_f32_16x16x32_bf16 v[32:35], a[104:107], v[152:155], v[32:35]
v_mfma_f32_16x16x32_bf16 v[36:39], a[104:107], v[156:159], v[36:39]
s_add_u32 s5, s78, 3735552
buffer_load_dwordx4 v[148:151], v3, s[12:15], s5 offen offset:3072 sc1
v_mfma_f32_16x16x32_bf16 v[48:51], a[108:111], v[152:155], v[48:51]
ds_write_b128 v6, v[72:75] offset:4096
v_mfma_f32_16x16x32_bf16 v[52:55], a[108:111], v[156:159], v[52:55]
v_mfma_f32_16x16x32_bf16 v[64:67], a[112:115], v[152:155], v[64:67]
v_mfma_f32_16x16x32_bf16 v[68:71], a[112:115], v[156:159], v[68:71]
v_mfma_f32_16x16x32_bf16 v[80:83], a[116:119], v[152:155], v[80:83]
v_mfma_f32_16x16x32_bf16 v[84:87], a[116:119], v[156:159], v[84:87]
s_waitcnt vmcnt(10)
v_mfma_f32_16x16x32_bf16 v[16:19], a[120:123], v[160:163], v[16:19]
v_mfma_f32_16x16x32_bf16 v[20:23], a[120:123], v[164:167], v[20:23]
s_add_u32 s5, s78, 3682304
buffer_load_dwordx4 v[152:155], v3, s[12:15], s5 offen offset:0 sc1
v_mfma_f32_16x16x32_bf16 v[32:35], a[124:127], v[160:163], v[32:35]
v_mfma_f32_16x16x32_bf16 v[36:39], a[124:127], v[164:167], v[36:39]
s_add_u32 s5, s78, 3739648
buffer_load_dwordx4 v[156:159], v3, s[12:15], s5 offen offset:0 sc1
v_mfma_f32_16x16x32_bf16 v[48:51], a[128:131], v[160:163], v[48:51]
ds_write_b128 v6, v[12:15] offset:5120
v_mfma_f32_16x16x32_bf16 v[52:55], a[128:131], v[164:167], v[52:55]
v_mfma_f32_16x16x32_bf16 v[64:67], a[132:135], v[160:163], v[64:67]
v_mfma_f32_16x16x32_bf16 v[68:71], a[132:135], v[164:167], v[68:71]
v_mfma_f32_16x16x32_bf16 v[80:83], a[136:139], v[160:163], v[80:83]
v_mfma_f32_16x16x32_bf16 v[84:87], a[136:139], v[164:167], v[84:87]
s_waitcnt vmcnt(10)
v_mfma_f32_16x16x32_bf16 v[16:19], a[140:143], v[112:115], v[16:19]
v_mfma_f32_16x16x32_bf16 v[20:23], a[140:143], v[116:119], v[20:23]
s_add_u32 s5, s78, 3682304
buffer_load_dwordx4 v[160:163], v3, s[12:15], s5 offen offset:1024 sc1
v_mfma_f32_16x16x32_bf16 v[32:35], a[144:147], v[112:115], v[32:35]
v_mfma_f32_16x16x32_bf16 v[36:39], a[144:147], v[116:119], v[36:39]
s_add_u32 s5, s78, 3739648
buffer_load_dwordx4 v[164:167], v3, s[12:15], s5 offen offset:1024 sc1
v_mfma_f32_16x16x32_bf16 v[48:51], a[148:151], v[112:115], v[48:51]
ds_write_b128 v6, v[28:31] offset:6144
v_mfma_f32_16x16x32_bf16 v[52:55], a[148:151], v[116:119], v[52:55]
v_mfma_f32_16x16x32_bf16 v[64:67], a[152:155], v[112:115], v[64:67]
v_mfma_f32_16x16x32_bf16 v[68:71], a[152:155], v[116:119], v[68:71]
v_mfma_f32_16x16x32_bf16 v[80:83], a[156:159], v[112:115], v[80:83]
v_mfma_f32_16x16x32_bf16 v[84:87], a[156:159], v[116:119], v[84:87]
s_waitcnt vmcnt(10)
v_mfma_f32_16x16x32_bf16 v[16:19], a[160:163], v[120:123], v[16:19]
v_mfma_f32_16x16x32_bf16 v[20:23], a[160:163], v[124:127], v[20:23]
v_mfma_f32_16x16x32_bf16 v[32:35], a[164:167], v[120:123], v[32:35]
v_mfma_f32_16x16x32_bf16 v[36:39], a[164:167], v[124:127], v[36:39]
v_mfma_f32_16x16x32_bf16 v[48:51], a[168:171], v[120:123], v[48:51]
ds_write_b128 v6, v[44:47] offset:7168
v_mfma_f32_16x16x32_bf16 v[52:55], a[168:171], v[124:127], v[52:55]
v_mfma_f32_16x16x32_bf16 v[64:67], a[172:175], v[120:123], v[64:67]
v_mfma_f32_16x16x32_bf16 v[68:71], a[172:175], v[124:127], v[68:71]
v_mfma_f32_16x16x32_bf16 v[80:83], a[176:179], v[120:123], v[80:83]
v_mfma_f32_16x16x32_bf16 v[84:87], a[176:179], v[124:127], v[84:87]
s_waitcnt vmcnt(8)
v_mfma_f32_16x16x32_bf16 v[16:19], a[180:183], v[128:131], v[16:19]
v_mfma_f32_16x16x32_bf16 v[20:23], a[180:183], v[132:135], v[20:23]
v_mfma_f32_16x16x32_bf16 v[32:35], a[184:187], v[128:131], v[32:35]
v_mfma_f32_16x16x32_bf16 v[36:39], a[184:187], v[132:135], v[36:39]
v_mfma_f32_16x16x32_bf16 v[48:51], a[188:191], v[128:131], v[48:51]
ds_write_b128 v6, v[60:63] offset:8192
v_mfma_f32_16x16x32_bf16 v[52:55], a[188:191], v[132:135], v[52:55]
v_mfma_f32_16x16x32_bf16 v[64:67], a[192:195], v[128:131], v[64:67]
v_mfma_f32_16x16x32_bf16 v[68:71], a[192:195], v[132:135], v[68:71]
v_mfma_f32_16x16x32_bf16 v[80:83], a[196:199], v[128:131], v[80:83]
v_mfma_f32_16x16x32_bf16 v[84:87], a[196:199], v[132:135], v[84:87]
s_waitcnt vmcnt(6)
v_mfma_f32_16x16x32_bf16 v[16:19], a[200:203], v[136:139], v[16:19]
v_mfma_f32_16x16x32_bf16 v[20:23], a[200:203], v[140:143], v[20:23]
v_mfma_f32_16x16x32_bf16 v[32:35], a[204:207], v[136:139], v[32:35]
v_mfma_f32_16x16x32_bf16 v[36:39], a[204:207], v[140:143], v[36:39]
v_mfma_f32_16x16x32_bf16 v[48:51], a[208:211], v[136:139], v[48:51]
ds_write_b128 v6, v[76:79] offset:9216
v_mfma_f32_16x16x32_bf16 v[52:55], a[208:211], v[140:143], v[52:55]
v_mfma_f32_16x16x32_bf16 v[64:67], a[212:215], v[136:139], v[64:67]
v_mfma_f32_16x16x32_bf16 v[68:71], a[212:215], v[140:143], v[68:71]
v_mfma_f32_16x16x32_bf16 v[80:83], a[216:219], v[136:139], v[80:83]
v_mfma_f32_16x16x32_bf16 v[84:87], a[216:219], v[140:143], v[84:87]
s_waitcnt vmcnt(4)
v_mfma_f32_16x16x32_bf16 v[16:19], a[220:223], v[144:147], v[16:19]
v_mfma_f32_16x16x32_bf16 v[20:23], a[220:223], v[148:151], v[20:23]
v_mfma_f32_16x16x32_bf16 v[32:35], a[224:227], v[144:147], v[32:35]
v_mfma_f32_16x16x32_bf16 v[36:39], a[224:227], v[148:151], v[36:39]
v_mfma_f32_16x16x32_bf16 v[48:51], a[228:231], v[144:147], v[48:51]
v_mfma_f32_16x16x32_bf16 v[52:55], a[228:231], v[148:151], v[52:55]
v_mfma_f32_16x16x32_bf16 v[64:67], a[232:235], v[144:147], v[64:67]
v_mfma_f32_16x16x32_bf16 v[68:71], a[232:235], v[148:151], v[68:71]
v_mfma_f32_16x16x32_bf16 v[80:83], a[236:239], v[144:147], v[80:83]
v_mfma_f32_16x16x32_bf16 v[84:87], a[236:239], v[148:151], v[84:87]
s_waitcnt vmcnt(2)
v_mfma_f32_16x16x32_bf16 v[16:19], a[240:243], v[152:155], v[16:19]
v_mfma_f32_16x16x32_bf16 v[20:23], a[240:243], v[156:159], v[20:23]
v_mfma_f32_16x16x32_bf16 v[32:35], a[244:247], v[152:155], v[32:35]
v_mfma_f32_16x16x32_bf16 v[36:39], a[244:247], v[156:159], v[36:39]
v_mfma_f32_16x16x32_bf16 v[48:51], a[248:251], v[152:155], v[48:51]
v_mfma_f32_16x16x32_bf16 v[52:55], a[248:251], v[156:159], v[52:55]
v_mfma_f32_16x16x32_bf16 v[64:67], a[252:255], v[152:155], v[64:67]
v_mfma_f32_16x16x32_bf16 v[68:71], a[252:255], v[156:159], v[68:71]
v_mfma_f32_16x16x32_bf16 v[80:83], v[88:91], v[152:155], v[80:83]
v_mfma_f32_16x16x32_bf16 v[84:87], v[88:91], v[156:159], v[84:87]
s_waitcnt vmcnt(0)
v_mfma_f32_16x16x32_bf16 v[16:19], v[92:95], v[160:163], v[16:19]
v_mfma_f32_16x16x32_bf16 v[20:23], v[92:95], v[164:167], v[20:23]
v_mfma_f32_16x16x32_bf16 v[32:35], v[96:99], v[160:163], v[32:35]
v_mfma_f32_16x16x32_bf16 v[36:39], v[96:99], v[164:167], v[36:39]
v_mfma_f32_16x16x32_bf16 v[48:51], v[100:103], v[160:163], v[48:51]
v_mfma_f32_16x16x32_bf16 v[52:55], v[100:103], v[164:167], v[52:55]
v_mfma_f32_16x16x32_bf16 v[64:67], v[104:107], v[160:163], v[64:67]
v_mfma_f32_16x16x32_bf16 v[68:71], v[104:107], v[164:167], v[68:71]
v_mfma_f32_16x16x32_bf16 v[80:83], v[108:111], v[160:163], v[80:83]
v_mfma_f32_16x16x32_bf16 v[84:87], v[108:111], v[164:167], v[84:87]
v_lshlrev_b32 v3, 4, v2
s_mul_i32 s5, s4, 20480
v_add_u32 v6, s5, v3
s_cmp_eq_u32 s4, 2
s_cbranch_scc1 Lp4w_62
ds_write_b128 v6, v[16:19] offset:10240
ds_write_b128 v6, v[32:35] offset:11264
ds_write_b128 v6, v[48:51] offset:12288
ds_write_b128 v6, v[64:67] offset:13312
ds_write_b128 v6, v[80:83] offset:14336
Lp4w_62:
s_cmp_eq_u32 s4, 3
s_cbranch_scc1 Lp4w_63
ds_write_b128 v6, v[20:23] offset:15360
ds_write_b128 v6, v[36:39] offset:16384
ds_write_b128 v6, v[52:55] offset:17408
ds_write_b128 v6, v[68:71] offset:18432
ds_write_b128 v6, v[84:87] offset:19456
Lp4w_63:
s_cmp_eq_u32 s4, 0
s_cbranch_scc0 Lp4c_65
v_pk_mov_b32 v[112:113], v[8:9], v[8:9] op_sel:[0,1]
v_pk_mov_b32 v[114:115], v[10:11], v[10:11] op_sel:[0,1]
v_pk_mov_b32 v[116:117], v[24:25], v[24:25] op_sel:[0,1]
v_pk_mov_b32 v[118:119], v[26:27], v[26:27] op_sel:[0,1]
v_pk_mov_b32 v[120:121], v[40:41], v[40:41] op_sel:[0,1]
v_pk_mov_b32 v[122:123], v[42:43], v[42:43] op_sel:[0,1]
v_pk_mov_b32 v[124:125], v[56:57], v[56:57] op_sel:[0,1]
v_pk_mov_b32 v[126:127], v[58:59], v[58:59] op_sel:[0,1]
v_pk_mov_b32 v[128:129], v[72:73], v[72:73] op_sel:[0,1]
v_pk_mov_b32 v[130:131], v[74:75], v[74:75] op_sel:[0,1]
s_branch Lp4o_64
Lp4c_65:
s_cmp_eq_u32 s4, 1
s_cbranch_scc0 Lp4c_66
v_pk_mov_b32 v[112:113], v[12:13], v[12:13] op_sel:[0,1]
v_pk_mov_b32 v[114:115], v[14:15], v[14:15] op_sel:[0,1]
v_pk_mov_b32 v[116:117], v[28:29], v[28:29] op_sel:[0,1]
v_pk_mov_b32 v[118:119], v[30:31], v[30:31] op_sel:[0,1]
v_pk_mov_b32 v[120:121], v[44:45], v[44:45] op_sel:[0,1]
v_pk_mov_b32 v[122:123], v[46:47], v[46:47] op_sel:[0,1]
v_pk_mov_b32 v[124:125], v[60:61], v[60:61] op_sel:[0,1]
v_pk_mov_b32 v[126:127], v[62:63], v[62:63] op_sel:[0,1]
v_pk_mov_b32 v[128:129], v[76:77], v[76:77] op_sel:[0,1]
v_pk_mov_b32 v[130:131], v[78:79], v[78:79] op_sel:[0,1]
s_branch Lp4o_64
Lp4c_66:
s_cmp_eq_u32 s4, 2
s_cbranch_scc0 Lp4c_67
v_pk_mov_b32 v[112:113], v[16:17], v[16:17] op_sel:[0,1]
v_pk_mov_b32 v[114:115], v[18:19], v[18:19] op_sel:[0,1]
v_pk_mov_b32 v[116:117], v[32:33], v[32:33] op_sel:[0,1]
v_pk_mov_b32 v[118:119], v[34:35], v[34:35] op_sel:[0,1]
v_pk_mov_b32 v[120:121], v[48:49], v[48:49] op_sel:[0,1]
v_pk_mov_b32 v[122:123], v[50:51], v[50:51] op_sel:[0,1]
v_pk_mov_b32 v[124:125], v[64:65], v[64:65] op_sel:[0,1]
v_pk_mov_b32 v[126:127], v[66:67], v[66:67] op_sel:[0,1]
v_pk_mov_b32 v[128:129], v[80:81], v[80:81] op_sel:[0,1]
v_pk_mov_b32 v[130:131], v[82:83], v[82:83] op_sel:[0,1]
s_branch Lp4o_64
Lp4c_67:
s_cmp_eq_u32 s4, 3
s_cbranch_scc0 Lp4c_68
v_pk_mov_b32 v[112:113], v[20:21], v[20:21] op_sel:[0,1]
v_pk_mov_b32 v[114:115], v[22:23], v[22:23] op_sel:[0,1]
v_pk_mov_b32 v[116:117], v[36:37], v[36:37] op_sel:[0,1]
v_pk_mov_b32 v[118:119], v[38:39], v[38:39] op_sel:[0,1]
v_pk_mov_b32 v[120:121], v[52:53], v[52:53] op_sel:[0,1]
v_pk_mov_b32 v[122:123], v[54:55], v[54:55] op_sel:[0,1]
v_pk_mov_b32 v[124:125], v[68:69], v[68:69] op_sel:[0,1]
v_pk_mov_b32 v[126:127], v[70:71], v[70:71] op_sel:[0,1]
v_pk_mov_b32 v[128:129], v[84:85], v[84:85] op_sel:[0,1]
v_pk_mov_b32 v[130:131], v[86:87], v[86:87] op_sel:[0,1]
s_branch Lp4o_64
Lp4c_68:
Lp4o_64:
s_waitcnt vmcnt(0) lgkmcnt(0)
s_barrier
s_add_u32 s5, s4, 1
s_and_b32 s5, s5, 3
s_mul_i32 s5, s5, 20480
s_mul_i32 s6, s4, 5120
s_add_u32 s5, s5, s6
v_add_u32 v5, s5, v3
s_add_u32 s5, s4, 2
s_and_b32 s5, s5, 3
s_mul_i32 s5, s5, 20480
s_mul_i32 s6, s4, 5120
s_add_u32 s5, s5, s6
v_add_u32 v6, s5, v3
s_add_u32 s5, s4, 3
s_and_b32 s5, s5, 3
s_mul_i32 s5, s5, 20480
s_mul_i32 s6, s4, 5120
s_add_u32 s5, s5, s6
v_add_u32 v7, s5, v3
ds_read_b128 v[172:175], v5 offset:0
ds_read_b128 v[176:179], v6 offset:0
ds_read_b128 v[180:183], v7 offset:0
ds_read_b128 v[184:187], v5 offset:1024
ds_read_b128 v[188:191], v6 offset:1024
ds_read_b128 v[192:195], v7 offset:1024
ds_read_b128 v[196:199], v5 offset:2048
ds_read_b128 v[200:203], v6 offset:2048
ds_read_b128 v[204:207], v7 offset:2048
ds_read_b128 v[208:211], v5 offset:3072
ds_read_b128 v[212:215], v6 offset:3072
ds_read_b128 v[216:219], v7 offset:3072
ds_read_b128 v[220:223], v5 offset:4096
ds_read_b128 v[224:227], v6 offset:4096
ds_read_b128 v[228:231], v7 offset:4096
v_lshlrev_b32 v8, 16, v242
v_and_b32 v9, 0xffff0000, v242
v_lshlrev_b32 v28, 16, v232
v_and_b32 v29, 0xffff0000, v232
v_pk_add_f32 v[112:113], v[112:113], v[8:9]
v_pk_add_f32 v[112:113], v[112:113], v[28:29]
v_lshlrev_b32 v10, 16, v243
v_and_b32 v11, 0xffff0000, v243
v_lshlrev_b32 v30, 16, v233
v_and_b32 v31, 0xffff0000, v233
v_pk_add_f32 v[114:115], v[114:115], v[10:11]
v_pk_add_f32 v[114:115], v[114:115], v[30:31]
v_lshlrev_b32 v12, 16, v244
v_and_b32 v13, 0xffff0000, v244
v_lshlrev_b32 v32, 16, v234
v_and_b32 v33, 0xffff0000, v234
v_pk_add_f32 v[116:117], v[116:117], v[12:13]
v_pk_add_f32 v[116:117], v[116:117], v[32:33]
v_lshlrev_b32 v14, 16, v245
v_and_b32 v15, 0xffff0000, v245
v_lshlrev_b32 v34, 16, v235
v_and_b32 v35, 0xffff0000, v235
v_pk_add_f32 v[118:119], v[118:119], v[14:15]
v_pk_add_f32 v[118:119], v[118:119], v[34:35]
v_lshlrev_b32 v16, 16, v246
v_and_b32 v17, 0xffff0000, v246
v_lshlrev_b32 v36, 16, v236
v_and_b32 v37, 0xffff0000, v236
v_pk_add_f32 v[120:121], v[120:121], v[16:17]
v_pk_add_f32 v[120:121], v[120:121], v[36:37]
v_lshlrev_b32 v18, 16, v247
v_and_b32 v19, 0xffff0000, v247
v_lshlrev_b32 v38, 16, v237
v_and_b32 v39, 0xffff0000, v237
v_pk_add_f32 v[122:123], v[122:123], v[18:19]
v_pk_add_f32 v[122:123], v[122:123], v[38:39]
v_lshlrev_b32 v20, 16, v248
v_and_b32 v21, 0xffff0000, v248
v_lshlrev_b32 v40, 16, v238
v_and_b32 v41, 0xffff0000, v238
v_pk_add_f32 v[124:125], v[124:125], v[20:21]
v_pk_add_f32 v[124:125], v[124:125], v[40:41]
v_lshlrev_b32 v22, 16, v249
v_and_b32 v23, 0xffff0000, v249
v_lshlrev_b32 v42, 16, v239
v_and_b32 v43, 0xffff0000, v239
v_pk_add_f32 v[126:127], v[126:127], v[22:23]
v_pk_add_f32 v[126:127], v[126:127], v[42:43]
v_lshlrev_b32 v24, 16, v250
v_and_b32 v25, 0xffff0000, v250
v_lshlrev_b32 v44, 16, v240
v_and_b32 v45, 0xffff0000, v240
v_pk_add_f32 v[128:129], v[128:129], v[24:25]
v_pk_add_f32 v[128:129], v[128:129], v[44:45]
v_lshlrev_b32 v26, 16, v251
v_and_b32 v27, 0xffff0000, v251
v_lshlrev_b32 v46, 16, v241
v_and_b32 v47, 0xffff0000, v241
v_pk_add_f32 v[130:131], v[130:131], v[26:27]
v_pk_add_f32 v[130:131], v[130:131], v[46:47]
s_mov_b32 s8, s40
s_mov_b32 s9, s41
s_mov_b32 s10, 2621440
s_mov_b32 s11, 0x20000
s_mul_i32 s5, s81, 20480
s_mul_i32 s6, s73, 160
s_add_u32 s5, s5, s6
v_mul_u32_u24 v4, 1280, v168
v_lshl_add_u32 v4, v169, 3, v4
s_mov_b32 s70, 0x00003f80
s_mov_b32 s71, 0x3f800000
s_waitcnt lgkmcnt(0)
v_pk_add_f32 v[112:113], v[112:113], v[172:173]
v_pk_add_f32 v[114:115], v[114:115], v[174:175]
v_pk_add_f32 v[116:117], v[116:117], v[184:185]
v_pk_add_f32 v[118:119], v[118:119], v[186:187]
v_pk_add_f32 v[120:121], v[120:121], v[196:197]
v_pk_add_f32 v[122:123], v[122:123], v[198:199]
v_pk_add_f32 v[124:125], v[124:125], v[208:209]
v_pk_add_f32 v[126:127], v[126:127], v[210:211]
v_pk_add_f32 v[128:129], v[128:129], v[220:221]
v_pk_add_f32 v[130:131], v[130:131], v[222:223]
v_pk_add_f32 v[112:113], v[112:113], v[176:177]
v_pk_add_f32 v[114:115], v[114:115], v[178:179]
v_pk_add_f32 v[116:117], v[116:117], v[188:189]
v_pk_add_f32 v[118:119], v[118:119], v[190:191]
v_pk_add_f32 v[120:121], v[120:121], v[200:201]
v_pk_add_f32 v[122:123], v[122:123], v[202:203]
v_pk_add_f32 v[124:125], v[124:125], v[212:213]
v_pk_add_f32 v[126:127], v[126:127], v[214:215]
v_pk_add_f32 v[128:129], v[128:129], v[224:225]
v_pk_add_f32 v[130:131], v[130:131], v[226:227]
v_pk_add_f32 v[112:113], v[112:113], v[180:181]
v_pk_add_f32 v[114:115], v[114:115], v[182:183]
v_pk_add_f32 v[116:117], v[116:117], v[192:193]
v_pk_add_f32 v[118:119], v[118:119], v[194:195]
v_pk_add_f32 v[120:121], v[120:121], v[204:205]
v_pk_add_f32 v[122:123], v[122:123], v[206:207]
v_pk_add_f32 v[124:125], v[124:125], v[216:217]
v_pk_add_f32 v[126:127], v[126:127], v[218:219]
v_pk_add_f32 v[128:129], v[128:129], v[228:229]
v_pk_add_f32 v[130:131], v[130:131], v[230:231]
v_cvt_pk_bf16_f32 v60, v112, v113
v_cvt_pk_bf16_f32 v61, v114, v115
v_cvt_pk_bf16_f32 v62, v116, v117
v_cvt_pk_bf16_f32 v63, v118, v119
v_cvt_pk_bf16_f32 v64, v120, v121
v_cvt_pk_bf16_f32 v65, v122, v123
v_cvt_pk_bf16_f32 v66, v124, v125
v_cvt_pk_bf16_f32 v67, v126, v127
v_cvt_pk_bf16_f32 v68, v128, v129
v_cvt_pk_bf16_f32 v69, v130, v131
buffer_store_dwordx2 v[60:61], v4, s[8:11], s5 offen offset:0
buffer_store_dwordx2 v[62:63], v4, s[8:11], s5 offen offset:32
buffer_store_dwordx2 v[64:65], v4, s[8:11], s5 offen offset:64
buffer_store_dwordx2 v[66:67], v4, s[8:11], s5 offen offset:96
buffer_store_dwordx2 v[68:69], v4, s[8:11], s5 offen offset:128
L_end_f:
s_endpgm
.section .rodata,"a"
.p2align 6
.amdhsa_kernel sequential_preLN__ssm_conv_s4d__dense_activation_squared_relu__prompt_kernel
  .amdhsa_next_free_vgpr 512
  .amdhsa_next_free_sgpr 102
  .amdhsa_accum_offset 256
  .amdhsa_group_segment_fixed_size 0
  .amdhsa_kernarg_size 120
  .amdhsa_user_sgpr_count 2
  .amdhsa_user_sgpr_kernarg_segment_ptr 1
  .amdhsa_system_sgpr_workgroup_id_x 1
.end_amdhsa_kernel
```
